```python
import torch

def _softmax(x, axis=-1):
    return torch.softmax(x, dim=axis)
def _gelu(x):
    return torch.nn.functional.gelu(x, approximate="tanh")
def _silu(x):
    return torch.nn.functional.silu(x)
def _sigmoid(x):
    return torch.sigmoid(x)
def _layernorm(x, axis=-1, eps=1e-5):
    m = x.mean(dim=axis, keepdim=True)
    v = x.var(dim=axis, keepdim=True, unbiased=False)
    return (x - m) / torch.sqrt(v + eps)
def _scatter_add(tgt, idx, src, axis=0):
    return tgt.clone().index_add_(axis, idx, src)
def _segment_sum(src, seg, n):
    out = torch.zeros((n,) + src.shape[1:], dtype=src.dtype)
    return out.index_add_(0, seg, src)
def _pad(x, pw):
    flat = tuple(v for pair in reversed(pw) for v in pair)
    return torch.nn.functional.pad(x, flat)

kernel_name = 'interleave_layers__sliding_block__glu_gated_bilinear__prompt'

def setup_inputs():

    _w = (lambda a: (lambda t: t.to(torch.bfloat16) if t.is_floating_point() else t)(torch.as_tensor(a)))
    def _A_setup():
        B, S, D = 1, 2048, 640
        return {
            "x": _w((lambda *s: torch.randn(*s, dtype=torch.bfloat16) * 0.05)(B, S, D)),
            "wqkv": _w((lambda *s: torch.randn(*s, dtype=torch.bfloat16) * 0.05)(D, 3 * D)),
            "wo": _w((lambda *s: torch.randn(*s, dtype=torch.bfloat16) * 0.05)(D, D)),
        }
    _A_in = _A_setup()

    def _B_setup():
        B, S, D, F = 1, 2048, 640, 1728
        return {
            "x": _w((lambda *s: torch.randn(*s, dtype=torch.bfloat16) * 0.05)(B, S, D)),
            "w_gate": _w((lambda *s: torch.randn(*s, dtype=torch.bfloat16) * 0.8)(D, F) * (D ** -0.5)),
            "w_up": _w((lambda *s: torch.randn(*s, dtype=torch.bfloat16) * 0.8)(D, F) * (D ** -0.5)),
            "w_down": _w((lambda *s: torch.randn(*s, dtype=torch.bfloat16) * 0.8)(F, D) * (F ** -0.5)),
        }
    _B_in = _B_setup()

    return {
        "A_x": _A_in["x"],
        "A_wqkv": _A_in["wqkv"],
        "A_wo": _A_in["wo"],
        "B_x": _B_in["x"],
        "B_w_gate": _B_in["w_gate"],
        "B_w_up": _B_in["w_up"],
        "B_w_down": _B_in["w_down"],
    }

def reference(A_x, A_wqkv, A_wo, B_x, B_w_gate, B_w_up, B_w_down):
    def _A_ref(x, wqkv, wo):
        B, S, D = x.shape
        H = 32; Dh = D // H; W = 256
        qkv = (lambda x, *d: x.permute(*d))((x @ wqkv).reshape(B, S, 3, H, Dh), 2, 0, 3, 1, 4)
        q, k, v = qkv[0], qkv[1], qkv[2]
        scores = torch.einsum("bhqd,bhkd->bhqk", q, k) * (Dh ** -0.5)
        idx = torch.arange(S)
        mask = (idx[:, None] - idx[None, :] >= 0) & (idx[:, None] - idx[None, :] < W)
        scores = torch.where(mask[None, None], scores, -1e9)
        p = _softmax(scores, axis=-1)
        o = torch.einsum("bhqk,bhkd->bhqd", p, v)
        return (lambda x, *d: x.permute(*d))(o, 0, 2, 1, 3).reshape(B, S, D) @ wo

    def _B_ref(x, w_gate, w_up, w_down):
        g = torch.einsum("bsd,df->bsf", x, w_gate)
        u = torch.einsum("bsd,df->bsf", x, w_up)
        h = g * u
        return torch.einsum("bsf,fd->bsd", h, w_down)

    x = A_x
    x = x + _A_ref(_layernorm(x, axis=-1), A_wqkv, A_wo)
    x = x + _B_ref(_layernorm(x, axis=-1), B_w_gate, B_w_up, B_w_down)
    x = x + _A_ref(_layernorm(x, axis=-1), A_wqkv, A_wo)
    x = x + _B_ref(_layernorm(x, axis=-1), B_w_gate, B_w_up, B_w_down)
    return x
```

```asm
; @launch grid=(256,1,1) block=(512,1,1) lds=163840
.amdgcn_target "amdgcn-amd-amdhsa--gfx950"
.text
.globl interleave_layers__sliding_block__glu_gated_bilinear__prompt_kernel
.p2align 8
.type interleave_layers__sliding_block__glu_gated_bilinear__prompt_kernel,@function
interleave_layers__sliding_block__glu_gated_bilinear__prompt_kernel:
    s_mov_b32 s3, 0
main_body:
    s_cmp_ge_u32 s2, 256
    s_cbranch_scc1 ps_end
    s_load_dwordx16 s[4:19], s[0:1], 0
    s_load_dwordx2 s[20:21], s[0:1], 72
    s_load_dwordx2 s[98:99], s[0:1], 64
    v_lshrrev_b32 v1, 6, v0
    v_and_b32 v0, 63, v0
    v_readfirstlane_b32 s22, v1
    s_and_b32 s23, s2, 7
    s_lshr_b32 s96, s2, 3
    s_waitcnt lgkmcnt(0)
    s_mov_b32 s0, 0
    s_cmp_lg_u32 s22, 4
    s_cbranch_scc1 ps_noginit_1
    v_mov_b32 v3, 0
    v_lshlrev_b32 v4, 2, v0
    v_add_u32 v4, 159744, v4
    s_mov_b64 exec, 0xff
    ds_write_b32 v4, v3
    s_mov_b64 exec, -1
    s_waitcnt lgkmcnt(0)
ps_noginit_1:
    s_cmp_lg_u32 s22, 7
    s_cbranch_scc1 ps_nopf_2
    s_getpc_b64 s[52:53]
ps_pc_3:
    s_sub_u32 s52, s52, ps_pc_3-main_body
    s_subb_u32 s53, s53, 0
    s_mov_b32 s54, ps_code_end-main_body
    s_mov_b32 s55, 0x20000
    s_lshl_b32 s56, s96, 12
    v_lshlrev_b32 v2, 7, v0
    v_add_u32 v2, s56, v2
    s_mov_b32 exec_hi, 0
    buffer_load_dword v254, v2, s[52:55], 0 offen
    s_mov_b64 exec, -1
ps_nopf_2:
    s_barrier
    v_mov_b32 v120, 0
    s_cmp_ge_u32 s22, 4
    s_cbranch_scc1 ps_nostats_4
    s_cmp_lg_u32 s2, 0
    s_cbranch_scc1 ps_nz_5
    s_cmp_lg_u32 s22, 3
    s_cbranch_scc1 ps_nz_5
    s_memrealtime s[62:63]
    s_waitcnt lgkmcnt(0)
    s_lshr_b32 s64, s62, 28
    s_lshl_b32 s63, s63, 4
    s_or_b32 s63, s63, s64
    s_or_b32 s63, s63, 0x80000000
    s_lshl_b32 s62, s62, 4
    s_mov_b32 s48, s98
    s_mov_b32 s49, s99
    s_mov_b32 s50, 256
    s_mov_b32 s51, 0x20000
    v_mov_b32 v4, s62
    v_mov_b32 v5, s63
    v_mov_b32 v6, 0
    s_mov_b64 exec, 1
    buffer_store_dwordx2 v[4:5], v6, s[48:51], 0 offen sc1
    s_mov_b64 exec, -1
ps_nz_5:
    s_lshl_b32 s52, s23, 5
    s_add_u32 s52, s52, s96
    s_and_b32 s53, s22, 1
    s_lshl_b32 s53, s53, 13
    s_cmp_ge_u32 s22, 2
    s_cbranch_scc1 ps_wx_6
    s_mov_b32 s24, s6
    s_mov_b32 s25, s7
    s_mov_b32 s26, 2457600
    s_mov_b32 s27, 0x20000
    s_mul_i32 s52, s52, 9600
    s_branch ps_wj_7
ps_wx_6:
    s_mov_b32 s24, s4
    s_mov_b32 s25, s5
    s_mov_b32 s26, 2621440
    s_mov_b32 s27, 0x20000
    s_mul_i32 s52, s52, 10240
ps_wj_7:
    s_add_u32 s52, s52, s53
    v_lshlrev_b32 v2, 7, v0
    buffer_load_dword v253, v2, s[24:27], s52 offen
    s_mov_b32 s24, s4
    s_mov_b32 s25, s5
    s_mov_b32 s26, 2621440
    s_mov_b32 s27, 0x20000
    s_lshl_b32 s52, s23, 8
    s_lshl_b32 s53, s96, 3
    s_add_u32 s52, s52, s53
    s_lshl_b32 s53, s22, 1
    s_add_u32 s52, s52, s53
    v_lshrrev_b32 v2, 5, v0
    v_add_u32 v2, s52, v2
    v_and_b32 v3, 31, v0
    v_lshrrev_b32 v1, 2, v3
    v_lshlrev_b32 v1, 3, v1
    v_lshl_add_u32 v120, v2, 6, v1
    v_mul_u32_u24 v2, 1280, v2
    v_mul_u32_u24 v3, 40, v3
    v_add_u32 v2, v2, v3
    buffer_load_dwordx4 v[80:83], v2, s[24:27], 0 offen
    buffer_load_dwordx4 v[84:87], v2, s[24:27], 0 offen offset:16
    buffer_load_dwordx2 v[88:89], v2, s[24:27], 0 offen offset:32
ps_nostats_4:
ps_top:
    s_cmp_ge_u32 s96, 30
    s_cbranch_scc1 ps_spare_8
    s_cmp_lt_u32 s22, 4
    s_cbranch_scc1 ps_qc_9
    s_cmp_eq_u32 s22, 4
    s_cbranch_scc1 ps_qx0_10
    s_cmp_eq_u32 s22, 5
    s_cbranch_scc1 ps_qx1_11
    s_cmp_eq_u32 s22, 6
    s_cbranch_scc1 ps_qw0_12
    s_branch ps_qw1_13
ps_qc_9:
    s_and_b32 s62, s96, 1
    s_lshl_b32 s63, s23, 1
    s_add_u32 s62, s62, s63
    s_lshl_b32 s52, s62, 7
    s_lshr_b32 s61, s96, 1
    s_lshl_b32 s53, s61, 7
    s_mul_i32 s38, s3, 7864320
    s_add_u32 s38, s38, 0
    s_add_u32 s36, s20, s38
    s_addc_u32 s37, s21, 0
    s_mov_b32 s38, 7864320
    s_mov_b32 s39, 0x20000
    s_lshr_b32 s68, s22, 1
    s_and_b32 s69, s22, 1
    s_lshl_b32 s70, s68, 6
    s_add_u32 s71, s70, s52
    s_lshl_b32 s72, s69, 6
    s_add_u32 s72, s72, s53
    v_lshrrev_b32 v5, 4, v0
    s_lshr_b32 s73, s72, 2
    v_add_u32 v5, s73, v5
    v_lshlrev_b32 v5, 14, v5
    v_and_b32 v4, 15, v0
    v_add_u32 v4, s71, v4
    v_lshl_add_u32 v238, v4, 3, v5
    s_mov_b32 s74, 65536
    s_mov_b32 s75, 131072
    s_mov_b32 s76, 196608
    s_lshl_b32 s77, s68, 2
    s_lshl_b32 s62, s77, 11
    v_lshlrev_b32 v4, 4, v0
    v_add_u32 v232, s62, v4
    v_add_u32 v233, 1024, v232
    s_cmp_lg_u32 s3, 0
    s_cbranch_scc1 ps_xa_14
    v_and_b32 v2, 15, v0
    v_lshrrev_b32 v3, 4, v0
    v_and_b32 v4, 7, v2
    v_xor_b32 v4, v4, v3
    v_lshlrev_b32 v4, 4, v4
    v_lshl_add_u32 v4, v2, 7, v4
    v_add_u32 v232, s62, v4
    v_xor_b32 v233, 64, v232
ps_xa_14:
    v_lshrrev_b32 v3, 4, v0
    v_and_b32 v2, 15, v0
    v_lshrrev_b32 v4, 2, v2
    v_and_b32 v5, 1, v3
    v_lshl_add_u32 v5, v5, 2, v4
    v_lshrrev_b32 v6, 1, v3
    v_lshl_add_u32 v6, v6, 4, v5
    v_lshlrev_b32 v6, 8, v6
    v_and_b32 v2, 3, v2
    v_lshl_add_u32 v8, v2, 3, v6
    s_lshl_b32 s78, s69, 2
    s_add_u32 s78, s78, 0
    v_xor_b32 v6, s78, v5
    v_lshl_add_u32 v234, v6, 5, v8
    v_add_u32 v234, 65536, v234
    s_lshl_b32 s78, s69, 2
    s_add_u32 s78, s78, 1
    v_xor_b32 v6, s78, v5
    v_lshl_add_u32 v235, v6, 5, v8
    v_add_u32 v235, 65536, v235
    s_lshl_b32 s78, s69, 2
    s_add_u32 s78, s78, 2
    v_xor_b32 v6, s78, v5
    v_lshl_add_u32 v236, v6, 5, v8
    v_add_u32 v236, 65536, v236
    s_lshl_b32 s78, s69, 2
    s_add_u32 s78, s78, 3
    v_xor_b32 v6, s78, v5
    v_lshl_add_u32 v237, v6, 5, v8
    v_add_u32 v237, 65536, v237
    v_mov_b32 v16, 0
    v_mov_b32 v17, 0
    v_mov_b32 v18, 0
    v_mov_b32 v19, 0
    v_mov_b32 v20, 0
    v_mov_b32 v21, 0
    v_mov_b32 v22, 0
    v_mov_b32 v23, 0
    v_mov_b32 v24, 0
    v_mov_b32 v25, 0
    v_mov_b32 v26, 0
    v_mov_b32 v27, 0
    v_mov_b32 v28, 0
    v_mov_b32 v29, 0
    v_mov_b32 v30, 0
    v_mov_b32 v31, 0
    v_mov_b32 v32, 0
    v_mov_b32 v33, 0
    v_mov_b32 v34, 0
    v_mov_b32 v35, 0
    v_mov_b32 v36, 0
    v_mov_b32 v37, 0
    v_mov_b32 v38, 0
    v_mov_b32 v39, 0
    v_mov_b32 v40, 0
    v_mov_b32 v41, 0
    v_mov_b32 v42, 0
    v_mov_b32 v43, 0
    v_mov_b32 v44, 0
    v_mov_b32 v45, 0
    v_mov_b32 v46, 0
    v_mov_b32 v47, 0
    v_mov_b32 v48, 0
    v_mov_b32 v49, 0
    v_mov_b32 v50, 0
    v_mov_b32 v51, 0
    v_mov_b32 v52, 0
    v_mov_b32 v53, 0
    v_mov_b32 v54, 0
    v_mov_b32 v55, 0
    v_mov_b32 v56, 0
    v_mov_b32 v57, 0
    v_mov_b32 v58, 0
    v_mov_b32 v59, 0
    v_mov_b32 v60, 0
    v_mov_b32 v61, 0
    v_mov_b32 v62, 0
    v_mov_b32 v63, 0
    v_mov_b32 v64, 0
    v_mov_b32 v65, 0
    v_mov_b32 v66, 0
    v_mov_b32 v67, 0
    v_mov_b32 v68, 0
    v_mov_b32 v69, 0
    v_mov_b32 v70, 0
    v_mov_b32 v71, 0
    v_mov_b32 v72, 0
    v_mov_b32 v73, 0
    v_mov_b32 v74, 0
    v_mov_b32 v75, 0
    v_mov_b32 v76, 0
    v_mov_b32 v77, 0
    v_mov_b32 v78, 0
    v_mov_b32 v79, 0
    v_mov_b32 v208, 0
    v_mov_b32 v209, 0
    v_mov_b32 v210, 0
    v_mov_b32 v211, 0
    v_mov_b32 v212, 0
    v_mov_b32 v213, 0
    v_mov_b32 v214, 0
    v_mov_b32 v215, 0
    v_mov_b32 v216, 0
    v_mov_b32 v217, 0
    v_mov_b32 v218, 0
    v_mov_b32 v219, 0
    v_mov_b32 v220, 0
    v_mov_b32 v221, 0
    v_mov_b32 v222, 0
    v_mov_b32 v223, 0
    v_mov_b32 v240, 0x3f803f80
    v_mov_b32 v241, 0x3f803f80
    v_mov_b32 v242, 0x3f803f80
    v_mov_b32 v243, 0x3f803f80
    s_lshl_b32 s79, s69, 8
    s_cmp_lg_u32 s3, 0
    s_cbranch_scc1 ps_q1_15
    s_cmp_lg_u32 s22, 0
    s_cbranch_scc1 ps_nfetch_17
    s_mov_b32 s48, s98
    s_mov_b32 s49, s99
    s_mov_b32 s50, 256
    s_mov_b32 s51, 0x20000
    s_memrealtime s[62:63]
    v_mov_b32 v98, 0
    s_mov_b32 s95, 0
    s_waitcnt lgkmcnt(0)
    s_lshr_b32 s64, s62, 28
    s_lshl_b32 s63, s63, 4
    s_or_b32 s63, s63, s64
    s_and_b32 s63, s63, 0x7fffffff
    s_lshl_b32 s62, s62, 4
    s_add_u32 s62, s62, 64000
    s_addc_u32 s63, s63, 0
ps_nf_18:
    buffer_load_dwordx2 v[96:97], v98, s[48:51], 0 offen sc1
    s_waitcnt vmcnt(0)
    v_readfirstlane_b32 s60, v96
    v_readfirstlane_b32 s61, v97
    s_add_u32 s95, s95, 1
    s_nop 2
    s_bitcmp1_b32 s61, 31
    s_cbranch_scc0 ps_nag_20
    s_cmp_ge_u32 s95, 0x8000
    s_cbranch_scc1 ps_nok_19
    s_and_b32 s64, s61, 0x7fffffff
    s_sub_u32 s65, s62, s60
    s_subb_u32 s64, s63, s64
    s_cmp_lg_u32 s64, 0
    s_cbranch_scc1 ps_nag_20
    s_cmp_lt_u32 s65, 128000
    s_cbranch_scc1 ps_nok_19
ps_nag_20:
    s_cmp_lt_u32 s95, 0x40000
    s_cbranch_scc1 ps_nf_18
ps_nok_19:
    v_mov_b32 v98, 159768
    ds_write_b64 v98, v[96:97]
    s_waitcnt lgkmcnt(0)
ps_nfetch_17:
    s_add_u32 s28, s20, 42991616
    s_addc_u32 s29, s21, 0
    s_mov_b32 s30, 131072
    s_mov_b32 s31, 0x20000
    s_waitcnt vmcnt(0)
    v_lshlrev_b32 v96, 16, v80
    v_and_b32 v97, 0xffff0000, v80
    v_lshlrev_b32 v98, 16, v81
    v_and_b32 v99, 0xffff0000, v81
    v_lshlrev_b32 v100, 16, v82
    v_and_b32 v101, 0xffff0000, v82
    v_lshlrev_b32 v102, 16, v83
    v_and_b32 v103, 0xffff0000, v83
    v_lshlrev_b32 v104, 16, v84
    v_and_b32 v105, 0xffff0000, v84
    v_lshlrev_b32 v106, 16, v85
    v_and_b32 v107, 0xffff0000, v85
    v_lshlrev_b32 v108, 16, v86
    v_and_b32 v109, 0xffff0000, v86
    v_lshlrev_b32 v110, 16, v87
    v_and_b32 v111, 0xffff0000, v87
    v_lshlrev_b32 v112, 16, v88
    v_and_b32 v113, 0xffff0000, v88
    v_lshlrev_b32 v114, 16, v89
    v_and_b32 v115, 0xffff0000, v89
    v_pk_add_f32 v[122:123], v[96:97], v[98:99]
    v_pk_add_f32 v[124:125], v[100:101], v[102:103]
    v_pk_add_f32 v[122:123], v[122:123], v[104:105]
    v_pk_add_f32 v[124:125], v[124:125], v[106:107]
    v_pk_add_f32 v[122:123], v[122:123], v[108:109]
    v_pk_add_f32 v[124:125], v[124:125], v[110:111]
    v_pk_add_f32 v[122:123], v[122:123], v[112:113]
    v_pk_add_f32 v[124:125], v[124:125], v[114:115]
    v_pk_add_f32 v[122:123], v[122:123], v[124:125]
    v_add_f32 v122, v122, v123
    s_nop 1
    v_add_f32_dpp v122, v122, v122 quad_perm:[1,0,3,2] row_mask:0xf bank_mask:0xf
    s_nop 1
    v_add_f32_dpp v122, v122, v122 quad_perm:[2,3,0,1] row_mask:0xf bank_mask:0xf
    v_mul_f32 v124, 0xbc4ccccd, v122
    v_pk_add_f32 v[96:97], v[96:97], v[124:125] op_sel_hi:[1,0]
    v_pk_add_f32 v[98:99], v[98:99], v[124:125] op_sel_hi:[1,0]
    v_pk_add_f32 v[100:101], v[100:101], v[124:125] op_sel_hi:[1,0]
    v_pk_add_f32 v[102:103], v[102:103], v[124:125] op_sel_hi:[1,0]
    v_pk_add_f32 v[104:105], v[104:105], v[124:125] op_sel_hi:[1,0]
    v_pk_add_f32 v[106:107], v[106:107], v[124:125] op_sel_hi:[1,0]
    v_pk_add_f32 v[108:109], v[108:109], v[124:125] op_sel_hi:[1,0]
    v_pk_add_f32 v[110:111], v[110:111], v[124:125] op_sel_hi:[1,0]
    v_pk_add_f32 v[112:113], v[112:113], v[124:125] op_sel_hi:[1,0]
    v_pk_add_f32 v[114:115], v[114:115], v[124:125] op_sel_hi:[1,0]
    v_pk_mul_f32 v[124:125], v[96:97], v[96:97]
    v_pk_mul_f32 v[126:127], v[98:99], v[98:99]
    v_pk_fma_f32 v[124:125], v[100:101], v[100:101], v[124:125]
    v_pk_fma_f32 v[126:127], v[102:103], v[102:103], v[126:127]
    v_pk_fma_f32 v[124:125], v[104:105], v[104:105], v[124:125]
    v_pk_fma_f32 v[126:127], v[106:107], v[106:107], v[126:127]
    v_pk_fma_f32 v[124:125], v[108:109], v[108:109], v[124:125]
    v_pk_fma_f32 v[126:127], v[110:111], v[110:111], v[126:127]
    v_pk_fma_f32 v[124:125], v[112:113], v[112:113], v[124:125]
    v_pk_fma_f32 v[126:127], v[114:115], v[114:115], v[126:127]
    v_pk_add_f32 v[124:125], v[124:125], v[126:127]
    v_add_f32 v123, v124, v125
    s_nop 1
    v_add_f32_dpp v123, v123, v123 quad_perm:[1,0,3,2] row_mask:0xf bank_mask:0xf
    s_nop 1
    v_add_f32_dpp v123, v123, v123 quad_perm:[2,3,0,1] row_mask:0xf bank_mask:0xf
    s_mov_b32 exec_lo, 0x11111111
    s_mov_b32 exec_hi, 0x11111111
    buffer_store_dwordx2 v[122:123], v120, s[28:31], 0 offen sc1
    s_mov_b64 exec, -1
    s_lshl_b32 s88, s23, 5
    s_add_u32 s88, s88, s96
    s_lshl_b32 s89, s22, 8
    s_add_u32 s88, s88, s89
    s_add_u32 s88, s88, 100
    s_cmp_lt_u32 s88, 910
    s_cselect_b32 s80, 1, 0
    s_min_u32 s88, s88, 909
    s_cmp_ge_u32 s88, 640
    s_cbranch_scc1 ps_mat_25
    s_cmp_ge_u32 s88, 370
    s_cbranch_scc1 ps_mat_24
    s_cmp_ge_u32 s88, 100
    s_cbranch_scc1 ps_mat_23
ps_mat_22:
    s_mov_b32 s44, s8
    s_mov_b32 s45, s9
    s_mov_b32 s46, 819200
    s_mov_b32 s47, 0x20000
    s_sub_u32 s89, s88, 0
    s_mul_i32 s90, s89, 6554
    s_lshr_b32 s90, s90, 16
    s_mul_i32 s91, s90, 10
    s_sub_u32 s91, s89, s91
    s_mov_b32 s92, 1280
    s_mov_b32 s82, 20480
    s_mov_b32 s84, 0
    s_mov_b32 s83, -1
    s_branch ps_tgo_21
ps_mat_23:
    s_mov_b32 s44, s16
    s_mov_b32 s45, s17
    s_mov_b32 s46, 2211840
    s_mov_b32 s47, 0x20000
    s_sub_u32 s89, s88, 100
    s_mul_i32 s90, s89, 6554
    s_lshr_b32 s90, s90, 16
    s_mul_i32 s91, s90, 10
    s_sub_u32 s91, s89, s91
    s_mov_b32 s92, 1280
    s_mov_b32 s82, 55296
    s_mov_b32 s84, 819200
    s_mov_b32 s83, -1
    s_branch ps_tgo_21
ps_mat_24:
    s_mov_b32 s44, s12
    s_mov_b32 s45, s13
    s_mov_b32 s46, 2211840
    s_mov_b32 s47, 0x20000
    s_sub_u32 s89, s88, 370
    s_mul_i32 s90, s89, 2428
    s_lshr_b32 s90, s90, 16
    s_mul_i32 s91, s90, 27
    s_sub_u32 s91, s89, s91
    s_mov_b32 s92, 3456
    s_mov_b32 s82, 20480
    s_mov_b32 s84, 3031040
    s_mul_i32 s83, s90, 13824
    s_lshl_b32 s94, s91, 8
    s_add_u32 s83, s83, s94
    s_add_u32 s83, s83, 0
    s_branch ps_tgo_21
ps_mat_25:
    s_mov_b32 s44, s14
    s_mov_b32 s45, s15
    s_mov_b32 s46, 2211840
    s_mov_b32 s47, 0x20000
    s_sub_u32 s89, s88, 640
    s_mul_i32 s90, s89, 2428
    s_lshr_b32 s90, s90, 16
    s_mul_i32 s91, s90, 27
    s_sub_u32 s91, s89, s91
    s_mov_b32 s92, 3456
    s_mov_b32 s82, 20480
    s_mov_b32 s84, 5242880
    s_mul_i32 s83, s90, 13824
    s_lshl_b32 s94, s91, 8
    s_add_u32 s83, s83, s94
    s_add_u32 s83, s83, 6912
ps_tgo_21:
    s_mul_i32 s93, s90, s92
    s_lshl_b32 s93, s93, 6
    s_lshl_b32 s94, s91, 7
    s_add_u32 s93, s93, s94
    s_lshl_b32 s81, s91, 2
    s_mul_i32 s81, s81, s82
    s_lshl_b32 s94, s90, 11
    s_add_u32 s81, s81, s94
    s_add_u32 s81, s81, s84
    v_lshrrev_b32 v2, 3, v0
    v_and_b32 v3, 7, v0
    v_lshrrev_b32 v4, 1, v3
    v_lshrrev_b32 v5, 1, v2
    v_and_b32 v5, 3, v5
    v_xor_b32 v4, v4, v5
    v_and_b32 v3, 1, v3
    v_lshl_or_b32 v3, v4, 1, v3
    v_and_b32 v4, 3, v2
    v_lshrrev_b32 v5, 2, v2
    v_lshl_add_u32 v4, v5, 3, v4
    v_mul_lo_u32 v4, v4, s92
    v_lshl_add_u32 v4, v3, 4, v4
    v_mul_lo_u32 v4, v0, s92
    buffer_load_dword v253, v4, s[44:47], s93 offen
    s_barrier
    ds_read_b128 v[112:115], v232 offset:0
    ds_read_b128 v[116:119], v232 offset:2048
    ds_read_b128 v[120:123], v232 offset:4096
    ds_read_b128 v[124:127], v232 offset:6144
    ds_read_b64_tr_b16 v[80:81], v234 offset:0
    ds_read_b64_tr_b16 v[82:83], v234 offset:2048
    ds_read_b64_tr_b16 v[84:85], v235 offset:0
    ds_read_b64_tr_b16 v[86:87], v235 offset:2048
    ds_read_b64_tr_b16 v[88:89], v236 offset:0
    ds_read_b64_tr_b16 v[90:91], v236 offset:2048
    ds_read_b64_tr_b16 v[92:93], v237 offset:0
    ds_read_b64_tr_b16 v[94:95], v237 offset:2048
    s_waitcnt lgkmcnt(9)
    ds_read_b128 v[128:131], v233 offset:0
    ds_read_b128 v[132:135], v233 offset:2048
    ds_read_b128 v[136:139], v233 offset:4096
    ds_read_b128 v[140:143], v233 offset:6144
    s_waitcnt lgkmcnt(9)
    ds_read_b64_tr_b16 v[96:97], v234 offset:8192
    ds_read_b64_tr_b16 v[98:99], v234 offset:10240
    ds_read_b64_tr_b16 v[100:101], v235 offset:8192
    ds_read_b64_tr_b16 v[102:103], v235 offset:10240
    s_waitcnt lgkmcnt(9)
    ds_read_b64_tr_b16 v[104:105], v236 offset:8192
    ds_read_b64_tr_b16 v[106:107], v236 offset:10240
    ds_read_b64_tr_b16 v[108:109], v237 offset:8192
    ds_read_b64_tr_b16 v[110:111], v237 offset:10240
    s_waitcnt vmcnt(1)
    v_mov_b32 v2, 159768
    ds_read_b64 v[2:3], v2
    v_mov_b32 v4, 159744
    v_mov_b32 v5, 3
    s_mov_b64 exec, 1
    ds_inc_rtn_u32 v6, v4, v5
    s_waitcnt lgkmcnt(0)
    v_readfirstlane_b32 s61, v6
    s_mov_b64 exec, -1
    s_nop 2
    s_cmp_lg_u32 s61, 3
    s_cbranch_scc1 ps_stj_26
    s_add_u32 s48, s20, 51134464
    s_addc_u32 s49, s21, 0
    s_mov_b32 s50, 65536
    s_mov_b32 s51, 0x20000
    s_lshl_b32 s62, s23, 12
    s_lshl_b32 s63, s96, 7
    s_add_u32 s62, s62, s63
    v_mov_b32 v6, s62
    s_getreg_b32 s63, hwreg(HW_REG_XCC_ID)
    s_and_b32 s63, s63, 15
    v_add_u32 v2, 1, v2
    v_mov_b32 v4, s63
    v_mov_b32 v5, 0
    s_mov_b64 exec, 1
    buffer_store_dwordx4 v[2:5], v6, s[48:51], 0 offen sc1
    s_mov_b64 exec, -1
ps_stj_26:
    s_mov_b32 s57, 2
ps_fs_27:
    s_waitcnt lgkmcnt(0)
    s_barrier
    v_mfma_f32_16x16x32_bf16 v[16:19], v[80:83], v[112:115], v[16:19]
    ds_read_b128 v[176:179], v232 offset:16384
    v_mfma_f32_16x16x32_bf16 v[20:23], v[80:83], v[116:119], v[20:23]
    ds_read_b128 v[180:183], v232 offset:18432
    v_mfma_f32_16x16x32_bf16 v[24:27], v[80:83], v[120:123], v[24:27]
    ds_read_b128 v[184:187], v232 offset:20480
    v_mfma_f32_16x16x32_bf16 v[28:31], v[80:83], v[124:127], v[28:31]
    ds_read_b128 v[188:191], v232 offset:22528
    v_mfma_f32_16x16x32_bf16 v[208:211], v[80:83], v[240:243], v[208:211]
    v_mfma_f32_16x16x32_bf16 v[32:35], v[84:87], v[112:115], v[32:35]
    ds_read_b64_tr_b16 v[144:145], v234 offset:16384
    v_mfma_f32_16x16x32_bf16 v[36:39], v[84:87], v[116:119], v[36:39]
    ds_read_b64_tr_b16 v[146:147], v234 offset:18432
    v_mfma_f32_16x16x32_bf16 v[40:43], v[84:87], v[120:123], v[40:43]
    ds_read_b64_tr_b16 v[148:149], v235 offset:16384
    v_mfma_f32_16x16x32_bf16 v[44:47], v[84:87], v[124:127], v[44:47]
    ds_read_b64_tr_b16 v[150:151], v235 offset:18432
    v_mfma_f32_16x16x32_bf16 v[212:215], v[84:87], v[240:243], v[212:215]
    v_mfma_f32_16x16x32_bf16 v[48:51], v[88:91], v[112:115], v[48:51]
    ds_read_b64_tr_b16 v[152:153], v236 offset:16384
    v_mfma_f32_16x16x32_bf16 v[52:55], v[88:91], v[116:119], v[52:55]
    ds_read_b64_tr_b16 v[154:155], v236 offset:18432
    v_mfma_f32_16x16x32_bf16 v[56:59], v[88:91], v[120:123], v[56:59]
    ds_read_b64_tr_b16 v[156:157], v237 offset:16384
    v_mfma_f32_16x16x32_bf16 v[60:63], v[88:91], v[124:127], v[60:63]
    ds_read_b64_tr_b16 v[158:159], v237 offset:18432
    s_waitcnt lgkmcnt(9)
    v_mfma_f32_16x16x32_bf16 v[216:219], v[88:91], v[240:243], v[216:219]
    v_mfma_f32_16x16x32_bf16 v[64:67], v[92:95], v[112:115], v[64:67]
    ds_read_b128 v[192:195], v233 offset:16384
    v_mfma_f32_16x16x32_bf16 v[68:71], v[92:95], v[116:119], v[68:71]
    ds_read_b128 v[196:199], v233 offset:18432
    v_mfma_f32_16x16x32_bf16 v[72:75], v[92:95], v[120:123], v[72:75]
    ds_read_b128 v[200:203], v233 offset:20480
    v_mfma_f32_16x16x32_bf16 v[76:79], v[92:95], v[124:127], v[76:79]
    ds_read_b128 v[204:207], v233 offset:22528
    s_waitcnt lgkmcnt(9)
    v_mfma_f32_16x16x32_bf16 v[220:223], v[92:95], v[240:243], v[220:223]
    v_mfma_f32_16x16x32_bf16 v[16:19], v[96:99], v[128:131], v[16:19]
    ds_read_b64_tr_b16 v[160:161], v234 offset:24576
    v_mfma_f32_16x16x32_bf16 v[20:23], v[96:99], v[132:135], v[20:23]
    ds_read_b64_tr_b16 v[162:163], v234 offset:26624
    v_mfma_f32_16x16x32_bf16 v[24:27], v[96:99], v[136:139], v[24:27]
    ds_read_b64_tr_b16 v[164:165], v235 offset:24576
    v_mfma_f32_16x16x32_bf16 v[28:31], v[96:99], v[140:143], v[28:31]
    ds_read_b64_tr_b16 v[166:167], v235 offset:26624
    s_waitcnt lgkmcnt(9)
    v_mfma_f32_16x16x32_bf16 v[208:211], v[96:99], v[240:243], v[208:211]
    v_mfma_f32_16x16x32_bf16 v[32:35], v[100:103], v[128:131], v[32:35]
    ds_read_b64_tr_b16 v[168:169], v236 offset:24576
    v_mfma_f32_16x16x32_bf16 v[36:39], v[100:103], v[132:135], v[36:39]
    ds_read_b64_tr_b16 v[170:171], v236 offset:26624
    v_mfma_f32_16x16x32_bf16 v[40:43], v[100:103], v[136:139], v[40:43]
    ds_read_b64_tr_b16 v[172:173], v237 offset:24576
    v_mfma_f32_16x16x32_bf16 v[44:47], v[100:103], v[140:143], v[44:47]
    ds_read_b64_tr_b16 v[174:175], v237 offset:26624
    v_mfma_f32_16x16x32_bf16 v[212:215], v[100:103], v[240:243], v[212:215]
    v_mfma_f32_16x16x32_bf16 v[48:51], v[104:107], v[128:131], v[48:51]
    v_mfma_f32_16x16x32_bf16 v[52:55], v[104:107], v[132:135], v[52:55]
    v_mfma_f32_16x16x32_bf16 v[56:59], v[104:107], v[136:139], v[56:59]
    v_mfma_f32_16x16x32_bf16 v[60:63], v[104:107], v[140:143], v[60:63]
    v_mfma_f32_16x16x32_bf16 v[216:219], v[104:107], v[240:243], v[216:219]
    v_mfma_f32_16x16x32_bf16 v[64:67], v[108:111], v[128:131], v[64:67]
    v_mfma_f32_16x16x32_bf16 v[68:71], v[108:111], v[132:135], v[68:71]
    v_mfma_f32_16x16x32_bf16 v[72:75], v[108:111], v[136:139], v[72:75]
    v_mfma_f32_16x16x32_bf16 v[76:79], v[108:111], v[140:143], v[76:79]
    v_mfma_f32_16x16x32_bf16 v[220:223], v[108:111], v[240:243], v[220:223]
    s_waitcnt lgkmcnt(0)
    s_barrier
    v_mfma_f32_16x16x32_bf16 v[16:19], v[144:147], v[176:179], v[16:19]
    ds_read_b128 v[112:115], v232 offset:32768
    v_mfma_f32_16x16x32_bf16 v[20:23], v[144:147], v[180:183], v[20:23]
    ds_read_b128 v[116:119], v232 offset:34816
    v_mfma_f32_16x16x32_bf16 v[24:27], v[144:147], v[184:187], v[24:27]
    ds_read_b128 v[120:123], v232 offset:36864
    v_mfma_f32_16x16x32_bf16 v[28:31], v[144:147], v[188:191], v[28:31]
    ds_read_b128 v[124:127], v232 offset:38912
    v_mfma_f32_16x16x32_bf16 v[208:211], v[144:147], v[240:243], v[208:211]
    v_mfma_f32_16x16x32_bf16 v[32:35], v[148:151], v[176:179], v[32:35]
    ds_read_b64_tr_b16 v[80:81], v234 offset:32768
    v_mfma_f32_16x16x32_bf16 v[36:39], v[148:151], v[180:183], v[36:39]
    ds_read_b64_tr_b16 v[82:83], v234 offset:34816
    v_mfma_f32_16x16x32_bf16 v[40:43], v[148:151], v[184:187], v[40:43]
    ds_read_b64_tr_b16 v[84:85], v235 offset:32768
    v_mfma_f32_16x16x32_bf16 v[44:47], v[148:151], v[188:191], v[44:47]
    ds_read_b64_tr_b16 v[86:87], v235 offset:34816
    v_mfma_f32_16x16x32_bf16 v[212:215], v[148:151], v[240:243], v[212:215]
    v_mfma_f32_16x16x32_bf16 v[48:51], v[152:155], v[176:179], v[48:51]
    ds_read_b64_tr_b16 v[88:89], v236 offset:32768
    v_mfma_f32_16x16x32_bf16 v[52:55], v[152:155], v[180:183], v[52:55]
    ds_read_b64_tr_b16 v[90:91], v236 offset:34816
    v_mfma_f32_16x16x32_bf16 v[56:59], v[152:155], v[184:187], v[56:59]
    ds_read_b64_tr_b16 v[92:93], v237 offset:32768
    v_mfma_f32_16x16x32_bf16 v[60:63], v[152:155], v[188:191], v[60:63]
    ds_read_b64_tr_b16 v[94:95], v237 offset:34816
    s_waitcnt lgkmcnt(9)
    v_mfma_f32_16x16x32_bf16 v[216:219], v[152:155], v[240:243], v[216:219]
    v_mfma_f32_16x16x32_bf16 v[64:67], v[156:159], v[176:179], v[64:67]
    ds_read_b128 v[128:131], v233 offset:32768
    v_mfma_f32_16x16x32_bf16 v[68:71], v[156:159], v[180:183], v[68:71]
    ds_read_b128 v[132:135], v233 offset:34816
    v_mfma_f32_16x16x32_bf16 v[72:75], v[156:159], v[184:187], v[72:75]
    ds_read_b128 v[136:139], v233 offset:36864
    v_mfma_f32_16x16x32_bf16 v[76:79], v[156:159], v[188:191], v[76:79]
    ds_read_b128 v[140:143], v233 offset:38912
    s_waitcnt lgkmcnt(9)
    v_mfma_f32_16x16x32_bf16 v[220:223], v[156:159], v[240:243], v[220:223]
    v_mfma_f32_16x16x32_bf16 v[16:19], v[160:163], v[192:195], v[16:19]
    ds_read_b64_tr_b16 v[96:97], v234 offset:40960
    v_mfma_f32_16x16x32_bf16 v[20:23], v[160:163], v[196:199], v[20:23]
    ds_read_b64_tr_b16 v[98:99], v234 offset:43008
    v_mfma_f32_16x16x32_bf16 v[24:27], v[160:163], v[200:203], v[24:27]
    ds_read_b64_tr_b16 v[100:101], v235 offset:40960
    v_mfma_f32_16x16x32_bf16 v[28:31], v[160:163], v[204:207], v[28:31]
    ds_read_b64_tr_b16 v[102:103], v235 offset:43008
    s_waitcnt lgkmcnt(9)
    v_mfma_f32_16x16x32_bf16 v[208:211], v[160:163], v[240:243], v[208:211]
    v_mfma_f32_16x16x32_bf16 v[32:35], v[164:167], v[192:195], v[32:35]
    ds_read_b64_tr_b16 v[104:105], v236 offset:40960
    v_mfma_f32_16x16x32_bf16 v[36:39], v[164:167], v[196:199], v[36:39]
    ds_read_b64_tr_b16 v[106:107], v236 offset:43008
    v_mfma_f32_16x16x32_bf16 v[40:43], v[164:167], v[200:203], v[40:43]
    ds_read_b64_tr_b16 v[108:109], v237 offset:40960
    v_mfma_f32_16x16x32_bf16 v[44:47], v[164:167], v[204:207], v[44:47]
    ds_read_b64_tr_b16 v[110:111], v237 offset:43008
    v_mfma_f32_16x16x32_bf16 v[212:215], v[164:167], v[240:243], v[212:215]
    v_mfma_f32_16x16x32_bf16 v[48:51], v[168:171], v[192:195], v[48:51]
    v_mfma_f32_16x16x32_bf16 v[52:55], v[168:171], v[196:199], v[52:55]
    v_mfma_f32_16x16x32_bf16 v[56:59], v[168:171], v[200:203], v[56:59]
    v_mfma_f32_16x16x32_bf16 v[60:63], v[168:171], v[204:207], v[60:63]
    v_mfma_f32_16x16x32_bf16 v[216:219], v[168:171], v[240:243], v[216:219]
    v_mfma_f32_16x16x32_bf16 v[64:67], v[172:175], v[192:195], v[64:67]
    v_mfma_f32_16x16x32_bf16 v[68:71], v[172:175], v[196:199], v[68:71]
    v_mfma_f32_16x16x32_bf16 v[72:75], v[172:175], v[200:203], v[72:75]
    v_mfma_f32_16x16x32_bf16 v[76:79], v[172:175], v[204:207], v[76:79]
    v_mfma_f32_16x16x32_bf16 v[220:223], v[172:175], v[240:243], v[220:223]
    s_waitcnt lgkmcnt(0)
    s_barrier
    v_mfma_f32_16x16x32_bf16 v[16:19], v[80:83], v[112:115], v[16:19]
    ds_read_b128 v[176:179], v232 offset:49152
    v_mfma_f32_16x16x32_bf16 v[20:23], v[80:83], v[116:119], v[20:23]
    ds_read_b128 v[180:183], v232 offset:51200
    v_mfma_f32_16x16x32_bf16 v[24:27], v[80:83], v[120:123], v[24:27]
    ds_read_b128 v[184:187], v232 offset:53248
    v_mfma_f32_16x16x32_bf16 v[28:31], v[80:83], v[124:127], v[28:31]
    ds_read_b128 v[188:191], v232 offset:55296
    v_mfma_f32_16x16x32_bf16 v[208:211], v[80:83], v[240:243], v[208:211]
    v_mfma_f32_16x16x32_bf16 v[32:35], v[84:87], v[112:115], v[32:35]
    ds_read_b64_tr_b16 v[144:145], v234 offset:49152
    v_mfma_f32_16x16x32_bf16 v[36:39], v[84:87], v[116:119], v[36:39]
    ds_read_b64_tr_b16 v[146:147], v234 offset:51200
    v_mfma_f32_16x16x32_bf16 v[40:43], v[84:87], v[120:123], v[40:43]
    ds_read_b64_tr_b16 v[148:149], v235 offset:49152
    v_mfma_f32_16x16x32_bf16 v[44:47], v[84:87], v[124:127], v[44:47]
    ds_read_b64_tr_b16 v[150:151], v235 offset:51200
    v_mfma_f32_16x16x32_bf16 v[212:215], v[84:87], v[240:243], v[212:215]
    v_mfma_f32_16x16x32_bf16 v[48:51], v[88:91], v[112:115], v[48:51]
    ds_read_b64_tr_b16 v[152:153], v236 offset:49152
    v_mfma_f32_16x16x32_bf16 v[52:55], v[88:91], v[116:119], v[52:55]
    ds_read_b64_tr_b16 v[154:155], v236 offset:51200
    v_mfma_f32_16x16x32_bf16 v[56:59], v[88:91], v[120:123], v[56:59]
    ds_read_b64_tr_b16 v[156:157], v237 offset:49152
    v_mfma_f32_16x16x32_bf16 v[60:63], v[88:91], v[124:127], v[60:63]
    ds_read_b64_tr_b16 v[158:159], v237 offset:51200
    s_waitcnt lgkmcnt(9)
    v_mfma_f32_16x16x32_bf16 v[216:219], v[88:91], v[240:243], v[216:219]
    v_mfma_f32_16x16x32_bf16 v[64:67], v[92:95], v[112:115], v[64:67]
    ds_read_b128 v[192:195], v233 offset:49152
    v_mfma_f32_16x16x32_bf16 v[68:71], v[92:95], v[116:119], v[68:71]
    ds_read_b128 v[196:199], v233 offset:51200
    v_mfma_f32_16x16x32_bf16 v[72:75], v[92:95], v[120:123], v[72:75]
    ds_read_b128 v[200:203], v233 offset:53248
    v_mfma_f32_16x16x32_bf16 v[76:79], v[92:95], v[124:127], v[76:79]
    ds_read_b128 v[204:207], v233 offset:55296
    s_waitcnt lgkmcnt(9)
    v_mfma_f32_16x16x32_bf16 v[220:223], v[92:95], v[240:243], v[220:223]
    v_mfma_f32_16x16x32_bf16 v[16:19], v[96:99], v[128:131], v[16:19]
    ds_read_b64_tr_b16 v[160:161], v234 offset:57344
    v_mfma_f32_16x16x32_bf16 v[20:23], v[96:99], v[132:135], v[20:23]
    ds_read_b64_tr_b16 v[162:163], v234 offset:59392
    v_mfma_f32_16x16x32_bf16 v[24:27], v[96:99], v[136:139], v[24:27]
    ds_read_b64_tr_b16 v[164:165], v235 offset:57344
    v_mfma_f32_16x16x32_bf16 v[28:31], v[96:99], v[140:143], v[28:31]
    ds_read_b64_tr_b16 v[166:167], v235 offset:59392
    s_waitcnt lgkmcnt(9)
    v_mfma_f32_16x16x32_bf16 v[208:211], v[96:99], v[240:243], v[208:211]
    v_mfma_f32_16x16x32_bf16 v[32:35], v[100:103], v[128:131], v[32:35]
    ds_read_b64_tr_b16 v[168:169], v236 offset:57344
    v_mfma_f32_16x16x32_bf16 v[36:39], v[100:103], v[132:135], v[36:39]
    ds_read_b64_tr_b16 v[170:171], v236 offset:59392
    v_mfma_f32_16x16x32_bf16 v[40:43], v[100:103], v[136:139], v[40:43]
    ds_read_b64_tr_b16 v[172:173], v237 offset:57344
    v_mfma_f32_16x16x32_bf16 v[44:47], v[100:103], v[140:143], v[44:47]
    ds_read_b64_tr_b16 v[174:175], v237 offset:59392
    v_mfma_f32_16x16x32_bf16 v[212:215], v[100:103], v[240:243], v[212:215]
    v_mfma_f32_16x16x32_bf16 v[48:51], v[104:107], v[128:131], v[48:51]
    v_mfma_f32_16x16x32_bf16 v[52:55], v[104:107], v[132:135], v[52:55]
    v_mfma_f32_16x16x32_bf16 v[56:59], v[104:107], v[136:139], v[56:59]
    v_mfma_f32_16x16x32_bf16 v[60:63], v[104:107], v[140:143], v[60:63]
    v_mfma_f32_16x16x32_bf16 v[216:219], v[104:107], v[240:243], v[216:219]
    v_mfma_f32_16x16x32_bf16 v[64:67], v[108:111], v[128:131], v[64:67]
    v_mfma_f32_16x16x32_bf16 v[68:71], v[108:111], v[132:135], v[68:71]
    v_mfma_f32_16x16x32_bf16 v[72:75], v[108:111], v[136:139], v[72:75]
    v_mfma_f32_16x16x32_bf16 v[76:79], v[108:111], v[140:143], v[76:79]
    v_mfma_f32_16x16x32_bf16 v[220:223], v[108:111], v[240:243], v[220:223]
    s_waitcnt lgkmcnt(0)
    s_barrier
    v_mfma_f32_16x16x32_bf16 v[16:19], v[144:147], v[176:179], v[16:19]
    ds_read_b128 v[112:115], v232 offset:0
    v_mfma_f32_16x16x32_bf16 v[20:23], v[144:147], v[180:183], v[20:23]
    ds_read_b128 v[116:119], v232 offset:2048
    v_mfma_f32_16x16x32_bf16 v[24:27], v[144:147], v[184:187], v[24:27]
    ds_read_b128 v[120:123], v232 offset:4096
    v_mfma_f32_16x16x32_bf16 v[28:31], v[144:147], v[188:191], v[28:31]
    ds_read_b128 v[124:127], v232 offset:6144
    v_mfma_f32_16x16x32_bf16 v[208:211], v[144:147], v[240:243], v[208:211]
    v_mfma_f32_16x16x32_bf16 v[32:35], v[148:151], v[176:179], v[32:35]
    ds_read_b64_tr_b16 v[80:81], v234 offset:0
    v_mfma_f32_16x16x32_bf16 v[36:39], v[148:151], v[180:183], v[36:39]
    ds_read_b64_tr_b16 v[82:83], v234 offset:2048
    v_mfma_f32_16x16x32_bf16 v[40:43], v[148:151], v[184:187], v[40:43]
    ds_read_b64_tr_b16 v[84:85], v235 offset:0
    v_mfma_f32_16x16x32_bf16 v[44:47], v[148:151], v[188:191], v[44:47]
    ds_read_b64_tr_b16 v[86:87], v235 offset:2048
    v_mfma_f32_16x16x32_bf16 v[212:215], v[148:151], v[240:243], v[212:215]
    v_mfma_f32_16x16x32_bf16 v[48:51], v[152:155], v[176:179], v[48:51]
    ds_read_b64_tr_b16 v[88:89], v236 offset:0
    v_mfma_f32_16x16x32_bf16 v[52:55], v[152:155], v[180:183], v[52:55]
    ds_read_b64_tr_b16 v[90:91], v236 offset:2048
    v_mfma_f32_16x16x32_bf16 v[56:59], v[152:155], v[184:187], v[56:59]
    ds_read_b64_tr_b16 v[92:93], v237 offset:0
    v_mfma_f32_16x16x32_bf16 v[60:63], v[152:155], v[188:191], v[60:63]
    ds_read_b64_tr_b16 v[94:95], v237 offset:2048
    s_waitcnt lgkmcnt(9)
    v_mfma_f32_16x16x32_bf16 v[216:219], v[152:155], v[240:243], v[216:219]
    v_mfma_f32_16x16x32_bf16 v[64:67], v[156:159], v[176:179], v[64:67]
    ds_read_b128 v[128:131], v233 offset:0
    v_mfma_f32_16x16x32_bf16 v[68:71], v[156:159], v[180:183], v[68:71]
    ds_read_b128 v[132:135], v233 offset:2048
    v_mfma_f32_16x16x32_bf16 v[72:75], v[156:159], v[184:187], v[72:75]
    ds_read_b128 v[136:139], v233 offset:4096
    v_mfma_f32_16x16x32_bf16 v[76:79], v[156:159], v[188:191], v[76:79]
    ds_read_b128 v[140:143], v233 offset:6144
    s_waitcnt lgkmcnt(9)
    v_mfma_f32_16x16x32_bf16 v[220:223], v[156:159], v[240:243], v[220:223]
    v_mfma_f32_16x16x32_bf16 v[16:19], v[160:163], v[192:195], v[16:19]
    ds_read_b64_tr_b16 v[96:97], v234 offset:8192
    v_mfma_f32_16x16x32_bf16 v[20:23], v[160:163], v[196:199], v[20:23]
    ds_read_b64_tr_b16 v[98:99], v234 offset:10240
    v_mfma_f32_16x16x32_bf16 v[24:27], v[160:163], v[200:203], v[24:27]
    ds_read_b64_tr_b16 v[100:101], v235 offset:8192
    v_mfma_f32_16x16x32_bf16 v[28:31], v[160:163], v[204:207], v[28:31]
    ds_read_b64_tr_b16 v[102:103], v235 offset:10240
    s_waitcnt lgkmcnt(9)
    v_mfma_f32_16x16x32_bf16 v[208:211], v[160:163], v[240:243], v[208:211]
    v_mfma_f32_16x16x32_bf16 v[32:35], v[164:167], v[192:195], v[32:35]
    ds_read_b64_tr_b16 v[104:105], v236 offset:8192
    v_mfma_f32_16x16x32_bf16 v[36:39], v[164:167], v[196:199], v[36:39]
    ds_read_b64_tr_b16 v[106:107], v236 offset:10240
    v_mfma_f32_16x16x32_bf16 v[40:43], v[164:167], v[200:203], v[40:43]
    ds_read_b64_tr_b16 v[108:109], v237 offset:8192
    v_mfma_f32_16x16x32_bf16 v[44:47], v[164:167], v[204:207], v[44:47]
    ds_read_b64_tr_b16 v[110:111], v237 offset:10240
    v_mfma_f32_16x16x32_bf16 v[212:215], v[164:167], v[240:243], v[212:215]
    v_mfma_f32_16x16x32_bf16 v[48:51], v[168:171], v[192:195], v[48:51]
    v_mfma_f32_16x16x32_bf16 v[52:55], v[168:171], v[196:199], v[52:55]
    v_mfma_f32_16x16x32_bf16 v[56:59], v[168:171], v[200:203], v[56:59]
    v_mfma_f32_16x16x32_bf16 v[60:63], v[168:171], v[204:207], v[60:63]
    v_mfma_f32_16x16x32_bf16 v[216:219], v[168:171], v[240:243], v[216:219]
    v_mfma_f32_16x16x32_bf16 v[64:67], v[172:175], v[192:195], v[64:67]
    v_mfma_f32_16x16x32_bf16 v[68:71], v[172:175], v[196:199], v[68:71]
    v_mfma_f32_16x16x32_bf16 v[72:75], v[172:175], v[200:203], v[72:75]
    v_mfma_f32_16x16x32_bf16 v[76:79], v[172:175], v[204:207], v[76:79]
    v_mfma_f32_16x16x32_bf16 v[220:223], v[172:175], v[240:243], v[220:223]
    s_sub_u32 s57, s57, 1
    s_cmp_lg_u32 s57, 0
    s_cbranch_scc1 ps_fs_27
    s_waitcnt lgkmcnt(0)
    s_barrier
    v_mfma_f32_16x16x32_bf16 v[16:19], v[80:83], v[112:115], v[16:19]
    ds_read_b128 v[176:179], v232 offset:16384
    v_mfma_f32_16x16x32_bf16 v[20:23], v[80:83], v[116:119], v[20:23]
    ds_read_b128 v[180:183], v232 offset:18432
    v_mfma_f32_16x16x32_bf16 v[24:27], v[80:83], v[120:123], v[24:27]
    ds_read_b128 v[184:187], v232 offset:20480
    v_mfma_f32_16x16x32_bf16 v[28:31], v[80:83], v[124:127], v[28:31]
    ds_read_b128 v[188:191], v232 offset:22528
    v_mfma_f32_16x16x32_bf16 v[208:211], v[80:83], v[240:243], v[208:211]
    v_mfma_f32_16x16x32_bf16 v[32:35], v[84:87], v[112:115], v[32:35]
    ds_read_b64_tr_b16 v[144:145], v234 offset:16384
    v_mfma_f32_16x16x32_bf16 v[36:39], v[84:87], v[116:119], v[36:39]
    ds_read_b64_tr_b16 v[146:147], v234 offset:18432
    v_mfma_f32_16x16x32_bf16 v[40:43], v[84:87], v[120:123], v[40:43]
    ds_read_b64_tr_b16 v[148:149], v235 offset:16384
    v_mfma_f32_16x16x32_bf16 v[44:47], v[84:87], v[124:127], v[44:47]
    ds_read_b64_tr_b16 v[150:151], v235 offset:18432
    v_mfma_f32_16x16x32_bf16 v[212:215], v[84:87], v[240:243], v[212:215]
    v_mfma_f32_16x16x32_bf16 v[48:51], v[88:91], v[112:115], v[48:51]
    ds_read_b64_tr_b16 v[152:153], v236 offset:16384
    v_mfma_f32_16x16x32_bf16 v[52:55], v[88:91], v[116:119], v[52:55]
    ds_read_b64_tr_b16 v[154:155], v236 offset:18432
    v_mfma_f32_16x16x32_bf16 v[56:59], v[88:91], v[120:123], v[56:59]
    ds_read_b64_tr_b16 v[156:157], v237 offset:16384
    v_mfma_f32_16x16x32_bf16 v[60:63], v[88:91], v[124:127], v[60:63]
    ds_read_b64_tr_b16 v[158:159], v237 offset:18432
    s_waitcnt lgkmcnt(9)
    v_mfma_f32_16x16x32_bf16 v[216:219], v[88:91], v[240:243], v[216:219]
    v_mfma_f32_16x16x32_bf16 v[64:67], v[92:95], v[112:115], v[64:67]
    ds_read_b128 v[192:195], v233 offset:16384
    v_mfma_f32_16x16x32_bf16 v[68:71], v[92:95], v[116:119], v[68:71]
    ds_read_b128 v[196:199], v233 offset:18432
    v_mfma_f32_16x16x32_bf16 v[72:75], v[92:95], v[120:123], v[72:75]
    ds_read_b128 v[200:203], v233 offset:20480
    v_mfma_f32_16x16x32_bf16 v[76:79], v[92:95], v[124:127], v[76:79]
    ds_read_b128 v[204:207], v233 offset:22528
    s_waitcnt lgkmcnt(9)
    v_mfma_f32_16x16x32_bf16 v[220:223], v[92:95], v[240:243], v[220:223]
    v_mfma_f32_16x16x32_bf16 v[16:19], v[96:99], v[128:131], v[16:19]
    ds_read_b64_tr_b16 v[160:161], v234 offset:24576
    v_mfma_f32_16x16x32_bf16 v[20:23], v[96:99], v[132:135], v[20:23]
    ds_read_b64_tr_b16 v[162:163], v234 offset:26624
    v_mfma_f32_16x16x32_bf16 v[24:27], v[96:99], v[136:139], v[24:27]
    ds_read_b64_tr_b16 v[164:165], v235 offset:24576
    v_mfma_f32_16x16x32_bf16 v[28:31], v[96:99], v[140:143], v[28:31]
    ds_read_b64_tr_b16 v[166:167], v235 offset:26624
    s_waitcnt lgkmcnt(9)
    v_mfma_f32_16x16x32_bf16 v[208:211], v[96:99], v[240:243], v[208:211]
    v_mfma_f32_16x16x32_bf16 v[32:35], v[100:103], v[128:131], v[32:35]
    ds_read_b64_tr_b16 v[168:169], v236 offset:24576
    v_mfma_f32_16x16x32_bf16 v[36:39], v[100:103], v[132:135], v[36:39]
    ds_read_b64_tr_b16 v[170:171], v236 offset:26624
    v_mfma_f32_16x16x32_bf16 v[40:43], v[100:103], v[136:139], v[40:43]
    ds_read_b64_tr_b16 v[172:173], v237 offset:24576
    v_mfma_f32_16x16x32_bf16 v[44:47], v[100:103], v[140:143], v[44:47]
    ds_read_b64_tr_b16 v[174:175], v237 offset:26624
    v_mfma_f32_16x16x32_bf16 v[212:215], v[100:103], v[240:243], v[212:215]
    v_mfma_f32_16x16x32_bf16 v[48:51], v[104:107], v[128:131], v[48:51]
    v_mfma_f32_16x16x32_bf16 v[52:55], v[104:107], v[132:135], v[52:55]
    v_mfma_f32_16x16x32_bf16 v[56:59], v[104:107], v[136:139], v[56:59]
    v_mfma_f32_16x16x32_bf16 v[60:63], v[104:107], v[140:143], v[60:63]
    v_mfma_f32_16x16x32_bf16 v[216:219], v[104:107], v[240:243], v[216:219]
    v_mfma_f32_16x16x32_bf16 v[64:67], v[108:111], v[128:131], v[64:67]
    v_mfma_f32_16x16x32_bf16 v[68:71], v[108:111], v[132:135], v[68:71]
    v_mfma_f32_16x16x32_bf16 v[72:75], v[108:111], v[136:139], v[72:75]
    v_mfma_f32_16x16x32_bf16 v[76:79], v[108:111], v[140:143], v[76:79]
    v_mfma_f32_16x16x32_bf16 v[220:223], v[108:111], v[240:243], v[220:223]
    s_waitcnt lgkmcnt(0)
    s_barrier
    v_mfma_f32_16x16x32_bf16 v[16:19], v[144:147], v[176:179], v[16:19]
    v_mfma_f32_16x16x32_bf16 v[20:23], v[144:147], v[180:183], v[20:23]
    v_mfma_f32_16x16x32_bf16 v[24:27], v[144:147], v[184:187], v[24:27]
    v_mfma_f32_16x16x32_bf16 v[28:31], v[144:147], v[188:191], v[28:31]
    v_mfma_f32_16x16x32_bf16 v[208:211], v[144:147], v[240:243], v[208:211]
    v_mfma_f32_16x16x32_bf16 v[32:35], v[148:151], v[176:179], v[32:35]
    v_mfma_f32_16x16x32_bf16 v[36:39], v[148:151], v[180:183], v[36:39]
    v_mfma_f32_16x16x32_bf16 v[40:43], v[148:151], v[184:187], v[40:43]
    v_mfma_f32_16x16x32_bf16 v[44:47], v[148:151], v[188:191], v[44:47]
    v_mfma_f32_16x16x32_bf16 v[212:215], v[148:151], v[240:243], v[212:215]
    v_mfma_f32_16x16x32_bf16 v[48:51], v[152:155], v[176:179], v[48:51]
    v_mfma_f32_16x16x32_bf16 v[52:55], v[152:155], v[180:183], v[52:55]
    v_mfma_f32_16x16x32_bf16 v[56:59], v[152:155], v[184:187], v[56:59]
    v_mfma_f32_16x16x32_bf16 v[60:63], v[152:155], v[188:191], v[60:63]
    v_mfma_f32_16x16x32_bf16 v[216:219], v[152:155], v[240:243], v[216:219]
    v_mfma_f32_16x16x32_bf16 v[64:67], v[156:159], v[176:179], v[64:67]
    v_mfma_f32_16x16x32_bf16 v[68:71], v[156:159], v[180:183], v[68:71]
    v_mfma_f32_16x16x32_bf16 v[72:75], v[156:159], v[184:187], v[72:75]
    v_mfma_f32_16x16x32_bf16 v[76:79], v[156:159], v[188:191], v[76:79]
    v_mfma_f32_16x16x32_bf16 v[220:223], v[156:159], v[240:243], v[220:223]
    v_mfma_f32_16x16x32_bf16 v[16:19], v[160:163], v[192:195], v[16:19]
    v_mfma_f32_16x16x32_bf16 v[20:23], v[160:163], v[196:199], v[20:23]
    v_mfma_f32_16x16x32_bf16 v[24:27], v[160:163], v[200:203], v[24:27]
    v_mfma_f32_16x16x32_bf16 v[28:31], v[160:163], v[204:207], v[28:31]
    v_mfma_f32_16x16x32_bf16 v[208:211], v[160:163], v[240:243], v[208:211]
    v_mfma_f32_16x16x32_bf16 v[32:35], v[164:167], v[192:195], v[32:35]
    v_mfma_f32_16x16x32_bf16 v[36:39], v[164:167], v[196:199], v[36:39]
    v_mfma_f32_16x16x32_bf16 v[40:43], v[164:167], v[200:203], v[40:43]
    v_mfma_f32_16x16x32_bf16 v[44:47], v[164:167], v[204:207], v[44:47]
    v_mfma_f32_16x16x32_bf16 v[212:215], v[164:167], v[240:243], v[212:215]
    v_mfma_f32_16x16x32_bf16 v[48:51], v[168:171], v[192:195], v[48:51]
    v_mfma_f32_16x16x32_bf16 v[52:55], v[168:171], v[196:199], v[52:55]
    v_mfma_f32_16x16x32_bf16 v[56:59], v[168:171], v[200:203], v[56:59]
    v_mfma_f32_16x16x32_bf16 v[60:63], v[168:171], v[204:207], v[60:63]
    v_mfma_f32_16x16x32_bf16 v[216:219], v[168:171], v[240:243], v[216:219]
    v_mfma_f32_16x16x32_bf16 v[64:67], v[172:175], v[192:195], v[64:67]
    v_mfma_f32_16x16x32_bf16 v[68:71], v[172:175], v[196:199], v[68:71]
    v_mfma_f32_16x16x32_bf16 v[72:75], v[172:175], v[200:203], v[72:75]
    v_mfma_f32_16x16x32_bf16 v[76:79], v[172:175], v[204:207], v[76:79]
    v_mfma_f32_16x16x32_bf16 v[220:223], v[172:175], v[240:243], v[220:223]
    s_lshl_b32 s88, s23, 5
    s_add_u32 s88, s88, s96
    s_lshl_b32 s89, s22, 8
    s_add_u32 s88, s88, s89
    s_add_u32 s88, s88, 100
    s_cmp_lt_u32 s88, 910
    s_cselect_b32 s80, 1, 0
    s_min_u32 s88, s88, 909
    s_cmp_ge_u32 s88, 640
    s_cbranch_scc1 ps_mat_32
    s_cmp_ge_u32 s88, 370
    s_cbranch_scc1 ps_mat_31
    s_cmp_ge_u32 s88, 100
    s_cbranch_scc1 ps_mat_30
ps_mat_29:
    s_mov_b32 s44, s8
    s_mov_b32 s45, s9
    s_mov_b32 s46, 819200
    s_mov_b32 s47, 0x20000
    s_sub_u32 s89, s88, 0
    s_mul_i32 s90, s89, 6554
    s_lshr_b32 s90, s90, 16
    s_mul_i32 s91, s90, 10
    s_sub_u32 s91, s89, s91
    s_mov_b32 s92, 1280
    s_mov_b32 s82, 20480
    s_mov_b32 s84, 0
    s_mov_b32 s83, -1
    s_branch ps_tgo_28
ps_mat_30:
    s_mov_b32 s44, s16
    s_mov_b32 s45, s17
    s_mov_b32 s46, 2211840
    s_mov_b32 s47, 0x20000
    s_sub_u32 s89, s88, 100
    s_mul_i32 s90, s89, 6554
    s_lshr_b32 s90, s90, 16
    s_mul_i32 s91, s90, 10
    s_sub_u32 s91, s89, s91
    s_mov_b32 s92, 1280
    s_mov_b32 s82, 55296
    s_mov_b32 s84, 819200
    s_mov_b32 s83, -1
    s_branch ps_tgo_28
ps_mat_31:
    s_mov_b32 s44, s12
    s_mov_b32 s45, s13
    s_mov_b32 s46, 2211840
    s_mov_b32 s47, 0x20000
    s_sub_u32 s89, s88, 370
    s_mul_i32 s90, s89, 2428
    s_lshr_b32 s90, s90, 16
    s_mul_i32 s91, s90, 27
    s_sub_u32 s91, s89, s91
    s_mov_b32 s92, 3456
    s_mov_b32 s82, 20480
    s_mov_b32 s84, 3031040
    s_mul_i32 s83, s90, 13824
    s_lshl_b32 s94, s91, 8
    s_add_u32 s83, s83, s94
    s_add_u32 s83, s83, 0
    s_branch ps_tgo_28
ps_mat_32:
    s_mov_b32 s44, s14
    s_mov_b32 s45, s15
    s_mov_b32 s46, 2211840
    s_mov_b32 s47, 0x20000
    s_sub_u32 s89, s88, 640
    s_mul_i32 s90, s89, 2428
    s_lshr_b32 s90, s90, 16
    s_mul_i32 s91, s90, 27
    s_sub_u32 s91, s89, s91
    s_mov_b32 s92, 3456
    s_mov_b32 s82, 20480
    s_mov_b32 s84, 5242880
    s_mul_i32 s83, s90, 13824
    s_lshl_b32 s94, s91, 8
    s_add_u32 s83, s83, s94
    s_add_u32 s83, s83, 6912
ps_tgo_28:
    s_mul_i32 s93, s90, s92
    s_lshl_b32 s93, s93, 6
    s_lshl_b32 s94, s91, 7
    s_add_u32 s93, s93, s94
    s_lshl_b32 s81, s91, 2
    s_mul_i32 s81, s81, s82
    s_lshl_b32 s94, s90, 11
    s_add_u32 s81, s81, s94
    s_add_u32 s81, s81, s84
    v_lshrrev_b32 v2, 3, v0
    v_and_b32 v3, 7, v0
    v_lshrrev_b32 v4, 1, v3
    v_lshrrev_b32 v5, 1, v2
    v_and_b32 v5, 3, v5
    v_xor_b32 v4, v4, v5
    v_and_b32 v3, 1, v3
    v_lshl_or_b32 v3, v4, 1, v3
    v_and_b32 v4, 3, v2
    v_lshrrev_b32 v5, 2, v2
    v_lshl_add_u32 v4, v5, 3, v4
    v_mul_lo_u32 v4, v4, s92
    v_lshl_add_u32 v4, v3, 4, v4
    s_mul_i32 s94, s92, 0
    s_add_u32 s94, s94, s93
    buffer_load_dwordx4 v[144:147], v4, s[44:47], s94 offen
    s_mul_i32 s94, s92, 4
    s_add_u32 s94, s94, s93
    buffer_load_dwordx4 v[148:151], v4, s[44:47], s94 offen
    s_mul_i32 s94, s92, 16
    s_add_u32 s94, s94, s93
    buffer_load_dwordx4 v[152:155], v4, s[44:47], s94 offen
    s_mul_i32 s94, s92, 20
    s_add_u32 s94, s94, s93
    buffer_load_dwordx4 v[156:159], v4, s[44:47], s94 offen
    s_mul_i32 s94, s92, 32
    s_add_u32 s94, s94, s93
    buffer_load_dwordx4 v[160:163], v4, s[44:47], s94 offen
    s_mul_i32 s94, s92, 36
    s_add_u32 s94, s94, s93
    buffer_load_dwordx4 v[164:167], v4, s[44:47], s94 offen
    s_mul_i32 s94, s92, 48
    s_add_u32 s94, s94, s93
    buffer_load_dwordx4 v[168:171], v4, s[44:47], s94 offen
    s_mul_i32 s94, s92, 52
    s_add_u32 s94, s94, s93
    buffer_load_dwordx4 v[172:175], v4, s[44:47], s94 offen
    v_lshrrev_b32 v3, 4, v0
    v_lshlrev_b32 v3, 4, v3
    v_add_u32 v3, 162048, v3
    v_add_u32 v3, s79, v3
    s_mov_b32 exec_lo, 0x00010001
    s_mov_b32 exec_hi, 0x00010001
    s_nop 7
    ds_write_b128 v3, v[208:211] offset:0
    ds_write_b128 v3, v[212:215] offset:64
    ds_write_b128 v3, v[216:219] offset:128
    ds_write_b128 v3, v[220:223] offset:192
    s_mov_b64 exec, -1
    v_and_b32 v2, 15, v0
    v_add_u32 v2, s70, v2
    v_lshlrev_b32 v2, 3, v2
    v_add_u32 v2, 160000, v2
    ds_read_b64 v[224:225], v2 offset:0
    ds_read_b64 v[226:227], v2 offset:128
    ds_read_b64 v[228:229], v2 offset:256
    ds_read_b64 v[230:231], v2 offset:384
    v_lshrrev_b32 v3, 4, v0
    v_lshlrev_b32 v3, 4, v3
    v_add_u32 v3, 161024, v3
    s_waitcnt lgkmcnt(0)
    v_mov_b32 v2, 159752
    ds_read_b32 v3, v2
    s_waitcnt lgkmcnt(0)
    v_readfirstlane_b32 s0, v3
    s_branch ps_qj_16
ps_q1_15:
    s_barrier
    ds_read_b128 v[112:115], v232 offset:0
    ds_read_b128 v[116:119], v232 offset:2048
    ds_read_b128 v[120:123], v232 offset:4096
    ds_read_b128 v[124:127], v232 offset:6144
    ds_read_b64_tr_b16 v[80:81], v234 offset:0
    ds_read_b64_tr_b16 v[82:83], v234 offset:2048
    ds_read_b64_tr_b16 v[84:85], v235 offset:0
    ds_read_b64_tr_b16 v[86:87], v235 offset:2048
    ds_read_b64_tr_b16 v[88:89], v236 offset:0
    ds_read_b64_tr_b16 v[90:91], v236 offset:2048
    ds_read_b64_tr_b16 v[92:93], v237 offset:0
    ds_read_b64_tr_b16 v[94:95], v237 offset:2048
    s_waitcnt lgkmcnt(9)
    ds_read_b128 v[128:131], v233 offset:0
    ds_read_b128 v[132:135], v233 offset:2048
    ds_read_b128 v[136:139], v233 offset:4096
    ds_read_b128 v[140:143], v233 offset:6144
    s_waitcnt lgkmcnt(9)
    ds_read_b64_tr_b16 v[96:97], v234 offset:8192
    ds_read_b64_tr_b16 v[98:99], v234 offset:10240
    ds_read_b64_tr_b16 v[100:101], v235 offset:8192
    ds_read_b64_tr_b16 v[102:103], v235 offset:10240
    s_waitcnt lgkmcnt(9)
    ds_read_b64_tr_b16 v[104:105], v236 offset:8192
    ds_read_b64_tr_b16 v[106:107], v236 offset:10240
    ds_read_b64_tr_b16 v[108:109], v237 offset:8192
    ds_read_b64_tr_b16 v[110:111], v237 offset:10240
    s_mov_b32 s57, 2
ps_fs_33:
    s_waitcnt lgkmcnt(0)
    s_barrier
    v_mfma_f32_16x16x32_bf16 v[16:19], v[80:83], v[112:115], v[16:19]
    ds_read_b128 v[176:179], v232 offset:16384
    v_mfma_f32_16x16x32_bf16 v[20:23], v[80:83], v[116:119], v[20:23]
    ds_read_b128 v[180:183], v232 offset:18432
    v_mfma_f32_16x16x32_bf16 v[24:27], v[80:83], v[120:123], v[24:27]
    ds_read_b128 v[184:187], v232 offset:20480
    v_mfma_f32_16x16x32_bf16 v[28:31], v[80:83], v[124:127], v[28:31]
    ds_read_b128 v[188:191], v232 offset:22528
    v_mfma_f32_16x16x32_bf16 v[32:35], v[84:87], v[112:115], v[32:35]
    ds_read_b64_tr_b16 v[144:145], v234 offset:16384
    v_mfma_f32_16x16x32_bf16 v[36:39], v[84:87], v[116:119], v[36:39]
    ds_read_b64_tr_b16 v[146:147], v234 offset:18432
    v_mfma_f32_16x16x32_bf16 v[40:43], v[84:87], v[120:123], v[40:43]
    ds_read_b64_tr_b16 v[148:149], v235 offset:16384
    v_mfma_f32_16x16x32_bf16 v[44:47], v[84:87], v[124:127], v[44:47]
    ds_read_b64_tr_b16 v[150:151], v235 offset:18432
    v_mfma_f32_16x16x32_bf16 v[48:51], v[88:91], v[112:115], v[48:51]
    ds_read_b64_tr_b16 v[152:153], v236 offset:16384
    v_mfma_f32_16x16x32_bf16 v[52:55], v[88:91], v[116:119], v[52:55]
    ds_read_b64_tr_b16 v[154:155], v236 offset:18432
    v_mfma_f32_16x16x32_bf16 v[56:59], v[88:91], v[120:123], v[56:59]
    ds_read_b64_tr_b16 v[156:157], v237 offset:16384
    v_mfma_f32_16x16x32_bf16 v[60:63], v[88:91], v[124:127], v[60:63]
    ds_read_b64_tr_b16 v[158:159], v237 offset:18432
    s_waitcnt lgkmcnt(9)
    v_mfma_f32_16x16x32_bf16 v[64:67], v[92:95], v[112:115], v[64:67]
    ds_read_b128 v[192:195], v233 offset:16384
    v_mfma_f32_16x16x32_bf16 v[68:71], v[92:95], v[116:119], v[68:71]
    ds_read_b128 v[196:199], v233 offset:18432
    v_mfma_f32_16x16x32_bf16 v[72:75], v[92:95], v[120:123], v[72:75]
    ds_read_b128 v[200:203], v233 offset:20480
    v_mfma_f32_16x16x32_bf16 v[76:79], v[92:95], v[124:127], v[76:79]
    ds_read_b128 v[204:207], v233 offset:22528
    s_waitcnt lgkmcnt(9)
    v_mfma_f32_16x16x32_bf16 v[16:19], v[96:99], v[128:131], v[16:19]
    ds_read_b64_tr_b16 v[160:161], v234 offset:24576
    v_mfma_f32_16x16x32_bf16 v[20:23], v[96:99], v[132:135], v[20:23]
    ds_read_b64_tr_b16 v[162:163], v234 offset:26624
    v_mfma_f32_16x16x32_bf16 v[24:27], v[96:99], v[136:139], v[24:27]
    ds_read_b64_tr_b16 v[164:165], v235 offset:24576
    v_mfma_f32_16x16x32_bf16 v[28:31], v[96:99], v[140:143], v[28:31]
    ds_read_b64_tr_b16 v[166:167], v235 offset:26624
    s_waitcnt lgkmcnt(9)
    v_mfma_f32_16x16x32_bf16 v[32:35], v[100:103], v[128:131], v[32:35]
    ds_read_b64_tr_b16 v[168:169], v236 offset:24576
    v_mfma_f32_16x16x32_bf16 v[36:39], v[100:103], v[132:135], v[36:39]
    ds_read_b64_tr_b16 v[170:171], v236 offset:26624
    v_mfma_f32_16x16x32_bf16 v[40:43], v[100:103], v[136:139], v[40:43]
    ds_read_b64_tr_b16 v[172:173], v237 offset:24576
    v_mfma_f32_16x16x32_bf16 v[44:47], v[100:103], v[140:143], v[44:47]
    ds_read_b64_tr_b16 v[174:175], v237 offset:26624
    v_mfma_f32_16x16x32_bf16 v[48:51], v[104:107], v[128:131], v[48:51]
    v_mfma_f32_16x16x32_bf16 v[52:55], v[104:107], v[132:135], v[52:55]
    v_mfma_f32_16x16x32_bf16 v[56:59], v[104:107], v[136:139], v[56:59]
    v_mfma_f32_16x16x32_bf16 v[60:63], v[104:107], v[140:143], v[60:63]
    v_mfma_f32_16x16x32_bf16 v[64:67], v[108:111], v[128:131], v[64:67]
    v_mfma_f32_16x16x32_bf16 v[68:71], v[108:111], v[132:135], v[68:71]
    v_mfma_f32_16x16x32_bf16 v[72:75], v[108:111], v[136:139], v[72:75]
    v_mfma_f32_16x16x32_bf16 v[76:79], v[108:111], v[140:143], v[76:79]
    s_waitcnt lgkmcnt(0)
    s_barrier
    v_mfma_f32_16x16x32_bf16 v[16:19], v[144:147], v[176:179], v[16:19]
    ds_read_b128 v[112:115], v232 offset:32768
    v_mfma_f32_16x16x32_bf16 v[20:23], v[144:147], v[180:183], v[20:23]
    ds_read_b128 v[116:119], v232 offset:34816
    v_mfma_f32_16x16x32_bf16 v[24:27], v[144:147], v[184:187], v[24:27]
    ds_read_b128 v[120:123], v232 offset:36864
    v_mfma_f32_16x16x32_bf16 v[28:31], v[144:147], v[188:191], v[28:31]
    ds_read_b128 v[124:127], v232 offset:38912
    v_mfma_f32_16x16x32_bf16 v[32:35], v[148:151], v[176:179], v[32:35]
    ds_read_b64_tr_b16 v[80:81], v234 offset:32768
    v_mfma_f32_16x16x32_bf16 v[36:39], v[148:151], v[180:183], v[36:39]
    ds_read_b64_tr_b16 v[82:83], v234 offset:34816
    v_mfma_f32_16x16x32_bf16 v[40:43], v[148:151], v[184:187], v[40:43]
    ds_read_b64_tr_b16 v[84:85], v235 offset:32768
    v_mfma_f32_16x16x32_bf16 v[44:47], v[148:151], v[188:191], v[44:47]
    ds_read_b64_tr_b16 v[86:87], v235 offset:34816
    v_mfma_f32_16x16x32_bf16 v[48:51], v[152:155], v[176:179], v[48:51]
    ds_read_b64_tr_b16 v[88:89], v236 offset:32768
    v_mfma_f32_16x16x32_bf16 v[52:55], v[152:155], v[180:183], v[52:55]
    ds_read_b64_tr_b16 v[90:91], v236 offset:34816
    v_mfma_f32_16x16x32_bf16 v[56:59], v[152:155], v[184:187], v[56:59]
    ds_read_b64_tr_b16 v[92:93], v237 offset:32768
    v_mfma_f32_16x16x32_bf16 v[60:63], v[152:155], v[188:191], v[60:63]
    ds_read_b64_tr_b16 v[94:95], v237 offset:34816
    s_waitcnt lgkmcnt(9)
    v_mfma_f32_16x16x32_bf16 v[64:67], v[156:159], v[176:179], v[64:67]
    ds_read_b128 v[128:131], v233 offset:32768
    v_mfma_f32_16x16x32_bf16 v[68:71], v[156:159], v[180:183], v[68:71]
    ds_read_b128 v[132:135], v233 offset:34816
    v_mfma_f32_16x16x32_bf16 v[72:75], v[156:159], v[184:187], v[72:75]
    ds_read_b128 v[136:139], v233 offset:36864
    v_mfma_f32_16x16x32_bf16 v[76:79], v[156:159], v[188:191], v[76:79]
    ds_read_b128 v[140:143], v233 offset:38912
    s_waitcnt lgkmcnt(9)
    v_mfma_f32_16x16x32_bf16 v[16:19], v[160:163], v[192:195], v[16:19]
    ds_read_b64_tr_b16 v[96:97], v234 offset:40960
    v_mfma_f32_16x16x32_bf16 v[20:23], v[160:163], v[196:199], v[20:23]
    ds_read_b64_tr_b16 v[98:99], v234 offset:43008
    v_mfma_f32_16x16x32_bf16 v[24:27], v[160:163], v[200:203], v[24:27]
    ds_read_b64_tr_b16 v[100:101], v235 offset:40960
    v_mfma_f32_16x16x32_bf16 v[28:31], v[160:163], v[204:207], v[28:31]
    ds_read_b64_tr_b16 v[102:103], v235 offset:43008
    s_waitcnt lgkmcnt(9)
    v_mfma_f32_16x16x32_bf16 v[32:35], v[164:167], v[192:195], v[32:35]
    ds_read_b64_tr_b16 v[104:105], v236 offset:40960
    v_mfma_f32_16x16x32_bf16 v[36:39], v[164:167], v[196:199], v[36:39]
    ds_read_b64_tr_b16 v[106:107], v236 offset:43008
    v_mfma_f32_16x16x32_bf16 v[40:43], v[164:167], v[200:203], v[40:43]
    ds_read_b64_tr_b16 v[108:109], v237 offset:40960
    v_mfma_f32_16x16x32_bf16 v[44:47], v[164:167], v[204:207], v[44:47]
    ds_read_b64_tr_b16 v[110:111], v237 offset:43008
    v_mfma_f32_16x16x32_bf16 v[48:51], v[168:171], v[192:195], v[48:51]
    v_mfma_f32_16x16x32_bf16 v[52:55], v[168:171], v[196:199], v[52:55]
    v_mfma_f32_16x16x32_bf16 v[56:59], v[168:171], v[200:203], v[56:59]
    v_mfma_f32_16x16x32_bf16 v[60:63], v[168:171], v[204:207], v[60:63]
    v_mfma_f32_16x16x32_bf16 v[64:67], v[172:175], v[192:195], v[64:67]
    v_mfma_f32_16x16x32_bf16 v[68:71], v[172:175], v[196:199], v[68:71]
    v_mfma_f32_16x16x32_bf16 v[72:75], v[172:175], v[200:203], v[72:75]
    v_mfma_f32_16x16x32_bf16 v[76:79], v[172:175], v[204:207], v[76:79]
    s_waitcnt lgkmcnt(0)
    s_barrier
    v_mfma_f32_16x16x32_bf16 v[16:19], v[80:83], v[112:115], v[16:19]
    ds_read_b128 v[176:179], v232 offset:49152
    v_mfma_f32_16x16x32_bf16 v[20:23], v[80:83], v[116:119], v[20:23]
    ds_read_b128 v[180:183], v232 offset:51200
    v_mfma_f32_16x16x32_bf16 v[24:27], v[80:83], v[120:123], v[24:27]
    ds_read_b128 v[184:187], v232 offset:53248
    v_mfma_f32_16x16x32_bf16 v[28:31], v[80:83], v[124:127], v[28:31]
    ds_read_b128 v[188:191], v232 offset:55296
    v_mfma_f32_16x16x32_bf16 v[32:35], v[84:87], v[112:115], v[32:35]
    ds_read_b64_tr_b16 v[144:145], v234 offset:49152
    v_mfma_f32_16x16x32_bf16 v[36:39], v[84:87], v[116:119], v[36:39]
    ds_read_b64_tr_b16 v[146:147], v234 offset:51200
    v_mfma_f32_16x16x32_bf16 v[40:43], v[84:87], v[120:123], v[40:43]
    ds_read_b64_tr_b16 v[148:149], v235 offset:49152
    v_mfma_f32_16x16x32_bf16 v[44:47], v[84:87], v[124:127], v[44:47]
    ds_read_b64_tr_b16 v[150:151], v235 offset:51200
    v_mfma_f32_16x16x32_bf16 v[48:51], v[88:91], v[112:115], v[48:51]
    ds_read_b64_tr_b16 v[152:153], v236 offset:49152
    v_mfma_f32_16x16x32_bf16 v[52:55], v[88:91], v[116:119], v[52:55]
    ds_read_b64_tr_b16 v[154:155], v236 offset:51200
    v_mfma_f32_16x16x32_bf16 v[56:59], v[88:91], v[120:123], v[56:59]
    ds_read_b64_tr_b16 v[156:157], v237 offset:49152
    v_mfma_f32_16x16x32_bf16 v[60:63], v[88:91], v[124:127], v[60:63]
    ds_read_b64_tr_b16 v[158:159], v237 offset:51200
    s_waitcnt lgkmcnt(9)
    v_mfma_f32_16x16x32_bf16 v[64:67], v[92:95], v[112:115], v[64:67]
    ds_read_b128 v[192:195], v233 offset:49152
    v_mfma_f32_16x16x32_bf16 v[68:71], v[92:95], v[116:119], v[68:71]
    ds_read_b128 v[196:199], v233 offset:51200
    v_mfma_f32_16x16x32_bf16 v[72:75], v[92:95], v[120:123], v[72:75]
    ds_read_b128 v[200:203], v233 offset:53248
    v_mfma_f32_16x16x32_bf16 v[76:79], v[92:95], v[124:127], v[76:79]
    ds_read_b128 v[204:207], v233 offset:55296
    s_waitcnt lgkmcnt(9)
    v_mfma_f32_16x16x32_bf16 v[16:19], v[96:99], v[128:131], v[16:19]
    ds_read_b64_tr_b16 v[160:161], v234 offset:57344
    v_mfma_f32_16x16x32_bf16 v[20:23], v[96:99], v[132:135], v[20:23]
    ds_read_b64_tr_b16 v[162:163], v234 offset:59392
    v_mfma_f32_16x16x32_bf16 v[24:27], v[96:99], v[136:139], v[24:27]
    ds_read_b64_tr_b16 v[164:165], v235 offset:57344
    v_mfma_f32_16x16x32_bf16 v[28:31], v[96:99], v[140:143], v[28:31]
    ds_read_b64_tr_b16 v[166:167], v235 offset:59392
    s_waitcnt lgkmcnt(9)
    v_mfma_f32_16x16x32_bf16 v[32:35], v[100:103], v[128:131], v[32:35]
    ds_read_b64_tr_b16 v[168:169], v236 offset:57344
    v_mfma_f32_16x16x32_bf16 v[36:39], v[100:103], v[132:135], v[36:39]
    ds_read_b64_tr_b16 v[170:171], v236 offset:59392
    v_mfma_f32_16x16x32_bf16 v[40:43], v[100:103], v[136:139], v[40:43]
    ds_read_b64_tr_b16 v[172:173], v237 offset:57344
    v_mfma_f32_16x16x32_bf16 v[44:47], v[100:103], v[140:143], v[44:47]
    ds_read_b64_tr_b16 v[174:175], v237 offset:59392
    v_mfma_f32_16x16x32_bf16 v[48:51], v[104:107], v[128:131], v[48:51]
    v_mfma_f32_16x16x32_bf16 v[52:55], v[104:107], v[132:135], v[52:55]
    v_mfma_f32_16x16x32_bf16 v[56:59], v[104:107], v[136:139], v[56:59]
    v_mfma_f32_16x16x32_bf16 v[60:63], v[104:107], v[140:143], v[60:63]
    v_mfma_f32_16x16x32_bf16 v[64:67], v[108:111], v[128:131], v[64:67]
    v_mfma_f32_16x16x32_bf16 v[68:71], v[108:111], v[132:135], v[68:71]
    v_mfma_f32_16x16x32_bf16 v[72:75], v[108:111], v[136:139], v[72:75]
    v_mfma_f32_16x16x32_bf16 v[76:79], v[108:111], v[140:143], v[76:79]
    s_waitcnt lgkmcnt(0)
    s_barrier
    v_mfma_f32_16x16x32_bf16 v[16:19], v[144:147], v[176:179], v[16:19]
    ds_read_b128 v[112:115], v232 offset:0
    v_mfma_f32_16x16x32_bf16 v[20:23], v[144:147], v[180:183], v[20:23]
    ds_read_b128 v[116:119], v232 offset:2048
    v_mfma_f32_16x16x32_bf16 v[24:27], v[144:147], v[184:187], v[24:27]
    ds_read_b128 v[120:123], v232 offset:4096
    v_mfma_f32_16x16x32_bf16 v[28:31], v[144:147], v[188:191], v[28:31]
    ds_read_b128 v[124:127], v232 offset:6144
    v_mfma_f32_16x16x32_bf16 v[32:35], v[148:151], v[176:179], v[32:35]
    ds_read_b64_tr_b16 v[80:81], v234 offset:0
    v_mfma_f32_16x16x32_bf16 v[36:39], v[148:151], v[180:183], v[36:39]
    ds_read_b64_tr_b16 v[82:83], v234 offset:2048
    v_mfma_f32_16x16x32_bf16 v[40:43], v[148:151], v[184:187], v[40:43]
    ds_read_b64_tr_b16 v[84:85], v235 offset:0
    v_mfma_f32_16x16x32_bf16 v[44:47], v[148:151], v[188:191], v[44:47]
    ds_read_b64_tr_b16 v[86:87], v235 offset:2048
    v_mfma_f32_16x16x32_bf16 v[48:51], v[152:155], v[176:179], v[48:51]
    ds_read_b64_tr_b16 v[88:89], v236 offset:0
    v_mfma_f32_16x16x32_bf16 v[52:55], v[152:155], v[180:183], v[52:55]
    ds_read_b64_tr_b16 v[90:91], v236 offset:2048
    v_mfma_f32_16x16x32_bf16 v[56:59], v[152:155], v[184:187], v[56:59]
    ds_read_b64_tr_b16 v[92:93], v237 offset:0
    v_mfma_f32_16x16x32_bf16 v[60:63], v[152:155], v[188:191], v[60:63]
    ds_read_b64_tr_b16 v[94:95], v237 offset:2048
    s_waitcnt lgkmcnt(9)
    v_mfma_f32_16x16x32_bf16 v[64:67], v[156:159], v[176:179], v[64:67]
    ds_read_b128 v[128:131], v233 offset:0
    v_mfma_f32_16x16x32_bf16 v[68:71], v[156:159], v[180:183], v[68:71]
    ds_read_b128 v[132:135], v233 offset:2048
    v_mfma_f32_16x16x32_bf16 v[72:75], v[156:159], v[184:187], v[72:75]
    ds_read_b128 v[136:139], v233 offset:4096
    v_mfma_f32_16x16x32_bf16 v[76:79], v[156:159], v[188:191], v[76:79]
    ds_read_b128 v[140:143], v233 offset:6144
    s_waitcnt lgkmcnt(9)
    v_mfma_f32_16x16x32_bf16 v[16:19], v[160:163], v[192:195], v[16:19]
    ds_read_b64_tr_b16 v[96:97], v234 offset:8192
    v_mfma_f32_16x16x32_bf16 v[20:23], v[160:163], v[196:199], v[20:23]
    ds_read_b64_tr_b16 v[98:99], v234 offset:10240
    v_mfma_f32_16x16x32_bf16 v[24:27], v[160:163], v[200:203], v[24:27]
    ds_read_b64_tr_b16 v[100:101], v235 offset:8192
    v_mfma_f32_16x16x32_bf16 v[28:31], v[160:163], v[204:207], v[28:31]
    ds_read_b64_tr_b16 v[102:103], v235 offset:10240
    s_waitcnt lgkmcnt(9)
    v_mfma_f32_16x16x32_bf16 v[32:35], v[164:167], v[192:195], v[32:35]
    ds_read_b64_tr_b16 v[104:105], v236 offset:8192
    v_mfma_f32_16x16x32_bf16 v[36:39], v[164:167], v[196:199], v[36:39]
    ds_read_b64_tr_b16 v[106:107], v236 offset:10240
    v_mfma_f32_16x16x32_bf16 v[40:43], v[164:167], v[200:203], v[40:43]
    ds_read_b64_tr_b16 v[108:109], v237 offset:8192
    v_mfma_f32_16x16x32_bf16 v[44:47], v[164:167], v[204:207], v[44:47]
    ds_read_b64_tr_b16 v[110:111], v237 offset:10240
    v_mfma_f32_16x16x32_bf16 v[48:51], v[168:171], v[192:195], v[48:51]
    v_mfma_f32_16x16x32_bf16 v[52:55], v[168:171], v[196:199], v[52:55]
    v_mfma_f32_16x16x32_bf16 v[56:59], v[168:171], v[200:203], v[56:59]
    v_mfma_f32_16x16x32_bf16 v[60:63], v[168:171], v[204:207], v[60:63]
    v_mfma_f32_16x16x32_bf16 v[64:67], v[172:175], v[192:195], v[64:67]
    v_mfma_f32_16x16x32_bf16 v[68:71], v[172:175], v[196:199], v[68:71]
    v_mfma_f32_16x16x32_bf16 v[72:75], v[172:175], v[200:203], v[72:75]
    v_mfma_f32_16x16x32_bf16 v[76:79], v[172:175], v[204:207], v[76:79]
    s_sub_u32 s57, s57, 1
    s_cmp_lg_u32 s57, 0
    s_cbranch_scc1 ps_fs_33
    s_waitcnt lgkmcnt(0)
    s_barrier
    v_mfma_f32_16x16x32_bf16 v[16:19], v[80:83], v[112:115], v[16:19]
    ds_read_b128 v[176:179], v232 offset:16384
    v_mfma_f32_16x16x32_bf16 v[20:23], v[80:83], v[116:119], v[20:23]
    ds_read_b128 v[180:183], v232 offset:18432
    v_mfma_f32_16x16x32_bf16 v[24:27], v[80:83], v[120:123], v[24:27]
    ds_read_b128 v[184:187], v232 offset:20480
    v_mfma_f32_16x16x32_bf16 v[28:31], v[80:83], v[124:127], v[28:31]
    ds_read_b128 v[188:191], v232 offset:22528
    v_mfma_f32_16x16x32_bf16 v[32:35], v[84:87], v[112:115], v[32:35]
    ds_read_b64_tr_b16 v[144:145], v234 offset:16384
    v_mfma_f32_16x16x32_bf16 v[36:39], v[84:87], v[116:119], v[36:39]
    ds_read_b64_tr_b16 v[146:147], v234 offset:18432
    v_mfma_f32_16x16x32_bf16 v[40:43], v[84:87], v[120:123], v[40:43]
    ds_read_b64_tr_b16 v[148:149], v235 offset:16384
    v_mfma_f32_16x16x32_bf16 v[44:47], v[84:87], v[124:127], v[44:47]
    ds_read_b64_tr_b16 v[150:151], v235 offset:18432
    v_mfma_f32_16x16x32_bf16 v[48:51], v[88:91], v[112:115], v[48:51]
    ds_read_b64_tr_b16 v[152:153], v236 offset:16384
    v_mfma_f32_16x16x32_bf16 v[52:55], v[88:91], v[116:119], v[52:55]
    ds_read_b64_tr_b16 v[154:155], v236 offset:18432
    v_mfma_f32_16x16x32_bf16 v[56:59], v[88:91], v[120:123], v[56:59]
    ds_read_b64_tr_b16 v[156:157], v237 offset:16384
    v_mfma_f32_16x16x32_bf16 v[60:63], v[88:91], v[124:127], v[60:63]
    ds_read_b64_tr_b16 v[158:159], v237 offset:18432
    s_waitcnt lgkmcnt(9)
    v_mfma_f32_16x16x32_bf16 v[64:67], v[92:95], v[112:115], v[64:67]
    ds_read_b128 v[192:195], v233 offset:16384
    v_mfma_f32_16x16x32_bf16 v[68:71], v[92:95], v[116:119], v[68:71]
    ds_read_b128 v[196:199], v233 offset:18432
    v_mfma_f32_16x16x32_bf16 v[72:75], v[92:95], v[120:123], v[72:75]
    ds_read_b128 v[200:203], v233 offset:20480
    v_mfma_f32_16x16x32_bf16 v[76:79], v[92:95], v[124:127], v[76:79]
    ds_read_b128 v[204:207], v233 offset:22528
    s_waitcnt lgkmcnt(9)
    v_mfma_f32_16x16x32_bf16 v[16:19], v[96:99], v[128:131], v[16:19]
    ds_read_b64_tr_b16 v[160:161], v234 offset:24576
    v_mfma_f32_16x16x32_bf16 v[20:23], v[96:99], v[132:135], v[20:23]
    ds_read_b64_tr_b16 v[162:163], v234 offset:26624
    v_mfma_f32_16x16x32_bf16 v[24:27], v[96:99], v[136:139], v[24:27]
    ds_read_b64_tr_b16 v[164:165], v235 offset:24576
    v_mfma_f32_16x16x32_bf16 v[28:31], v[96:99], v[140:143], v[28:31]
    ds_read_b64_tr_b16 v[166:167], v235 offset:26624
    s_waitcnt lgkmcnt(9)
    v_mfma_f32_16x16x32_bf16 v[32:35], v[100:103], v[128:131], v[32:35]
    ds_read_b64_tr_b16 v[168:169], v236 offset:24576
    v_mfma_f32_16x16x32_bf16 v[36:39], v[100:103], v[132:135], v[36:39]
    ds_read_b64_tr_b16 v[170:171], v236 offset:26624
    v_mfma_f32_16x16x32_bf16 v[40:43], v[100:103], v[136:139], v[40:43]
    ds_read_b64_tr_b16 v[172:173], v237 offset:24576
    v_mfma_f32_16x16x32_bf16 v[44:47], v[100:103], v[140:143], v[44:47]
    ds_read_b64_tr_b16 v[174:175], v237 offset:26624
    v_mfma_f32_16x16x32_bf16 v[48:51], v[104:107], v[128:131], v[48:51]
    v_mfma_f32_16x16x32_bf16 v[52:55], v[104:107], v[132:135], v[52:55]
    v_mfma_f32_16x16x32_bf16 v[56:59], v[104:107], v[136:139], v[56:59]
    v_mfma_f32_16x16x32_bf16 v[60:63], v[104:107], v[140:143], v[60:63]
    v_mfma_f32_16x16x32_bf16 v[64:67], v[108:111], v[128:131], v[64:67]
    v_mfma_f32_16x16x32_bf16 v[68:71], v[108:111], v[132:135], v[68:71]
    v_mfma_f32_16x16x32_bf16 v[72:75], v[108:111], v[136:139], v[72:75]
    v_mfma_f32_16x16x32_bf16 v[76:79], v[108:111], v[140:143], v[76:79]
    s_waitcnt lgkmcnt(0)
    s_barrier
    v_mfma_f32_16x16x32_bf16 v[16:19], v[144:147], v[176:179], v[16:19]
    v_mfma_f32_16x16x32_bf16 v[20:23], v[144:147], v[180:183], v[20:23]
    v_mfma_f32_16x16x32_bf16 v[24:27], v[144:147], v[184:187], v[24:27]
    v_mfma_f32_16x16x32_bf16 v[28:31], v[144:147], v[188:191], v[28:31]
    v_mfma_f32_16x16x32_bf16 v[32:35], v[148:151], v[176:179], v[32:35]
    v_mfma_f32_16x16x32_bf16 v[36:39], v[148:151], v[180:183], v[36:39]
    v_mfma_f32_16x16x32_bf16 v[40:43], v[148:151], v[184:187], v[40:43]
    v_mfma_f32_16x16x32_bf16 v[44:47], v[148:151], v[188:191], v[44:47]
    v_mfma_f32_16x16x32_bf16 v[48:51], v[152:155], v[176:179], v[48:51]
    v_mfma_f32_16x16x32_bf16 v[52:55], v[152:155], v[180:183], v[52:55]
    v_mfma_f32_16x16x32_bf16 v[56:59], v[152:155], v[184:187], v[56:59]
    v_mfma_f32_16x16x32_bf16 v[60:63], v[152:155], v[188:191], v[60:63]
    v_mfma_f32_16x16x32_bf16 v[64:67], v[156:159], v[176:179], v[64:67]
    v_mfma_f32_16x16x32_bf16 v[68:71], v[156:159], v[180:183], v[68:71]
    v_mfma_f32_16x16x32_bf16 v[72:75], v[156:159], v[184:187], v[72:75]
    v_mfma_f32_16x16x32_bf16 v[76:79], v[156:159], v[188:191], v[76:79]
    v_mfma_f32_16x16x32_bf16 v[16:19], v[160:163], v[192:195], v[16:19]
    v_mfma_f32_16x16x32_bf16 v[20:23], v[160:163], v[196:199], v[20:23]
    v_mfma_f32_16x16x32_bf16 v[24:27], v[160:163], v[200:203], v[24:27]
    v_mfma_f32_16x16x32_bf16 v[28:31], v[160:163], v[204:207], v[28:31]
    v_mfma_f32_16x16x32_bf16 v[32:35], v[164:167], v[192:195], v[32:35]
    v_mfma_f32_16x16x32_bf16 v[36:39], v[164:167], v[196:199], v[36:39]
    v_mfma_f32_16x16x32_bf16 v[40:43], v[164:167], v[200:203], v[40:43]
    v_mfma_f32_16x16x32_bf16 v[44:47], v[164:167], v[204:207], v[44:47]
    v_mfma_f32_16x16x32_bf16 v[48:51], v[168:171], v[192:195], v[48:51]
    v_mfma_f32_16x16x32_bf16 v[52:55], v[168:171], v[196:199], v[52:55]
    v_mfma_f32_16x16x32_bf16 v[56:59], v[168:171], v[200:203], v[56:59]
    v_mfma_f32_16x16x32_bf16 v[60:63], v[168:171], v[204:207], v[60:63]
    v_mfma_f32_16x16x32_bf16 v[64:67], v[172:175], v[192:195], v[64:67]
    v_mfma_f32_16x16x32_bf16 v[68:71], v[172:175], v[196:199], v[68:71]
    v_mfma_f32_16x16x32_bf16 v[72:75], v[172:175], v[200:203], v[72:75]
    v_mfma_f32_16x16x32_bf16 v[76:79], v[172:175], v[204:207], v[76:79]
    v_and_b32 v2, 15, v0
    v_add_u32 v2, s70, v2
    v_lshlrev_b32 v2, 3, v2
    v_add_u32 v2, 160000, v2
    ds_read_b64 v[224:225], v2 offset:0
    ds_read_b64 v[226:227], v2 offset:128
    ds_read_b64 v[228:229], v2 offset:256
    ds_read_b64 v[230:231], v2 offset:384
    v_lshrrev_b32 v3, 4, v0
    v_lshlrev_b32 v3, 4, v3
    v_add_u32 v3, 162048, v3
    v_add_u32 v3, s79, v3
    ds_read_b128 v[208:211], v3 offset:0
    ds_read_b128 v[212:215], v3 offset:64
    ds_read_b128 v[216:219], v3 offset:128
    ds_read_b128 v[220:223], v3 offset:192
    s_waitcnt lgkmcnt(0)
ps_qj_16:
    v_pk_fma_f32 v[16:17], v[208:209], v[224:225], v[16:17] op_sel:[0,1,0] op_sel_hi:[1,1,1]
    v_pk_fma_f32 v[18:19], v[210:211], v[224:225], v[18:19] op_sel:[0,1,0] op_sel_hi:[1,1,1]
    v_pk_fma_f32 v[32:33], v[212:213], v[224:225], v[32:33] op_sel:[0,1,0] op_sel_hi:[1,1,1]
    v_pk_fma_f32 v[34:35], v[214:215], v[224:225], v[34:35] op_sel:[0,1,0] op_sel_hi:[1,1,1]
    v_pk_fma_f32 v[48:49], v[216:217], v[224:225], v[48:49] op_sel:[0,1,0] op_sel_hi:[1,1,1]
    v_pk_fma_f32 v[50:51], v[218:219], v[224:225], v[50:51] op_sel:[0,1,0] op_sel_hi:[1,1,1]
    v_pk_fma_f32 v[64:65], v[220:221], v[224:225], v[64:65] op_sel:[0,1,0] op_sel_hi:[1,1,1]
    v_pk_fma_f32 v[66:67], v[222:223], v[224:225], v[66:67] op_sel:[0,1,0] op_sel_hi:[1,1,1]
    v_pk_mul_f32 v[16:17], v[16:17], v[224:225] op_sel:[0,0] op_sel_hi:[1,0]
    v_pk_mul_f32 v[18:19], v[18:19], v[224:225] op_sel:[0,0] op_sel_hi:[1,0]
    v_pk_mul_f32 v[32:33], v[32:33], v[224:225] op_sel:[0,0] op_sel_hi:[1,0]
    v_pk_mul_f32 v[34:35], v[34:35], v[224:225] op_sel:[0,0] op_sel_hi:[1,0]
    v_pk_mul_f32 v[48:49], v[48:49], v[224:225] op_sel:[0,0] op_sel_hi:[1,0]
    v_pk_mul_f32 v[50:51], v[50:51], v[224:225] op_sel:[0,0] op_sel_hi:[1,0]
    v_pk_mul_f32 v[64:65], v[64:65], v[224:225] op_sel:[0,0] op_sel_hi:[1,0]
    v_pk_mul_f32 v[66:67], v[66:67], v[224:225] op_sel:[0,0] op_sel_hi:[1,0]
    v_cvt_pk_bf16_f32 v80, v16, v17
    v_cvt_pk_bf16_f32 v81, v18, v19
    v_cvt_pk_bf16_f32 v82, v32, v33
    v_cvt_pk_bf16_f32 v83, v34, v35
    v_cvt_pk_bf16_f32 v84, v48, v49
    v_cvt_pk_bf16_f32 v85, v50, v51
    v_cvt_pk_bf16_f32 v86, v64, v65
    v_cvt_pk_bf16_f32 v87, v66, v67
    buffer_store_dwordx2 v[80:81], v238, s[36:39], 0 offen offset:0 sc1
    buffer_store_dwordx2 v[82:83], v238, s[36:39], s74 offen offset:0 sc1
    buffer_store_dwordx2 v[84:85], v238, s[36:39], s75 offen offset:0 sc1
    buffer_store_dwordx2 v[86:87], v238, s[36:39], s76 offen offset:0 sc1
    v_pk_fma_f32 v[20:21], v[208:209], v[226:227], v[20:21] op_sel:[0,1,0] op_sel_hi:[1,1,1]
    v_pk_fma_f32 v[22:23], v[210:211], v[226:227], v[22:23] op_sel:[0,1,0] op_sel_hi:[1,1,1]
    v_pk_fma_f32 v[36:37], v[212:213], v[226:227], v[36:37] op_sel:[0,1,0] op_sel_hi:[1,1,1]
    v_pk_fma_f32 v[38:39], v[214:215], v[226:227], v[38:39] op_sel:[0,1,0] op_sel_hi:[1,1,1]
    v_pk_fma_f32 v[52:53], v[216:217], v[226:227], v[52:53] op_sel:[0,1,0] op_sel_hi:[1,1,1]
    v_pk_fma_f32 v[54:55], v[218:219], v[226:227], v[54:55] op_sel:[0,1,0] op_sel_hi:[1,1,1]
    v_pk_fma_f32 v[68:69], v[220:221], v[226:227], v[68:69] op_sel:[0,1,0] op_sel_hi:[1,1,1]
    v_pk_fma_f32 v[70:71], v[222:223], v[226:227], v[70:71] op_sel:[0,1,0] op_sel_hi:[1,1,1]
    v_pk_mul_f32 v[20:21], v[20:21], v[226:227] op_sel:[0,0] op_sel_hi:[1,0]
    v_pk_mul_f32 v[22:23], v[22:23], v[226:227] op_sel:[0,0] op_sel_hi:[1,0]
    v_pk_mul_f32 v[36:37], v[36:37], v[226:227] op_sel:[0,0] op_sel_hi:[1,0]
    v_pk_mul_f32 v[38:39], v[38:39], v[226:227] op_sel:[0,0] op_sel_hi:[1,0]
    v_pk_mul_f32 v[52:53], v[52:53], v[226:227] op_sel:[0,0] op_sel_hi:[1,0]
    v_pk_mul_f32 v[54:55], v[54:55], v[226:227] op_sel:[0,0] op_sel_hi:[1,0]
    v_pk_mul_f32 v[68:69], v[68:69], v[226:227] op_sel:[0,0] op_sel_hi:[1,0]
    v_pk_mul_f32 v[70:71], v[70:71], v[226:227] op_sel:[0,0] op_sel_hi:[1,0]
    v_cvt_pk_bf16_f32 v88, v20, v21
    v_cvt_pk_bf16_f32 v89, v22, v23
    v_cvt_pk_bf16_f32 v90, v36, v37
    v_cvt_pk_bf16_f32 v91, v38, v39
    v_cvt_pk_bf16_f32 v92, v52, v53
    v_cvt_pk_bf16_f32 v93, v54, v55
    v_cvt_pk_bf16_f32 v94, v68, v69
    v_cvt_pk_bf16_f32 v95, v70, v71
    buffer_store_dwordx2 v[88:89], v238, s[36:39], 0 offen offset:128 sc1
    buffer_store_dwordx2 v[90:91], v238, s[36:39], s74 offen offset:128 sc1
    buffer_store_dwordx2 v[92:93], v238, s[36:39], s75 offen offset:128 sc1
    buffer_store_dwordx2 v[94:95], v238, s[36:39], s76 offen offset:128 sc1
    v_pk_fma_f32 v[24:25], v[208:209], v[228:229], v[24:25] op_sel:[0,1,0] op_sel_hi:[1,1,1]
    v_pk_fma_f32 v[26:27], v[210:211], v[228:229], v[26:27] op_sel:[0,1,0] op_sel_hi:[1,1,1]
    v_pk_fma_f32 v[40:41], v[212:213], v[228:229], v[40:41] op_sel:[0,1,0] op_sel_hi:[1,1,1]
    v_pk_fma_f32 v[42:43], v[214:215], v[228:229], v[42:43] op_sel:[0,1,0] op_sel_hi:[1,1,1]
    v_pk_fma_f32 v[56:57], v[216:217], v[228:229], v[56:57] op_sel:[0,1,0] op_sel_hi:[1,1,1]
    v_pk_fma_f32 v[58:59], v[218:219], v[228:229], v[58:59] op_sel:[0,1,0] op_sel_hi:[1,1,1]
    v_pk_fma_f32 v[72:73], v[220:221], v[228:229], v[72:73] op_sel:[0,1,0] op_sel_hi:[1,1,1]
    v_pk_fma_f32 v[74:75], v[222:223], v[228:229], v[74:75] op_sel:[0,1,0] op_sel_hi:[1,1,1]
    v_pk_mul_f32 v[24:25], v[24:25], v[228:229] op_sel:[0,0] op_sel_hi:[1,0]
    v_pk_mul_f32 v[26:27], v[26:27], v[228:229] op_sel:[0,0] op_sel_hi:[1,0]
    v_pk_mul_f32 v[40:41], v[40:41], v[228:229] op_sel:[0,0] op_sel_hi:[1,0]
    v_pk_mul_f32 v[42:43], v[42:43], v[228:229] op_sel:[0,0] op_sel_hi:[1,0]
    v_pk_mul_f32 v[56:57], v[56:57], v[228:229] op_sel:[0,0] op_sel_hi:[1,0]
    v_pk_mul_f32 v[58:59], v[58:59], v[228:229] op_sel:[0,0] op_sel_hi:[1,0]
    v_pk_mul_f32 v[72:73], v[72:73], v[228:229] op_sel:[0,0] op_sel_hi:[1,0]
    v_pk_mul_f32 v[74:75], v[74:75], v[228:229] op_sel:[0,0] op_sel_hi:[1,0]
    v_cvt_pk_bf16_f32 v96, v24, v25
    v_cvt_pk_bf16_f32 v97, v26, v27
    v_cvt_pk_bf16_f32 v98, v40, v41
    v_cvt_pk_bf16_f32 v99, v42, v43
    v_cvt_pk_bf16_f32 v100, v56, v57
    v_cvt_pk_bf16_f32 v101, v58, v59
    v_cvt_pk_bf16_f32 v102, v72, v73
    v_cvt_pk_bf16_f32 v103, v74, v75
    buffer_store_dwordx2 v[96:97], v238, s[36:39], 0 offen offset:256 sc1
    buffer_store_dwordx2 v[98:99], v238, s[36:39], s74 offen offset:256 sc1
    buffer_store_dwordx2 v[100:101], v238, s[36:39], s75 offen offset:256 sc1
    buffer_store_dwordx2 v[102:103], v238, s[36:39], s76 offen offset:256 sc1
    v_pk_fma_f32 v[28:29], v[208:209], v[230:231], v[28:29] op_sel:[0,1,0] op_sel_hi:[1,1,1]
    v_pk_fma_f32 v[30:31], v[210:211], v[230:231], v[30:31] op_sel:[0,1,0] op_sel_hi:[1,1,1]
    v_pk_fma_f32 v[44:45], v[212:213], v[230:231], v[44:45] op_sel:[0,1,0] op_sel_hi:[1,1,1]
    v_pk_fma_f32 v[46:47], v[214:215], v[230:231], v[46:47] op_sel:[0,1,0] op_sel_hi:[1,1,1]
    v_pk_fma_f32 v[60:61], v[216:217], v[230:231], v[60:61] op_sel:[0,1,0] op_sel_hi:[1,1,1]
    v_pk_fma_f32 v[62:63], v[218:219], v[230:231], v[62:63] op_sel:[0,1,0] op_sel_hi:[1,1,1]
    v_pk_fma_f32 v[76:77], v[220:221], v[230:231], v[76:77] op_sel:[0,1,0] op_sel_hi:[1,1,1]
    v_pk_fma_f32 v[78:79], v[222:223], v[230:231], v[78:79] op_sel:[0,1,0] op_sel_hi:[1,1,1]
    v_pk_mul_f32 v[28:29], v[28:29], v[230:231] op_sel:[0,0] op_sel_hi:[1,0]
    v_pk_mul_f32 v[30:31], v[30:31], v[230:231] op_sel:[0,0] op_sel_hi:[1,0]
    v_pk_mul_f32 v[44:45], v[44:45], v[230:231] op_sel:[0,0] op_sel_hi:[1,0]
    v_pk_mul_f32 v[46:47], v[46:47], v[230:231] op_sel:[0,0] op_sel_hi:[1,0]
    v_pk_mul_f32 v[60:61], v[60:61], v[230:231] op_sel:[0,0] op_sel_hi:[1,0]
    v_pk_mul_f32 v[62:63], v[62:63], v[230:231] op_sel:[0,0] op_sel_hi:[1,0]
    v_pk_mul_f32 v[76:77], v[76:77], v[230:231] op_sel:[0,0] op_sel_hi:[1,0]
    v_pk_mul_f32 v[78:79], v[78:79], v[230:231] op_sel:[0,0] op_sel_hi:[1,0]
    v_cvt_pk_bf16_f32 v104, v28, v29
    v_cvt_pk_bf16_f32 v105, v30, v31
    v_cvt_pk_bf16_f32 v106, v44, v45
    v_cvt_pk_bf16_f32 v107, v46, v47
    v_cvt_pk_bf16_f32 v108, v60, v61
    v_cvt_pk_bf16_f32 v109, v62, v63
    v_cvt_pk_bf16_f32 v110, v76, v77
    v_cvt_pk_bf16_f32 v111, v78, v79
    buffer_store_dwordx2 v[104:105], v238, s[36:39], 0 offen offset:384 sc1
    buffer_store_dwordx2 v[106:107], v238, s[36:39], s74 offen offset:384 sc1
    buffer_store_dwordx2 v[108:109], v238, s[36:39], s75 offen offset:384 sc1
    buffer_store_dwordx2 v[110:111], v238, s[36:39], s76 offen offset:384 sc1
    v_mov_b32 v2, 159768
    ds_read_b64 v[2:3], v2
    s_add_u32 s48, s20, 51134464
    s_addc_u32 s49, s21, 0
    s_mov_b32 s50, 65536
    s_mov_b32 s51, 0x20000
    s_lshl_b32 s62, s23, 12
    s_lshl_b32 s63, s96, 7
    s_add_u32 s62, s62, s63
    v_mov_b32 v6, s62
    v_mov_b32 v7, 159744
    v_mov_b32 v8, 3
    s_getreg_b32 s63, hwreg(HW_REG_XCC_ID)
    s_and_b32 s63, s63, 15
    v_mov_b32 v4, s63
    v_mov_b32 v5, 0
    s_lshl_b32 s63, s3, 1
    s_add_u32 s63, s63, 2
    s_waitcnt lgkmcnt(0)
    v_add_u32 v2, s63, v2
    s_mov_b64 exec, 1
    s_waitcnt vmcnt(0)
    ds_inc_rtn_u32 v9, v7, v8
    s_waitcnt lgkmcnt(0)
    v_readfirstlane_b32 s61, v9
    s_nop 3
    s_cmp_lg_u32 s61, 3
    s_cbranch_scc1 ps_nosig_34
    s_mul_i32 s63, s3, 3
    s_sub_u32 s63, s63, 1
    v_add_u32 v8, s63, v2
    v_mov_b32 v9, v3
    v_add_u32 v7, 32768, v6
    s_cmp_eq_u32 s0, 0
    s_cbranch_scc1 ps_glob_36
    buffer_store_dwordx2 v[8:9], v7, s[48:51], 0 offen
    s_branch ps_dual_37
ps_glob_36:
    buffer_store_dwordx2 v[8:9], v7, s[48:51], 0 offen sc1
ps_dual_37:
ps_ql0_35:
    buffer_store_dwordx4 v[2:5], v6, s[48:51], 0 offen sc1
ps_nosig_34:
    s_mov_b64 exec, -1
    s_cmp_lg_u32 s3, 0
    s_cbranch_scc1 ps_nort_38
    s_lshl_b32 s94, s22, 12
    s_add_u32 s94, s94, 65536
    v_lshlrev_b32 v2, 4, v0
    v_add_u32 v7, s94, v2
    v_lshrrev_b32 v3, 4, v0
    v_and_b32 v4, 15, v0
    v_lshrrev_b32 v5, 2, v4
    v_and_b32 v6, 1, v3
    v_lshl_add_u32 v6, v6, 2, v5
    v_lshrrev_b32 v3, 1, v3
    v_lshl_add_u32 v3, v3, 4, v6
    v_lshrrev_b32 v6, 1, v6
    v_and_b32 v6, 3, v6
    v_lshlrev_b32 v3, 7, v3
    v_and_b32 v4, 3, v4
    v_lshl_add_u32 v3, v4, 3, v3
    v_add_u32 v3, s94, v3
    v_xor_b32 v8, 0, v6
    v_lshl_add_u32 v10, v8, 5, v3
    v_xor_b32 v8, 1, v6
    v_lshl_add_u32 v11, v8, 5, v3
    v_xor_b32 v8, 2, v6
    v_lshl_add_u32 v12, v8, 5, v3
    v_xor_b32 v8, 3, v6
    v_lshl_add_u32 v13, v8, 5, v3
    s_waitcnt vmcnt(0)
    ds_write_b128 v7, v[144:147] offset:0
    ds_write_b128 v7, v[148:151] offset:1024
    ds_write_b128 v7, v[152:155] offset:2048
    ds_write_b128 v7, v[156:159] offset:3072
    s_waitcnt lgkmcnt(0)
    ds_read_b64_tr_b16 v[112:113], v10
    ds_read_b64_tr_b16 v[114:115], v10 offset:1024
    ds_read_b64_tr_b16 v[120:121], v11
    ds_read_b64_tr_b16 v[122:123], v11 offset:1024
    ds_read_b64_tr_b16 v[128:129], v12
    ds_read_b64_tr_b16 v[130:131], v12 offset:1024
    ds_read_b64_tr_b16 v[136:137], v13
    ds_read_b64_tr_b16 v[138:139], v13 offset:1024
    s_waitcnt lgkmcnt(0)
    ds_write_b128 v7, v[160:163] offset:0
    ds_write_b128 v7, v[164:167] offset:1024
    ds_write_b128 v7, v[168:171] offset:2048
    ds_write_b128 v7, v[172:175] offset:3072
    s_waitcnt lgkmcnt(0)
    ds_read_b64_tr_b16 v[116:117], v10
    ds_read_b64_tr_b16 v[118:119], v10 offset:1024
    ds_read_b64_tr_b16 v[124:125], v11
    ds_read_b64_tr_b16 v[126:127], v11 offset:1024
    ds_read_b64_tr_b16 v[132:133], v12
    ds_read_b64_tr_b16 v[134:135], v12 offset:1024
    ds_read_b64_tr_b16 v[140:141], v13
    ds_read_b64_tr_b16 v[142:143], v13 offset:1024
    s_waitcnt lgkmcnt(0)
    v_mov_b32 v16, 0x3f803f80
    v_mov_b32 v17, 0x3f803f80
    v_mov_b32 v18, 0x3f803f80
    v_mov_b32 v19, 0x3f803f80
    s_nop 1
    v_mfma_f32_16x16x32_bf16 v[176:179], v[112:115], v[16:19], 0
    v_mfma_f32_16x16x32_bf16 v[176:179], v[116:119], v[16:19], v[176:179]
    v_mfma_f32_16x16x32_bf16 v[180:183], v[120:123], v[16:19], 0
    v_mfma_f32_16x16x32_bf16 v[180:183], v[124:127], v[16:19], v[180:183]
    v_mfma_f32_16x16x32_bf16 v[184:187], v[128:131], v[16:19], 0
    v_mfma_f32_16x16x32_bf16 v[184:187], v[132:135], v[16:19], v[184:187]
    v_mfma_f32_16x16x32_bf16 v[188:191], v[136:139], v[16:19], 0
    v_mfma_f32_16x16x32_bf16 v[188:191], v[140:143], v[16:19], v[188:191]
    s_mov_b32 s32, s80
    s_mov_b32 s33, s81
    s_mov_b32 s34, s82
    s_mov_b32 s35, s83
ps_nort_38:
    s_branch ps_att
ps_qx0_10:
    s_and_b32 s62, s96, 1
    s_lshl_b32 s63, s23, 1
    s_add_u32 s62, s62, s63
    s_lshl_b32 s52, s62, 7
    s_lshr_b32 s61, s96, 1
    s_lshl_b32 s53, s61, 7
    s_add_u32 s24, s4, 0
    s_addc_u32 s25, s5, 0
    s_add_u32 s26, s20, 26214400
    s_addc_u32 s27, s21, 0
    s_cmp_eq_u32 s3, 0
    s_cselect_b32 s24, s24, s26
    s_cselect_b32 s25, s25, s27
    s_mov_b32 s26, 2621440
    s_mov_b32 s27, 0x20000
    s_lshr_b32 s62, s52, 4
    s_mul_i32 s62, s62, 20480
    v_lshlrev_b32 v2, 4, v0
    v_add_u32 v2, s62, v2
    v_add_u32 v8, 0, v2
    v_add_u32 v10, 20480, v2
    v_add_u32 v12, 40960, v2
    v_add_u32 v14, 61440, v2
    v_add_u32 v8, 0, v2
    v_add_u32 v9, 1024, v2
    v_add_u32 v10, 20480, v2
    v_add_u32 v11, 21504, v2
    v_add_u32 v12, 40960, v2
    v_add_u32 v13, 41984, v2
    v_add_u32 v14, 61440, v2
    v_add_u32 v15, 62464, v2
    s_cmp_lg_u32 s3, 0
    s_cbranch_scc1 ps_xs16_39
    v_lshrrev_b32 v2, 3, v0
    v_and_b32 v3, 7, v0
    v_xor_b32 v3, v3, v2
    v_add_u32 v2, s52, v2
    v_mul_u32_u24 v2, 1280, v2
    v_lshl_add_u32 v2, v3, 4, v2
    v_add_u32 v8, 0, v2
    v_add_u32 v9, 10240, v2
    v_add_u32 v10, 20480, v2
    v_add_u32 v11, 30720, v2
    v_add_u32 v12, 40960, v2
    v_add_u32 v13, 51200, v2
    v_add_u32 v14, 61440, v2
    v_add_u32 v15, 71680, v2
ps_xs16_39:
    s_cmp_eq_u32 s3, 0
    s_cselect_b32 s79, 128, 0
    s_cselect_b32 s78, 0, 1
    s_lshl_b32 s78, s78, 11
    s_add_u32 s79, s79, s78
    s_mov_b32 s83, 0
    s_mov_b32 s54, 0
    s_mov_b32 s55, 0
    s_cmp_eq_u32 s3, 0
    s_cbranch_scc1 ps_nodep_40
    s_mul_i32 s60, s3, 5
    s_add_u32 s60, s60, 0
    s_and_b32 s43, s96, 1
    s_lshl_b32 s43, s43, 1
    s_mov_b32 s62, 0xcccccccc
    s_lshr_b32 s43, s62, s43
    s_add_u32 s48, s20, 51134464
    s_addc_u32 s49, s21, 0
    s_mov_b32 s50, 65536
    s_mov_b32 s51, 0x20000
    v_mov_b32 v50, 159768
    ds_read_b64 v[50:51], v50
    s_lshl_b32 s62, s23, 12
    s_add_u32 s62, s62, 32768
    v_and_b32 v48, 31, v0
    v_lshlrev_b32 v48, 7, v48
    v_add_u32 v48, s62, v48
    s_mov_b32 s42, 0
    s_waitcnt lgkmcnt(0)
ps_gw_41:
    buffer_load_dwordx2 v[52:53], v48, s[48:51], 0 offen sc1
    s_waitcnt vmcnt(0)
    v_sub_u32 v49, v52, v50
    v_subrev_u32 v49, s60, v49
    s_sub_u32 s63, 16, s60
    v_cmp_eq_u32 s[40:41], v53, v51
    v_cmp_gt_u32 vcc, s63, v49
    s_nop 3
    s_and_b64 vcc, vcc, s[40:41]
    s_or_b32 vcc_lo, vcc_lo, s43
    s_or_b32 vcc_hi, vcc_hi, s43
    s_cmp_eq_u64 vcc, -1
    s_cbranch_scc1 ps_gok_42
ps_ga_43:
    s_sleep 1
    s_add_u32 s42, s42, 1
    s_cmp_lt_u32 s42, 0x20000
    s_cbranch_scc1 ps_gw_41
ps_gok_42:
    v_mov_b32 v48, 159748
    v_mov_b32 v49, s60
    ds_write_b32 v48, v49
ps_nodep_40:
    s_add_u32 m0, s55, 0
    s_nop 0
    buffer_load_dwordx4 v8, s[24:27], s54 offen sc1 lds
    s_add_u32 m0, s55, 1024
    s_nop 0
    buffer_load_dwordx4 v9, s[24:27], s54 offen sc1 lds
    s_add_u32 m0, s55, 2048
    s_nop 0
    buffer_load_dwordx4 v10, s[24:27], s54 offen sc1 lds
    s_add_u32 m0, s55, 3072
    s_nop 0
    buffer_load_dwordx4 v11, s[24:27], s54 offen sc1 lds
    s_add_u32 m0, s55, 4096
    s_nop 0
    buffer_load_dwordx4 v12, s[24:27], s54 offen sc1 lds
    s_add_u32 m0, s55, 5120
    s_nop 0
    buffer_load_dwordx4 v13, s[24:27], s54 offen sc1 lds
    s_add_u32 m0, s55, 6144
    s_nop 0
    buffer_load_dwordx4 v14, s[24:27], s54 offen sc1 lds
    s_add_u32 m0, s55, 7168
    s_nop 0
    buffer_load_dwordx4 v15, s[24:27], s54 offen sc1 lds
    s_add_u32 s54, s54, s79
    s_add_u32 s55, s55, 16384
    s_cmp_eq_u32 s55, 65536
    s_cselect_b32 s55, 0, s55
    s_add_u32 m0, s55, 0
    s_nop 0
    buffer_load_dwordx4 v8, s[24:27], s54 offen sc1 lds
    s_add_u32 m0, s55, 1024
    s_nop 0
    buffer_load_dwordx4 v9, s[24:27], s54 offen sc1 lds
    s_add_u32 m0, s55, 2048
    s_nop 0
    buffer_load_dwordx4 v10, s[24:27], s54 offen sc1 lds
    s_add_u32 m0, s55, 3072
    s_nop 0
    buffer_load_dwordx4 v11, s[24:27], s54 offen sc1 lds
    s_add_u32 m0, s55, 4096
    s_nop 0
    buffer_load_dwordx4 v12, s[24:27], s54 offen sc1 lds
    s_add_u32 m0, s55, 5120
    s_nop 0
    buffer_load_dwordx4 v13, s[24:27], s54 offen sc1 lds
    s_add_u32 m0, s55, 6144
    s_nop 0
    buffer_load_dwordx4 v14, s[24:27], s54 offen sc1 lds
    s_add_u32 m0, s55, 7168
    s_nop 0
    buffer_load_dwordx4 v15, s[24:27], s54 offen sc1 lds
    s_add_u32 s54, s54, s79
    s_add_u32 s55, s55, 16384
    s_cmp_eq_u32 s55, 65536
    s_cselect_b32 s55, 0, s55
    s_add_u32 m0, s55, 0
    s_nop 0
    buffer_load_dwordx4 v8, s[24:27], s54 offen sc1 lds
    s_add_u32 m0, s55, 1024
    s_nop 0
    buffer_load_dwordx4 v9, s[24:27], s54 offen sc1 lds
    s_add_u32 m0, s55, 2048
    s_nop 0
    buffer_load_dwordx4 v10, s[24:27], s54 offen sc1 lds
    s_add_u32 m0, s55, 3072
    s_nop 0
    buffer_load_dwordx4 v11, s[24:27], s54 offen sc1 lds
    s_add_u32 m0, s55, 4096
    s_nop 0
    buffer_load_dwordx4 v12, s[24:27], s54 offen sc1 lds
    s_add_u32 m0, s55, 5120
    s_nop 0
    buffer_load_dwordx4 v13, s[24:27], s54 offen sc1 lds
    s_add_u32 m0, s55, 6144
    s_nop 0
    buffer_load_dwordx4 v14, s[24:27], s54 offen sc1 lds
    s_add_u32 m0, s55, 7168
    s_nop 0
    buffer_load_dwordx4 v15, s[24:27], s54 offen sc1 lds
    s_add_u32 s54, s54, s79
    s_add_u32 s55, s55, 16384
    s_cmp_eq_u32 s55, 65536
    s_cselect_b32 s55, 0, s55
    s_waitcnt vmcnt(16)
    s_barrier
    s_mov_b32 s57, 7
ps_ldl_44:
    s_cmp_lg_u32 s57, 3
    s_cbranch_scc1 ps_hk_45
    s_cmp_lg_u32 s3, 0
    s_cbranch_scc1 ps_hk_45
    s_add_u32 s48, s20, 51134464
    s_addc_u32 s49, s21, 0
    s_mov_b32 s50, 65536
    s_mov_b32 s51, 0x20000
    v_mov_b32 v50, 159768
    ds_read_b64 v[50:51], v50
    s_lshl_b32 s62, s23, 12
    v_and_b32 v48, 31, v0
    v_lshlrev_b32 v48, 7, v48
    v_add_u32 v48, s62, v48
    buffer_load_dwordx4 v[52:55], v48, s[48:51], 0 offen sc1
ps_hk_45:
    s_add_u32 m0, s55, 0
    s_nop 0
    buffer_load_dwordx4 v8, s[24:27], s54 offen sc1 lds
    s_add_u32 m0, s55, 1024
    s_nop 0
    buffer_load_dwordx4 v9, s[24:27], s54 offen sc1 lds
    s_add_u32 m0, s55, 2048
    s_nop 0
    buffer_load_dwordx4 v10, s[24:27], s54 offen sc1 lds
    s_add_u32 m0, s55, 3072
    s_nop 0
    buffer_load_dwordx4 v11, s[24:27], s54 offen sc1 lds
    s_add_u32 m0, s55, 4096
    s_nop 0
    buffer_load_dwordx4 v12, s[24:27], s54 offen sc1 lds
    s_add_u32 m0, s55, 5120
    s_nop 0
    buffer_load_dwordx4 v13, s[24:27], s54 offen sc1 lds
    s_add_u32 m0, s55, 6144
    s_nop 0
    buffer_load_dwordx4 v14, s[24:27], s54 offen sc1 lds
    s_add_u32 m0, s55, 7168
    s_nop 0
    buffer_load_dwordx4 v15, s[24:27], s54 offen sc1 lds
    s_add_u32 s54, s54, s79
    s_add_u32 s55, s55, 16384
    s_cmp_eq_u32 s55, 65536
    s_cselect_b32 s55, 0, s55
    s_waitcnt vmcnt(16)
    s_cmp_lg_u32 s57, 1
    s_cbranch_scc1 ps_hk_46
    s_cmp_lg_u32 s3, 0
    s_cbranch_scc1 ps_hk_46
    s_mov_b32 s60, 1
    s_waitcnt lgkmcnt(0)
    v_sub_u32 v49, v52, v50
    v_subrev_u32 v49, s60, v49
    s_sub_u32 s63, 16, s60
    v_cmp_eq_u32 s[40:41], v53, v51
    v_cmp_gt_u32 vcc, s63, v49
    s_nop 3
    s_and_b64 vcc, vcc, s[40:41]
    s_cmp_eq_u64 vcc, -1
    s_cbranch_scc0 ps_hno_47
    s_mov_b32 s83, 1
    s_getreg_b32 s62, hwreg(HW_REG_XCC_ID)
    s_and_b32 s62, s62, 15
    v_cmp_ne_u32 vcc, s62, v54
    s_nop 3
    s_cmp_eq_u32 vcc_lo, 0
    s_cselect_b32 s63, 1, 0
    v_mov_b32 v48, 159752
    v_mov_b32 v49, s63
    ds_write_b32 v48, v49
    v_mov_b32 v48, 159756
    v_mov_b32 v49, 1
    ds_write_b32 v48, v49
ps_hno_47:
ps_hk_46:
    s_sub_u32 s57, s57, 1
    s_cmp_lg_u32 s57, 0
    s_barrier
    s_cbranch_scc1 ps_ldl_44
    s_cmp_lg_u32 s3, 0
    s_cbranch_scc1 ps_epi0_48
    s_cmp_lg_u32 s83, 0
    s_cbranch_scc1 ps_epi0ok_49
    s_mov_b32 s60, 1
    s_add_u32 s48, s20, 51134464
    s_addc_u32 s49, s21, 0
    s_mov_b32 s50, 65536
    s_mov_b32 s51, 0x20000
    v_mov_b32 v50, 159768
    ds_read_b64 v[50:51], v50
    s_lshl_b32 s62, s23, 12
    v_and_b32 v48, 31, v0
    v_lshlrev_b32 v48, 7, v48
    v_add_u32 v48, s62, v48
    s_mov_b32 s42, 0
    s_waitcnt lgkmcnt(0)
ps_gw_50:
    buffer_load_dwordx4 v[52:55], v48, s[48:51], 0 offen sc1
    s_waitcnt vmcnt(0)
    v_sub_u32 v49, v52, v50
    v_subrev_u32 v49, s60, v49
    s_sub_u32 s63, 16, s60
    v_cmp_eq_u32 s[40:41], v53, v51
    v_cmp_gt_u32 vcc, s63, v49
    s_nop 3
    s_and_b64 vcc, vcc, s[40:41]
    s_cmp_eq_u64 vcc, -1
    s_cbranch_scc1 ps_gok_51
ps_ga_52:
    s_sleep 1
    s_add_u32 s42, s42, 1
    s_cmp_lt_u32 s42, 0x20000
    s_cbranch_scc1 ps_gw_50
ps_gok_51:
    s_getreg_b32 s62, hwreg(HW_REG_XCC_ID)
    s_and_b32 s62, s62, 15
    v_cmp_ne_u32 vcc, s62, v54
    s_nop 3
    s_cmp_eq_u32 vcc_lo, 0
    s_cselect_b32 s63, 1, 0
    v_mov_b32 v48, 159752
    v_mov_b32 v49, s63
    ds_write_b32 v48, v49
    v_mov_b32 v48, 159756
    v_mov_b32 v49, 1
    ds_write_b32 v48, v49
ps_epi0ok_49:
ps_epi0_48:
    s_mul_i32 s42, s3, 131072
    s_add_u32 s42, s42, 42991616
    s_add_u32 s40, s20, s42
    s_addc_u32 s41, s21, 0
    s_mov_b32 s42, 131072
    s_mov_b32 s43, 0x20000
    s_add_u32 s62, s52, 0
    v_add_u32 v2, s62, v0
    v_lshlrev_b32 v2, 6, v2
    buffer_load_dwordx4 v[56:59], v2, s[40:43], 0 offen offset:0 sc1
    buffer_load_dwordx4 v[60:63], v2, s[40:43], 0 offen offset:16 sc1
    buffer_load_dwordx4 v[64:67], v2, s[40:43], 0 offen offset:32 sc1
    buffer_load_dwordx4 v[68:71], v2, s[40:43], 0 offen offset:48 sc1
    s_waitcnt vmcnt(12)
    s_barrier
    s_waitcnt vmcnt(4)
    s_barrier
    s_waitcnt vmcnt(0)
    v_add_f32 v73, v56, v58
    v_add_f32 v72, v57, v59
    v_add_f32 v73, v73, v60
    v_add_f32 v72, v72, v61
    v_add_f32 v73, v73, v62
    v_add_f32 v72, v72, v63
    v_add_f32 v73, v73, v64
    v_add_f32 v72, v72, v65
    v_add_f32 v73, v73, v66
    v_add_f32 v72, v72, v67
    v_add_f32 v73, v73, v68
    v_add_f32 v72, v72, v69
    v_add_f32 v73, v73, v70
    v_add_f32 v72, v72, v71
    v_mul_f32 v73, 0xbacccccd, v73
    v_mov_b32 v74, 0x3c4ccccd
    v_fma_f32 v56, v56, v74, v73
    v_fma_f32 v58, v58, v74, v73
    v_fma_f32 v60, v60, v74, v73
    v_fma_f32 v62, v62, v74, v73
    v_fma_f32 v64, v64, v74, v73
    v_fma_f32 v66, v66, v74, v73
    v_fma_f32 v68, v68, v74, v73
    v_fma_f32 v70, v70, v74, v73
    v_mul_f32 v75, v56, v56
    v_fmac_f32 v75, v58, v58
    v_fmac_f32 v75, v60, v60
    v_fmac_f32 v75, v62, v62
    v_fmac_f32 v75, v64, v64
    v_fmac_f32 v75, v66, v66
    v_fmac_f32 v75, v68, v68
    v_fmac_f32 v75, v70, v70
    v_mov_b32 v56, 0x42a00000
    v_fma_f32 v72, v75, v56, v72
    v_mov_b32 v56, 0x3727c5ac
    v_mov_b32 v57, 0x3acccccd
    v_fma_f32 v72, v72, v57, v56
    v_rsq_f32 v72, v72
    s_cmp_lt_u32 s61, 5
    s_cselect_b32 s62, 0x3ea52b5c, 1.0
    v_mul_f32 v72, s62, v72
    v_lshlrev_b32 v2, 3, v0
    v_add_u32 v2, 160000, v2
    ds_write_b64 v2, v[72:73]
    s_waitcnt lgkmcnt(0)
    s_barrier
    s_branch ps_att
ps_qx1_11:
    s_and_b32 s62, s96, 1
    s_lshl_b32 s63, s23, 1
    s_add_u32 s62, s62, s63
    s_lshl_b32 s52, s62, 7
    s_lshr_b32 s61, s96, 1
    s_lshl_b32 s53, s61, 7
    s_add_u32 s24, s4, 0
    s_addc_u32 s25, s5, 0
    s_add_u32 s26, s20, 26214400
    s_addc_u32 s27, s21, 0
    s_cmp_eq_u32 s3, 0
    s_cselect_b32 s24, s24, s26
    s_cselect_b32 s25, s25, s27
    s_mov_b32 s26, 2621440
    s_mov_b32 s27, 0x20000
    s_lshr_b32 s62, s52, 4
    s_mul_i32 s62, s62, 20480
    v_lshlrev_b32 v2, 4, v0
    v_add_u32 v2, s62, v2
    v_add_u32 v8, 81920, v2
    v_add_u32 v10, 102400, v2
    v_add_u32 v12, 122880, v2
    v_add_u32 v14, 143360, v2
    v_add_u32 v8, 81920, v2
    v_add_u32 v9, 82944, v2
    v_add_u32 v10, 102400, v2
    v_add_u32 v11, 103424, v2
    v_add_u32 v12, 122880, v2
    v_add_u32 v13, 123904, v2
    v_add_u32 v14, 143360, v2
    v_add_u32 v15, 144384, v2
    s_cmp_lg_u32 s3, 0
    s_cbranch_scc1 ps_xs16_53
    v_lshrrev_b32 v2, 3, v0
    v_and_b32 v3, 7, v0
    v_xor_b32 v3, v3, v2
    v_add_u32 v2, s52, v2
    v_mul_u32_u24 v2, 1280, v2
    v_lshl_add_u32 v2, v3, 4, v2
    v_add_u32 v8, 81920, v2
    v_add_u32 v9, 92160, v2
    v_add_u32 v10, 102400, v2
    v_add_u32 v11, 112640, v2
    v_add_u32 v12, 122880, v2
    v_add_u32 v13, 133120, v2
    v_add_u32 v14, 143360, v2
    v_add_u32 v15, 153600, v2
ps_xs16_53:
    s_cmp_eq_u32 s3, 0
    s_cselect_b32 s79, 128, 0
    s_cselect_b32 s78, 0, 1
    s_lshl_b32 s78, s78, 11
    s_add_u32 s79, s79, s78
    s_mov_b32 s54, 0
    s_mov_b32 s55, 0
    s_cmp_eq_u32 s3, 0
    s_cbranch_scc1 ps_nodep_54
    s_mul_i32 s63, s3, 5
    s_add_u32 s63, s63, 0
    v_mov_b32 v48, 159748
    s_mov_b32 s64, 0
ps_lw_55:
    ds_read_b32 v49, v48
    s_add_u32 s64, s64, 1
    s_waitcnt lgkmcnt(0)
    v_cmp_gt_u32 vcc, s63, v49
    s_cbranch_vccz ps_lok_56
    s_sleep 1
    s_cmp_lt_u32 s64, 0x200000
    s_cbranch_scc1 ps_lw_55
ps_lok_56:
ps_nodep_54:
    s_add_u32 m0, s55, 8192
    s_nop 0
    buffer_load_dwordx4 v8, s[24:27], s54 offen sc1 lds
    s_add_u32 m0, s55, 9216
    s_nop 0
    buffer_load_dwordx4 v9, s[24:27], s54 offen sc1 lds
    s_add_u32 m0, s55, 10240
    s_nop 0
    buffer_load_dwordx4 v10, s[24:27], s54 offen sc1 lds
    s_add_u32 m0, s55, 11264
    s_nop 0
    buffer_load_dwordx4 v11, s[24:27], s54 offen sc1 lds
    s_add_u32 m0, s55, 12288
    s_nop 0
    buffer_load_dwordx4 v12, s[24:27], s54 offen sc1 lds
    s_add_u32 m0, s55, 13312
    s_nop 0
    buffer_load_dwordx4 v13, s[24:27], s54 offen sc1 lds
    s_add_u32 m0, s55, 14336
    s_nop 0
    buffer_load_dwordx4 v14, s[24:27], s54 offen sc1 lds
    s_add_u32 m0, s55, 15360
    s_nop 0
    buffer_load_dwordx4 v15, s[24:27], s54 offen sc1 lds
    s_add_u32 s54, s54, s79
    s_add_u32 s55, s55, 16384
    s_cmp_eq_u32 s55, 65536
    s_cselect_b32 s55, 0, s55
    s_add_u32 m0, s55, 8192
    s_nop 0
    buffer_load_dwordx4 v8, s[24:27], s54 offen sc1 lds
    s_add_u32 m0, s55, 9216
    s_nop 0
    buffer_load_dwordx4 v9, s[24:27], s54 offen sc1 lds
    s_add_u32 m0, s55, 10240
    s_nop 0
    buffer_load_dwordx4 v10, s[24:27], s54 offen sc1 lds
    s_add_u32 m0, s55, 11264
    s_nop 0
    buffer_load_dwordx4 v11, s[24:27], s54 offen sc1 lds
    s_add_u32 m0, s55, 12288
    s_nop 0
    buffer_load_dwordx4 v12, s[24:27], s54 offen sc1 lds
    s_add_u32 m0, s55, 13312
    s_nop 0
    buffer_load_dwordx4 v13, s[24:27], s54 offen sc1 lds
    s_add_u32 m0, s55, 14336
    s_nop 0
    buffer_load_dwordx4 v14, s[24:27], s54 offen sc1 lds
    s_add_u32 m0, s55, 15360
    s_nop 0
    buffer_load_dwordx4 v15, s[24:27], s54 offen sc1 lds
    s_add_u32 s54, s54, s79
    s_add_u32 s55, s55, 16384
    s_cmp_eq_u32 s55, 65536
    s_cselect_b32 s55, 0, s55
    s_add_u32 m0, s55, 8192
    s_nop 0
    buffer_load_dwordx4 v8, s[24:27], s54 offen sc1 lds
    s_add_u32 m0, s55, 9216
    s_nop 0
    buffer_load_dwordx4 v9, s[24:27], s54 offen sc1 lds
    s_add_u32 m0, s55, 10240
    s_nop 0
    buffer_load_dwordx4 v10, s[24:27], s54 offen sc1 lds
    s_add_u32 m0, s55, 11264
    s_nop 0
    buffer_load_dwordx4 v11, s[24:27], s54 offen sc1 lds
    s_add_u32 m0, s55, 12288
    s_nop 0
    buffer_load_dwordx4 v12, s[24:27], s54 offen sc1 lds
    s_add_u32 m0, s55, 13312
    s_nop 0
    buffer_load_dwordx4 v13, s[24:27], s54 offen sc1 lds
    s_add_u32 m0, s55, 14336
    s_nop 0
    buffer_load_dwordx4 v14, s[24:27], s54 offen sc1 lds
    s_add_u32 m0, s55, 15360
    s_nop 0
    buffer_load_dwordx4 v15, s[24:27], s54 offen sc1 lds
    s_add_u32 s54, s54, s79
    s_add_u32 s55, s55, 16384
    s_cmp_eq_u32 s55, 65536
    s_cselect_b32 s55, 0, s55
    s_waitcnt vmcnt(16)
    s_barrier
    s_mov_b32 s57, 7
ps_ldl_57:
    s_add_u32 m0, s55, 8192
    s_nop 0
    buffer_load_dwordx4 v8, s[24:27], s54 offen sc1 lds
    s_add_u32 m0, s55, 9216
    s_nop 0
    buffer_load_dwordx4 v9, s[24:27], s54 offen sc1 lds
    s_add_u32 m0, s55, 10240
    s_nop 0
    buffer_load_dwordx4 v10, s[24:27], s54 offen sc1 lds
    s_add_u32 m0, s55, 11264
    s_nop 0
    buffer_load_dwordx4 v11, s[24:27], s54 offen sc1 lds
    s_add_u32 m0, s55, 12288
    s_nop 0
    buffer_load_dwordx4 v12, s[24:27], s54 offen sc1 lds
    s_add_u32 m0, s55, 13312
    s_nop 0
    buffer_load_dwordx4 v13, s[24:27], s54 offen sc1 lds
    s_add_u32 m0, s55, 14336
    s_nop 0
    buffer_load_dwordx4 v14, s[24:27], s54 offen sc1 lds
    s_add_u32 m0, s55, 15360
    s_nop 0
    buffer_load_dwordx4 v15, s[24:27], s54 offen sc1 lds
    s_add_u32 s54, s54, s79
    s_add_u32 s55, s55, 16384
    s_cmp_eq_u32 s55, 65536
    s_cselect_b32 s55, 0, s55
    s_waitcnt vmcnt(16)
    s_sub_u32 s57, s57, 1
    s_cmp_lg_u32 s57, 0
    s_barrier
    s_cbranch_scc1 ps_ldl_57
    s_cmp_lg_u32 s3, 0
    s_cbranch_scc1 ps_epi0_58
    v_mov_b32 v48, 159756
    s_mov_b32 s64, 0
ps_lw_59:
    ds_read_b32 v49, v48
    s_add_u32 s64, s64, 1
    s_waitcnt lgkmcnt(0)
    v_cmp_gt_u32 vcc, 1, v49
    s_cbranch_vccz ps_lok_60
    s_sleep 1
    s_cmp_lt_u32 s64, 0x200000
    s_cbranch_scc1 ps_lw_59
ps_lok_60:
ps_epi0_58:
    s_mul_i32 s42, s3, 131072
    s_add_u32 s42, s42, 42991616
    s_add_u32 s40, s20, s42
    s_addc_u32 s41, s21, 0
    s_mov_b32 s42, 131072
    s_mov_b32 s43, 0x20000
    s_add_u32 s62, s52, 64
    v_add_u32 v2, s62, v0
    v_lshlrev_b32 v2, 6, v2
    buffer_load_dwordx4 v[56:59], v2, s[40:43], 0 offen offset:0 sc1
    buffer_load_dwordx4 v[60:63], v2, s[40:43], 0 offen offset:16 sc1
    buffer_load_dwordx4 v[64:67], v2, s[40:43], 0 offen offset:32 sc1
    buffer_load_dwordx4 v[68:71], v2, s[40:43], 0 offen offset:48 sc1
    s_waitcnt vmcnt(12)
    s_barrier
    s_waitcnt vmcnt(4)
    s_barrier
    s_waitcnt vmcnt(0)
    v_add_f32 v73, v56, v58
    v_add_f32 v72, v57, v59
    v_add_f32 v73, v73, v60
    v_add_f32 v72, v72, v61
    v_add_f32 v73, v73, v62
    v_add_f32 v72, v72, v63
    v_add_f32 v73, v73, v64
    v_add_f32 v72, v72, v65
    v_add_f32 v73, v73, v66
    v_add_f32 v72, v72, v67
    v_add_f32 v73, v73, v68
    v_add_f32 v72, v72, v69
    v_add_f32 v73, v73, v70
    v_add_f32 v72, v72, v71
    v_mul_f32 v73, 0xbacccccd, v73
    v_mov_b32 v74, 0x3c4ccccd
    v_fma_f32 v56, v56, v74, v73
    v_fma_f32 v58, v58, v74, v73
    v_fma_f32 v60, v60, v74, v73
    v_fma_f32 v62, v62, v74, v73
    v_fma_f32 v64, v64, v74, v73
    v_fma_f32 v66, v66, v74, v73
    v_fma_f32 v68, v68, v74, v73
    v_fma_f32 v70, v70, v74, v73
    v_mul_f32 v75, v56, v56
    v_fmac_f32 v75, v58, v58
    v_fmac_f32 v75, v60, v60
    v_fmac_f32 v75, v62, v62
    v_fmac_f32 v75, v64, v64
    v_fmac_f32 v75, v66, v66
    v_fmac_f32 v75, v68, v68
    v_fmac_f32 v75, v70, v70
    v_mov_b32 v56, 0x42a00000
    v_fma_f32 v72, v75, v56, v72
    v_mov_b32 v56, 0x3727c5ac
    v_mov_b32 v57, 0x3acccccd
    v_fma_f32 v72, v72, v57, v56
    v_rsq_f32 v72, v72
    s_cmp_lt_u32 s61, 5
    s_cselect_b32 s62, 0x3ea52b5c, 1.0
    v_mul_f32 v72, s62, v72
    v_lshlrev_b32 v2, 3, v0
    v_add_u32 v2, 160512, v2
    ds_write_b64 v2, v[72:73]
    s_waitcnt lgkmcnt(0)
    s_barrier
    s_branch ps_att
ps_qw0_12:
    s_and_b32 s62, s96, 1
    s_lshl_b32 s63, s23, 1
    s_add_u32 s62, s62, s63
    s_lshl_b32 s52, s62, 7
    s_lshr_b32 s61, s96, 1
    s_lshl_b32 s53, s61, 7
    s_mov_b32 s28, s6
    s_mov_b32 s29, s7
    s_mov_b32 s30, 2457600
    s_mov_b32 s31, 0x20000
    v_lshrrev_b32 v3, 4, v0
    v_add_u32 v3, 0, v3
    v_and_b32 v4, 15, v0
    v_lshrrev_b32 v5, 1, v4
    v_and_b32 v6, 7, v3
    v_xor_b32 v5, v5, v6
    v_and_b32 v4, 1, v4
    v_lshl_or_b32 v4, v5, 1, v4
    v_and_b32 v5, 0x33, v3
    v_and_b32 v6, 4, v3
    v_lshl_or_b32 v5, v6, 1, v5
    v_and_b32 v6, 8, v3
    v_lshrrev_b32 v6, 1, v6
    v_or_b32 v5, v5, v6
    v_mul_u32_u24 v5, 3840, v5
    v_lshl_add_u32 v5, v4, 4, v5
    s_lshl_b32 s63, s53, 1
    v_add_u32 v8, s63, v5
    v_lshrrev_b32 v3, 4, v0
    v_add_u32 v3, 4, v3
    v_and_b32 v4, 15, v0
    v_lshrrev_b32 v5, 1, v4
    v_and_b32 v6, 7, v3
    v_xor_b32 v5, v5, v6
    v_and_b32 v4, 1, v4
    v_lshl_or_b32 v4, v5, 1, v4
    v_and_b32 v5, 0x33, v3
    v_and_b32 v6, 4, v3
    v_lshl_or_b32 v5, v6, 1, v5
    v_and_b32 v6, 8, v3
    v_lshrrev_b32 v6, 1, v6
    v_or_b32 v5, v5, v6
    v_mul_u32_u24 v5, 3840, v5
    v_lshl_add_u32 v5, v4, 4, v5
    s_lshl_b32 s63, s53, 1
    v_add_u32 v9, s63, v5
    v_lshrrev_b32 v3, 4, v0
    v_add_u32 v3, 8, v3
    v_and_b32 v4, 15, v0
    v_lshrrev_b32 v5, 1, v4
    v_and_b32 v6, 7, v3
    v_xor_b32 v5, v5, v6
    v_and_b32 v4, 1, v4
    v_lshl_or_b32 v4, v5, 1, v4
    v_and_b32 v5, 0x33, v3
    v_and_b32 v6, 4, v3
    v_lshl_or_b32 v5, v6, 1, v5
    v_and_b32 v6, 8, v3
    v_lshrrev_b32 v6, 1, v6
    v_or_b32 v5, v5, v6
    v_mul_u32_u24 v5, 3840, v5
    v_lshl_add_u32 v5, v4, 4, v5
    s_lshl_b32 s63, s53, 1
    v_add_u32 v10, s63, v5
    v_lshrrev_b32 v3, 4, v0
    v_add_u32 v3, 12, v3
    v_and_b32 v4, 15, v0
    v_lshrrev_b32 v5, 1, v4
    v_and_b32 v6, 7, v3
    v_xor_b32 v5, v5, v6
    v_and_b32 v4, 1, v4
    v_lshl_or_b32 v4, v5, 1, v4
    v_and_b32 v5, 0x33, v3
    v_and_b32 v6, 4, v3
    v_lshl_or_b32 v5, v6, 1, v5
    v_and_b32 v6, 8, v3
    v_lshrrev_b32 v6, 1, v6
    v_or_b32 v5, v5, v6
    v_mul_u32_u24 v5, 3840, v5
    v_lshl_add_u32 v5, v4, 4, v5
    s_lshl_b32 s63, s53, 1
    v_add_u32 v11, s63, v5
    v_lshrrev_b32 v3, 4, v0
    v_add_u32 v3, 16, v3
    v_and_b32 v4, 15, v0
    v_lshrrev_b32 v5, 1, v4
    v_and_b32 v6, 7, v3
    v_xor_b32 v5, v5, v6
    v_and_b32 v4, 1, v4
    v_lshl_or_b32 v4, v5, 1, v4
    v_and_b32 v5, 0x33, v3
    v_and_b32 v6, 4, v3
    v_lshl_or_b32 v5, v6, 1, v5
    v_and_b32 v6, 8, v3
    v_lshrrev_b32 v6, 1, v6
    v_or_b32 v5, v5, v6
    v_mul_u32_u24 v5, 3840, v5
    v_lshl_add_u32 v5, v4, 4, v5
    s_lshl_b32 s63, s53, 1
    v_add_u32 v12, s63, v5
    v_lshrrev_b32 v3, 4, v0
    v_add_u32 v3, 20, v3
    v_and_b32 v4, 15, v0
    v_lshrrev_b32 v5, 1, v4
    v_and_b32 v6, 7, v3
    v_xor_b32 v5, v5, v6
    v_and_b32 v4, 1, v4
    v_lshl_or_b32 v4, v5, 1, v4
    v_and_b32 v5, 0x33, v3
    v_and_b32 v6, 4, v3
    v_lshl_or_b32 v5, v6, 1, v5
    v_and_b32 v6, 8, v3
    v_lshrrev_b32 v6, 1, v6
    v_or_b32 v5, v5, v6
    v_mul_u32_u24 v5, 3840, v5
    v_lshl_add_u32 v5, v4, 4, v5
    s_lshl_b32 s63, s53, 1
    v_add_u32 v13, s63, v5
    v_lshrrev_b32 v3, 4, v0
    v_add_u32 v3, 24, v3
    v_and_b32 v4, 15, v0
    v_lshrrev_b32 v5, 1, v4
    v_and_b32 v6, 7, v3
    v_xor_b32 v5, v5, v6
    v_and_b32 v4, 1, v4
    v_lshl_or_b32 v4, v5, 1, v4
    v_and_b32 v5, 0x33, v3
    v_and_b32 v6, 4, v3
    v_lshl_or_b32 v5, v6, 1, v5
    v_and_b32 v6, 8, v3
    v_lshrrev_b32 v6, 1, v6
    v_or_b32 v5, v5, v6
    v_mul_u32_u24 v5, 3840, v5
    v_lshl_add_u32 v5, v4, 4, v5
    s_lshl_b32 s63, s53, 1
    v_add_u32 v14, s63, v5
    v_lshrrev_b32 v3, 4, v0
    v_add_u32 v3, 28, v3
    v_and_b32 v4, 15, v0
    v_lshrrev_b32 v5, 1, v4
    v_and_b32 v6, 7, v3
    v_xor_b32 v5, v5, v6
    v_and_b32 v4, 1, v4
    v_lshl_or_b32 v4, v5, 1, v4
    v_and_b32 v5, 0x33, v3
    v_and_b32 v6, 4, v3
    v_lshl_or_b32 v5, v6, 1, v5
    v_and_b32 v6, 8, v3
    v_lshrrev_b32 v6, 1, v6
    v_or_b32 v5, v5, v6
    v_mul_u32_u24 v5, 3840, v5
    v_lshl_add_u32 v5, v4, 4, v5
    s_lshl_b32 s63, s53, 1
    v_add_u32 v15, s63, v5
    s_mov_b32 s54, 0
    s_mov_b32 s55, 65536
    s_add_u32 m0, s55, 0
    s_nop 0
    buffer_load_dwordx4 v8, s[28:31], s54 offen lds
    s_add_u32 m0, s55, 1024
    s_nop 0
    buffer_load_dwordx4 v9, s[28:31], s54 offen lds
    s_add_u32 m0, s55, 2048
    s_nop 0
    buffer_load_dwordx4 v10, s[28:31], s54 offen lds
    s_add_u32 m0, s55, 3072
    s_nop 0
    buffer_load_dwordx4 v11, s[28:31], s54 offen lds
    s_add_u32 m0, s55, 4096
    s_nop 0
    buffer_load_dwordx4 v12, s[28:31], s54 offen lds
    s_add_u32 m0, s55, 5120
    s_nop 0
    buffer_load_dwordx4 v13, s[28:31], s54 offen lds
    s_add_u32 m0, s55, 6144
    s_nop 0
    buffer_load_dwordx4 v14, s[28:31], s54 offen lds
    s_add_u32 m0, s55, 7168
    s_nop 0
    buffer_load_dwordx4 v15, s[28:31], s54 offen lds
    s_add_u32 s54, s54, 245760
    s_add_u32 s55, s55, 16384
    s_cmp_eq_u32 s55, 131072
    s_cselect_b32 s55, 65536, s55
    s_add_u32 m0, s55, 0
    s_nop 0
    buffer_load_dwordx4 v8, s[28:31], s54 offen lds
    s_add_u32 m0, s55, 1024
    s_nop 0
    buffer_load_dwordx4 v9, s[28:31], s54 offen lds
    s_add_u32 m0, s55, 2048
    s_nop 0
    buffer_load_dwordx4 v10, s[28:31], s54 offen lds
    s_add_u32 m0, s55, 3072
    s_nop 0
    buffer_load_dwordx4 v11, s[28:31], s54 offen lds
    s_add_u32 m0, s55, 4096
    s_nop 0
    buffer_load_dwordx4 v12, s[28:31], s54 offen lds
    s_add_u32 m0, s55, 5120
    s_nop 0
    buffer_load_dwordx4 v13, s[28:31], s54 offen lds
    s_add_u32 m0, s55, 6144
    s_nop 0
    buffer_load_dwordx4 v14, s[28:31], s54 offen lds
    s_add_u32 m0, s55, 7168
    s_nop 0
    buffer_load_dwordx4 v15, s[28:31], s54 offen lds
    s_add_u32 s54, s54, 245760
    s_add_u32 s55, s55, 16384
    s_cmp_eq_u32 s55, 131072
    s_cselect_b32 s55, 65536, s55
    s_add_u32 m0, s55, 0
    s_nop 0
    buffer_load_dwordx4 v8, s[28:31], s54 offen lds
    s_add_u32 m0, s55, 1024
    s_nop 0
    buffer_load_dwordx4 v9, s[28:31], s54 offen lds
    s_add_u32 m0, s55, 2048
    s_nop 0
    buffer_load_dwordx4 v10, s[28:31], s54 offen lds
    s_add_u32 m0, s55, 3072
    s_nop 0
    buffer_load_dwordx4 v11, s[28:31], s54 offen lds
    s_add_u32 m0, s55, 4096
    s_nop 0
    buffer_load_dwordx4 v12, s[28:31], s54 offen lds
    s_add_u32 m0, s55, 5120
    s_nop 0
    buffer_load_dwordx4 v13, s[28:31], s54 offen lds
    s_add_u32 m0, s55, 6144
    s_nop 0
    buffer_load_dwordx4 v14, s[28:31], s54 offen lds
    s_add_u32 m0, s55, 7168
    s_nop 0
    buffer_load_dwordx4 v15, s[28:31], s54 offen lds
    s_add_u32 s54, s54, 245760
    s_add_u32 s55, s55, 16384
    s_cmp_eq_u32 s55, 131072
    s_cselect_b32 s55, 65536, s55
    s_waitcnt vmcnt(16)
    s_barrier
    s_mov_b32 s57, 7
ps_ldl_61:
    s_add_u32 m0, s55, 0
    s_nop 0
    buffer_load_dwordx4 v8, s[28:31], s54 offen lds
    s_add_u32 m0, s55, 1024
    s_nop 0
    buffer_load_dwordx4 v9, s[28:31], s54 offen lds
    s_add_u32 m0, s55, 2048
    s_nop 0
    buffer_load_dwordx4 v10, s[28:31], s54 offen lds
    s_add_u32 m0, s55, 3072
    s_nop 0
    buffer_load_dwordx4 v11, s[28:31], s54 offen lds
    s_add_u32 m0, s55, 4096
    s_nop 0
    buffer_load_dwordx4 v12, s[28:31], s54 offen lds
    s_add_u32 m0, s55, 5120
    s_nop 0
    buffer_load_dwordx4 v13, s[28:31], s54 offen lds
    s_add_u32 m0, s55, 6144
    s_nop 0
    buffer_load_dwordx4 v14, s[28:31], s54 offen lds
    s_add_u32 m0, s55, 7168
    s_nop 0
    buffer_load_dwordx4 v15, s[28:31], s54 offen lds
    s_add_u32 s54, s54, 245760
    s_add_u32 s55, s55, 16384
    s_cmp_eq_u32 s55, 131072
    s_cselect_b32 s55, 65536, s55
    s_waitcnt vmcnt(16)
    s_sub_u32 s57, s57, 1
    s_cmp_lg_u32 s57, 0
    s_barrier
    s_cbranch_scc1 ps_ldl_61
    s_waitcnt vmcnt(8)
    s_barrier
    s_waitcnt vmcnt(0)
    s_barrier
    s_barrier
    s_branch ps_att
ps_qw1_13:
    s_and_b32 s62, s96, 1
    s_lshl_b32 s63, s23, 1
    s_add_u32 s62, s62, s63
    s_lshl_b32 s52, s62, 7
    s_lshr_b32 s61, s96, 1
    s_lshl_b32 s53, s61, 7
    s_mov_b32 s28, s6
    s_mov_b32 s29, s7
    s_mov_b32 s30, 2457600
    s_mov_b32 s31, 0x20000
    v_lshrrev_b32 v3, 4, v0
    v_add_u32 v3, 32, v3
    v_and_b32 v4, 15, v0
    v_lshrrev_b32 v5, 1, v4
    v_and_b32 v6, 7, v3
    v_xor_b32 v5, v5, v6
    v_and_b32 v4, 1, v4
    v_lshl_or_b32 v4, v5, 1, v4
    v_and_b32 v5, 0x33, v3
    v_and_b32 v6, 4, v3
    v_lshl_or_b32 v5, v6, 1, v5
    v_and_b32 v6, 8, v3
    v_lshrrev_b32 v6, 1, v6
    v_or_b32 v5, v5, v6
    v_mul_u32_u24 v5, 3840, v5
    v_lshl_add_u32 v5, v4, 4, v5
    s_lshl_b32 s63, s53, 1
    v_add_u32 v8, s63, v5
    v_lshrrev_b32 v3, 4, v0
    v_add_u32 v3, 36, v3
    v_and_b32 v4, 15, v0
    v_lshrrev_b32 v5, 1, v4
    v_and_b32 v6, 7, v3
    v_xor_b32 v5, v5, v6
    v_and_b32 v4, 1, v4
    v_lshl_or_b32 v4, v5, 1, v4
    v_and_b32 v5, 0x33, v3
    v_and_b32 v6, 4, v3
    v_lshl_or_b32 v5, v6, 1, v5
    v_and_b32 v6, 8, v3
    v_lshrrev_b32 v6, 1, v6
    v_or_b32 v5, v5, v6
    v_mul_u32_u24 v5, 3840, v5
    v_lshl_add_u32 v5, v4, 4, v5
    s_lshl_b32 s63, s53, 1
    v_add_u32 v9, s63, v5
    v_lshrrev_b32 v3, 4, v0
    v_add_u32 v3, 40, v3
    v_and_b32 v4, 15, v0
    v_lshrrev_b32 v5, 1, v4
    v_and_b32 v6, 7, v3
    v_xor_b32 v5, v5, v6
    v_and_b32 v4, 1, v4
    v_lshl_or_b32 v4, v5, 1, v4
    v_and_b32 v5, 0x33, v3
    v_and_b32 v6, 4, v3
    v_lshl_or_b32 v5, v6, 1, v5
    v_and_b32 v6, 8, v3
    v_lshrrev_b32 v6, 1, v6
    v_or_b32 v5, v5, v6
    v_mul_u32_u24 v5, 3840, v5
    v_lshl_add_u32 v5, v4, 4, v5
    s_lshl_b32 s63, s53, 1
    v_add_u32 v10, s63, v5
    v_lshrrev_b32 v3, 4, v0
    v_add_u32 v3, 44, v3
    v_and_b32 v4, 15, v0
    v_lshrrev_b32 v5, 1, v4
    v_and_b32 v6, 7, v3
    v_xor_b32 v5, v5, v6
    v_and_b32 v4, 1, v4
    v_lshl_or_b32 v4, v5, 1, v4
    v_and_b32 v5, 0x33, v3
    v_and_b32 v6, 4, v3
    v_lshl_or_b32 v5, v6, 1, v5
    v_and_b32 v6, 8, v3
    v_lshrrev_b32 v6, 1, v6
    v_or_b32 v5, v5, v6
    v_mul_u32_u24 v5, 3840, v5
    v_lshl_add_u32 v5, v4, 4, v5
    s_lshl_b32 s63, s53, 1
    v_add_u32 v11, s63, v5
    v_lshrrev_b32 v3, 4, v0
    v_add_u32 v3, 48, v3
    v_and_b32 v4, 15, v0
    v_lshrrev_b32 v5, 1, v4
    v_and_b32 v6, 7, v3
    v_xor_b32 v5, v5, v6
    v_and_b32 v4, 1, v4
    v_lshl_or_b32 v4, v5, 1, v4
    v_and_b32 v5, 0x33, v3
    v_and_b32 v6, 4, v3
    v_lshl_or_b32 v5, v6, 1, v5
    v_and_b32 v6, 8, v3
    v_lshrrev_b32 v6, 1, v6
    v_or_b32 v5, v5, v6
    v_mul_u32_u24 v5, 3840, v5
    v_lshl_add_u32 v5, v4, 4, v5
    s_lshl_b32 s63, s53, 1
    v_add_u32 v12, s63, v5
    v_lshrrev_b32 v3, 4, v0
    v_add_u32 v3, 52, v3
    v_and_b32 v4, 15, v0
    v_lshrrev_b32 v5, 1, v4
    v_and_b32 v6, 7, v3
    v_xor_b32 v5, v5, v6
    v_and_b32 v4, 1, v4
    v_lshl_or_b32 v4, v5, 1, v4
    v_and_b32 v5, 0x33, v3
    v_and_b32 v6, 4, v3
    v_lshl_or_b32 v5, v6, 1, v5
    v_and_b32 v6, 8, v3
    v_lshrrev_b32 v6, 1, v6
    v_or_b32 v5, v5, v6
    v_mul_u32_u24 v5, 3840, v5
    v_lshl_add_u32 v5, v4, 4, v5
    s_lshl_b32 s63, s53, 1
    v_add_u32 v13, s63, v5
    v_lshrrev_b32 v3, 4, v0
    v_add_u32 v3, 56, v3
    v_and_b32 v4, 15, v0
    v_lshrrev_b32 v5, 1, v4
    v_and_b32 v6, 7, v3
    v_xor_b32 v5, v5, v6
    v_and_b32 v4, 1, v4
    v_lshl_or_b32 v4, v5, 1, v4
    v_and_b32 v5, 0x33, v3
    v_and_b32 v6, 4, v3
    v_lshl_or_b32 v5, v6, 1, v5
    v_and_b32 v6, 8, v3
    v_lshrrev_b32 v6, 1, v6
    v_or_b32 v5, v5, v6
    v_mul_u32_u24 v5, 3840, v5
    v_lshl_add_u32 v5, v4, 4, v5
    s_lshl_b32 s63, s53, 1
    v_add_u32 v14, s63, v5
    v_lshrrev_b32 v3, 4, v0
    v_add_u32 v3, 60, v3
    v_and_b32 v4, 15, v0
    v_lshrrev_b32 v5, 1, v4
    v_and_b32 v6, 7, v3
    v_xor_b32 v5, v5, v6
    v_and_b32 v4, 1, v4
    v_lshl_or_b32 v4, v5, 1, v4
    v_and_b32 v5, 0x33, v3
    v_and_b32 v6, 4, v3
    v_lshl_or_b32 v5, v6, 1, v5
    v_and_b32 v6, 8, v3
    v_lshrrev_b32 v6, 1, v6
    v_or_b32 v5, v5, v6
    v_mul_u32_u24 v5, 3840, v5
    v_lshl_add_u32 v5, v4, 4, v5
    s_lshl_b32 s63, s53, 1
    v_add_u32 v15, s63, v5
    s_mov_b32 s54, 0
    s_mov_b32 s55, 65536
    s_add_u32 m0, s55, 8192
    s_nop 0
    buffer_load_dwordx4 v8, s[28:31], s54 offen lds
    s_add_u32 m0, s55, 9216
    s_nop 0
    buffer_load_dwordx4 v9, s[28:31], s54 offen lds
    s_add_u32 m0, s55, 10240
    s_nop 0
    buffer_load_dwordx4 v10, s[28:31], s54 offen lds
    s_add_u32 m0, s55, 11264
    s_nop 0
    buffer_load_dwordx4 v11, s[28:31], s54 offen lds
    s_add_u32 m0, s55, 12288
    s_nop 0
    buffer_load_dwordx4 v12, s[28:31], s54 offen lds
    s_add_u32 m0, s55, 13312
    s_nop 0
    buffer_load_dwordx4 v13, s[28:31], s54 offen lds
    s_add_u32 m0, s55, 14336
    s_nop 0
    buffer_load_dwordx4 v14, s[28:31], s54 offen lds
    s_add_u32 m0, s55, 15360
    s_nop 0
    buffer_load_dwordx4 v15, s[28:31], s54 offen lds
    s_add_u32 s54, s54, 245760
    s_add_u32 s55, s55, 16384
    s_cmp_eq_u32 s55, 131072
    s_cselect_b32 s55, 65536, s55
    s_add_u32 m0, s55, 8192
    s_nop 0
    buffer_load_dwordx4 v8, s[28:31], s54 offen lds
    s_add_u32 m0, s55, 9216
    s_nop 0
    buffer_load_dwordx4 v9, s[28:31], s54 offen lds
    s_add_u32 m0, s55, 10240
    s_nop 0
    buffer_load_dwordx4 v10, s[28:31], s54 offen lds
    s_add_u32 m0, s55, 11264
    s_nop 0
    buffer_load_dwordx4 v11, s[28:31], s54 offen lds
    s_add_u32 m0, s55, 12288
    s_nop 0
    buffer_load_dwordx4 v12, s[28:31], s54 offen lds
    s_add_u32 m0, s55, 13312
    s_nop 0
    buffer_load_dwordx4 v13, s[28:31], s54 offen lds
    s_add_u32 m0, s55, 14336
    s_nop 0
    buffer_load_dwordx4 v14, s[28:31], s54 offen lds
    s_add_u32 m0, s55, 15360
    s_nop 0
    buffer_load_dwordx4 v15, s[28:31], s54 offen lds
    s_add_u32 s54, s54, 245760
    s_add_u32 s55, s55, 16384
    s_cmp_eq_u32 s55, 131072
    s_cselect_b32 s55, 65536, s55
    s_add_u32 m0, s55, 8192
    s_nop 0
    buffer_load_dwordx4 v8, s[28:31], s54 offen lds
    s_add_u32 m0, s55, 9216
    s_nop 0
    buffer_load_dwordx4 v9, s[28:31], s54 offen lds
    s_add_u32 m0, s55, 10240
    s_nop 0
    buffer_load_dwordx4 v10, s[28:31], s54 offen lds
    s_add_u32 m0, s55, 11264
    s_nop 0
    buffer_load_dwordx4 v11, s[28:31], s54 offen lds
    s_add_u32 m0, s55, 12288
    s_nop 0
    buffer_load_dwordx4 v12, s[28:31], s54 offen lds
    s_add_u32 m0, s55, 13312
    s_nop 0
    buffer_load_dwordx4 v13, s[28:31], s54 offen lds
    s_add_u32 m0, s55, 14336
    s_nop 0
    buffer_load_dwordx4 v14, s[28:31], s54 offen lds
    s_add_u32 m0, s55, 15360
    s_nop 0
    buffer_load_dwordx4 v15, s[28:31], s54 offen lds
    s_add_u32 s54, s54, 245760
    s_add_u32 s55, s55, 16384
    s_cmp_eq_u32 s55, 131072
    s_cselect_b32 s55, 65536, s55
    s_waitcnt vmcnt(16)
    s_barrier
    s_mov_b32 s57, 7
ps_ldl_62:
    s_add_u32 m0, s55, 8192
    s_nop 0
    buffer_load_dwordx4 v8, s[28:31], s54 offen lds
    s_add_u32 m0, s55, 9216
    s_nop 0
    buffer_load_dwordx4 v9, s[28:31], s54 offen lds
    s_add_u32 m0, s55, 10240
    s_nop 0
    buffer_load_dwordx4 v10, s[28:31], s54 offen lds
    s_add_u32 m0, s55, 11264
    s_nop 0
    buffer_load_dwordx4 v11, s[28:31], s54 offen lds
    s_add_u32 m0, s55, 12288
    s_nop 0
    buffer_load_dwordx4 v12, s[28:31], s54 offen lds
    s_add_u32 m0, s55, 13312
    s_nop 0
    buffer_load_dwordx4 v13, s[28:31], s54 offen lds
    s_add_u32 m0, s55, 14336
    s_nop 0
    buffer_load_dwordx4 v14, s[28:31], s54 offen lds
    s_add_u32 m0, s55, 15360
    s_nop 0
    buffer_load_dwordx4 v15, s[28:31], s54 offen lds
    s_add_u32 s54, s54, 245760
    s_add_u32 s55, s55, 16384
    s_cmp_eq_u32 s55, 131072
    s_cselect_b32 s55, 65536, s55
    s_waitcnt vmcnt(16)
    s_sub_u32 s57, s57, 1
    s_cmp_lg_u32 s57, 0
    s_barrier
    s_cbranch_scc1 ps_ldl_62
    s_waitcnt vmcnt(8)
    s_barrier
    s_waitcnt vmcnt(0)
    s_barrier
    s_barrier
    s_branch ps_att
ps_spare_8:
    s_cmp_lg_u32 s3, 0
    s_cbranch_scc1 ps_sp1_63
    s_cmp_ge_u32 s22, 4
    s_cbranch_scc1 ps_spf_64
    s_cmp_lg_u32 s22, 0
    s_cbranch_scc1 ps_nfetch_65
    s_mov_b32 s48, s98
    s_mov_b32 s49, s99
    s_mov_b32 s50, 256
    s_mov_b32 s51, 0x20000
    s_memrealtime s[62:63]
    v_mov_b32 v98, 0
    s_mov_b32 s95, 0
    s_waitcnt lgkmcnt(0)
    s_lshr_b32 s64, s62, 28
    s_lshl_b32 s63, s63, 4
    s_or_b32 s63, s63, s64
    s_and_b32 s63, s63, 0x7fffffff
    s_lshl_b32 s62, s62, 4
    s_add_u32 s62, s62, 64000
    s_addc_u32 s63, s63, 0
ps_nf_66:
    buffer_load_dwordx2 v[96:97], v98, s[48:51], 0 offen sc1
    s_waitcnt vmcnt(0)
    v_readfirstlane_b32 s60, v96
    v_readfirstlane_b32 s61, v97
    s_add_u32 s95, s95, 1
    s_nop 2
    s_bitcmp1_b32 s61, 31
    s_cbranch_scc0 ps_nag_68
    s_cmp_ge_u32 s95, 0x8000
    s_cbranch_scc1 ps_nok_67
    s_and_b32 s64, s61, 0x7fffffff
    s_sub_u32 s65, s62, s60
    s_subb_u32 s64, s63, s64
    s_cmp_lg_u32 s64, 0
    s_cbranch_scc1 ps_nag_68
    s_cmp_lt_u32 s65, 128000
    s_cbranch_scc1 ps_nok_67
ps_nag_68:
    s_cmp_lt_u32 s95, 0x40000
    s_cbranch_scc1 ps_nf_66
ps_nok_67:
    v_mov_b32 v98, 159768
    ds_write_b64 v98, v[96:97]
    s_waitcnt lgkmcnt(0)
ps_nfetch_65:
    s_add_u32 s28, s20, 42991616
    s_addc_u32 s29, s21, 0
    s_mov_b32 s30, 131072
    s_mov_b32 s31, 0x20000
    s_waitcnt vmcnt(0)
    v_lshlrev_b32 v96, 16, v80
    v_and_b32 v97, 0xffff0000, v80
    v_lshlrev_b32 v98, 16, v81
    v_and_b32 v99, 0xffff0000, v81
    v_lshlrev_b32 v100, 16, v82
    v_and_b32 v101, 0xffff0000, v82
    v_lshlrev_b32 v102, 16, v83
    v_and_b32 v103, 0xffff0000, v83
    v_lshlrev_b32 v104, 16, v84
    v_and_b32 v105, 0xffff0000, v84
    v_lshlrev_b32 v106, 16, v85
    v_and_b32 v107, 0xffff0000, v85
    v_lshlrev_b32 v108, 16, v86
    v_and_b32 v109, 0xffff0000, v86
    v_lshlrev_b32 v110, 16, v87
    v_and_b32 v111, 0xffff0000, v87
    v_lshlrev_b32 v112, 16, v88
    v_and_b32 v113, 0xffff0000, v88
    v_lshlrev_b32 v114, 16, v89
    v_and_b32 v115, 0xffff0000, v89
    v_pk_add_f32 v[122:123], v[96:97], v[98:99]
    v_pk_add_f32 v[124:125], v[100:101], v[102:103]
    v_pk_add_f32 v[122:123], v[122:123], v[104:105]
    v_pk_add_f32 v[124:125], v[124:125], v[106:107]
    v_pk_add_f32 v[122:123], v[122:123], v[108:109]
    v_pk_add_f32 v[124:125], v[124:125], v[110:111]
    v_pk_add_f32 v[122:123], v[122:123], v[112:113]
    v_pk_add_f32 v[124:125], v[124:125], v[114:115]
    v_pk_add_f32 v[122:123], v[122:123], v[124:125]
    v_add_f32 v122, v122, v123
    s_nop 1
    v_add_f32_dpp v122, v122, v122 quad_perm:[1,0,3,2] row_mask:0xf bank_mask:0xf
    s_nop 1
    v_add_f32_dpp v122, v122, v122 quad_perm:[2,3,0,1] row_mask:0xf bank_mask:0xf
    v_mul_f32 v124, 0xbc4ccccd, v122
    v_pk_add_f32 v[96:97], v[96:97], v[124:125] op_sel_hi:[1,0]
    v_pk_add_f32 v[98:99], v[98:99], v[124:125] op_sel_hi:[1,0]
    v_pk_add_f32 v[100:101], v[100:101], v[124:125] op_sel_hi:[1,0]
    v_pk_add_f32 v[102:103], v[102:103], v[124:125] op_sel_hi:[1,0]
    v_pk_add_f32 v[104:105], v[104:105], v[124:125] op_sel_hi:[1,0]
    v_pk_add_f32 v[106:107], v[106:107], v[124:125] op_sel_hi:[1,0]
    v_pk_add_f32 v[108:109], v[108:109], v[124:125] op_sel_hi:[1,0]
    v_pk_add_f32 v[110:111], v[110:111], v[124:125] op_sel_hi:[1,0]
    v_pk_add_f32 v[112:113], v[112:113], v[124:125] op_sel_hi:[1,0]
    v_pk_add_f32 v[114:115], v[114:115], v[124:125] op_sel_hi:[1,0]
    v_pk_mul_f32 v[124:125], v[96:97], v[96:97]
    v_pk_mul_f32 v[126:127], v[98:99], v[98:99]
    v_pk_fma_f32 v[124:125], v[100:101], v[100:101], v[124:125]
    v_pk_fma_f32 v[126:127], v[102:103], v[102:103], v[126:127]
    v_pk_fma_f32 v[124:125], v[104:105], v[104:105], v[124:125]
    v_pk_fma_f32 v[126:127], v[106:107], v[106:107], v[126:127]
    v_pk_fma_f32 v[124:125], v[108:109], v[108:109], v[124:125]
    v_pk_fma_f32 v[126:127], v[110:111], v[110:111], v[126:127]
    v_pk_fma_f32 v[124:125], v[112:113], v[112:113], v[124:125]
    v_pk_fma_f32 v[126:127], v[114:115], v[114:115], v[126:127]
    v_pk_add_f32 v[124:125], v[124:125], v[126:127]
    v_add_f32 v123, v124, v125
    s_nop 1
    v_add_f32_dpp v123, v123, v123 quad_perm:[1,0,3,2] row_mask:0xf bank_mask:0xf
    s_nop 1
    v_add_f32_dpp v123, v123, v123 quad_perm:[2,3,0,1] row_mask:0xf bank_mask:0xf
    s_mov_b32 exec_lo, 0x11111111
    s_mov_b32 exec_hi, 0x11111111
    buffer_store_dwordx2 v[122:123], v120, s[28:31], 0 offen sc1
    s_mov_b64 exec, -1
    s_lshl_b32 s88, s23, 5
    s_add_u32 s88, s88, s96
    s_lshl_b32 s89, s22, 8
    s_add_u32 s88, s88, s89
    s_add_u32 s88, s88, 100
    s_cmp_lt_u32 s88, 910
    s_cselect_b32 s80, 1, 0
    s_min_u32 s88, s88, 909
    s_cmp_ge_u32 s88, 640
    s_cbranch_scc1 ps_mat_73
    s_cmp_ge_u32 s88, 370
    s_cbranch_scc1 ps_mat_72
    s_cmp_ge_u32 s88, 100
    s_cbranch_scc1 ps_mat_71
ps_mat_70:
    s_mov_b32 s44, s8
    s_mov_b32 s45, s9
    s_mov_b32 s46, 819200
    s_mov_b32 s47, 0x20000
    s_sub_u32 s89, s88, 0
    s_mul_i32 s90, s89, 6554
    s_lshr_b32 s90, s90, 16
    s_mul_i32 s91, s90, 10
    s_sub_u32 s91, s89, s91
    s_mov_b32 s92, 1280
    s_mov_b32 s82, 20480
    s_mov_b32 s84, 0
    s_mov_b32 s83, -1
    s_branch ps_tgo_69
ps_mat_71:
    s_mov_b32 s44, s16
    s_mov_b32 s45, s17
    s_mov_b32 s46, 2211840
    s_mov_b32 s47, 0x20000
    s_sub_u32 s89, s88, 100
    s_mul_i32 s90, s89, 6554
    s_lshr_b32 s90, s90, 16
    s_mul_i32 s91, s90, 10
    s_sub_u32 s91, s89, s91
    s_mov_b32 s92, 1280
    s_mov_b32 s82, 55296
    s_mov_b32 s84, 819200
    s_mov_b32 s83, -1
    s_branch ps_tgo_69
ps_mat_72:
    s_mov_b32 s44, s12
    s_mov_b32 s45, s13
    s_mov_b32 s46, 2211840
    s_mov_b32 s47, 0x20000
    s_sub_u32 s89, s88, 370
    s_mul_i32 s90, s89, 2428
    s_lshr_b32 s90, s90, 16
    s_mul_i32 s91, s90, 27
    s_sub_u32 s91, s89, s91
    s_mov_b32 s92, 3456
    s_mov_b32 s82, 20480
    s_mov_b32 s84, 3031040
    s_mul_i32 s83, s90, 13824
    s_lshl_b32 s94, s91, 8
    s_add_u32 s83, s83, s94
    s_add_u32 s83, s83, 0
    s_branch ps_tgo_69
ps_mat_73:
    s_mov_b32 s44, s14
    s_mov_b32 s45, s15
    s_mov_b32 s46, 2211840
    s_mov_b32 s47, 0x20000
    s_sub_u32 s89, s88, 640
    s_mul_i32 s90, s89, 2428
    s_lshr_b32 s90, s90, 16
    s_mul_i32 s91, s90, 27
    s_sub_u32 s91, s89, s91
    s_mov_b32 s92, 3456
    s_mov_b32 s82, 20480
    s_mov_b32 s84, 5242880
    s_mul_i32 s83, s90, 13824
    s_lshl_b32 s94, s91, 8
    s_add_u32 s83, s83, s94
    s_add_u32 s83, s83, 6912
ps_tgo_69:
    s_mul_i32 s93, s90, s92
    s_lshl_b32 s93, s93, 6
    s_lshl_b32 s94, s91, 7
    s_add_u32 s93, s93, s94
    s_lshl_b32 s81, s91, 2
    s_mul_i32 s81, s81, s82
    s_lshl_b32 s94, s90, 11
    s_add_u32 s81, s81, s94
    s_add_u32 s81, s81, s84
    v_lshrrev_b32 v2, 3, v0
    v_and_b32 v3, 7, v0
    v_lshrrev_b32 v4, 1, v3
    v_lshrrev_b32 v5, 1, v2
    v_and_b32 v5, 3, v5
    v_xor_b32 v4, v4, v5
    v_and_b32 v3, 1, v3
    v_lshl_or_b32 v3, v4, 1, v3
    v_and_b32 v4, 3, v2
    v_lshrrev_b32 v5, 2, v2
    v_lshl_add_u32 v4, v5, 3, v4
    v_mul_lo_u32 v4, v4, s92
    v_lshl_add_u32 v4, v3, 4, v4
    v_mul_lo_u32 v4, v0, s92
    buffer_load_dword v253, v4, s[44:47], s93 offen
ps_spf_64:
    s_barrier
    s_lshl_b32 s88, s23, 1
    s_add_u32 s88, s88, s96
    s_sub_u32 s88, s88, 30
    s_lshl_b32 s88, s88, 3
    s_add_u32 s88, s88, s22
    s_cmp_lt_u32 s88, 100
    s_cselect_b32 s80, 1, 0
    s_min_u32 s88, s88, 99
    s_cmp_ge_u32 s88, 640
    s_cbranch_scc1 ps_mat_78
    s_cmp_ge_u32 s88, 370
    s_cbranch_scc1 ps_mat_77
    s_cmp_ge_u32 s88, 100
    s_cbranch_scc1 ps_mat_76
ps_mat_75:
    s_mov_b32 s44, s8
    s_mov_b32 s45, s9
    s_mov_b32 s46, 819200
    s_mov_b32 s47, 0x20000
    s_sub_u32 s89, s88, 0
    s_mul_i32 s90, s89, 6554
    s_lshr_b32 s90, s90, 16
    s_mul_i32 s91, s90, 10
    s_sub_u32 s91, s89, s91
    s_mov_b32 s92, 1280
    s_mov_b32 s82, 20480
    s_mov_b32 s84, 0
    s_mov_b32 s83, -1
    s_branch ps_tgo_74
ps_mat_76:
    s_mov_b32 s44, s16
    s_mov_b32 s45, s17
    s_mov_b32 s46, 2211840
    s_mov_b32 s47, 0x20000
    s_sub_u32 s89, s88, 100
    s_mul_i32 s90, s89, 6554
    s_lshr_b32 s90, s90, 16
    s_mul_i32 s91, s90, 10
    s_sub_u32 s91, s89, s91
    s_mov_b32 s92, 1280
    s_mov_b32 s82, 55296
    s_mov_b32 s84, 819200
    s_mov_b32 s83, -1
    s_branch ps_tgo_74
ps_mat_77:
    s_mov_b32 s44, s12
    s_mov_b32 s45, s13
    s_mov_b32 s46, 2211840
    s_mov_b32 s47, 0x20000
    s_sub_u32 s89, s88, 370
    s_mul_i32 s90, s89, 2428
    s_lshr_b32 s90, s90, 16
    s_mul_i32 s91, s90, 27
    s_sub_u32 s91, s89, s91
    s_mov_b32 s92, 3456
    s_mov_b32 s82, 20480
    s_mov_b32 s84, 3031040
    s_mul_i32 s83, s90, 13824
    s_lshl_b32 s94, s91, 8
    s_add_u32 s83, s83, s94
    s_add_u32 s83, s83, 0
    s_branch ps_tgo_74
ps_mat_78:
    s_mov_b32 s44, s14
    s_mov_b32 s45, s15
    s_mov_b32 s46, 2211840
    s_mov_b32 s47, 0x20000
    s_sub_u32 s89, s88, 640
    s_mul_i32 s90, s89, 2428
    s_lshr_b32 s90, s90, 16
    s_mul_i32 s91, s90, 27
    s_sub_u32 s91, s89, s91
    s_mov_b32 s92, 3456
    s_mov_b32 s82, 20480
    s_mov_b32 s84, 5242880
    s_mul_i32 s83, s90, 13824
    s_lshl_b32 s94, s91, 8
    s_add_u32 s83, s83, s94
    s_add_u32 s83, s83, 6912
ps_tgo_74:
    s_mul_i32 s93, s90, s92
    s_lshl_b32 s93, s93, 6
    s_lshl_b32 s94, s91, 7
    s_add_u32 s93, s93, s94
    s_lshl_b32 s81, s91, 2
    s_mul_i32 s81, s81, s82
    s_lshl_b32 s94, s90, 11
    s_add_u32 s81, s81, s94
    s_add_u32 s81, s81, s84
    v_lshrrev_b32 v2, 3, v0
    v_and_b32 v3, 7, v0
    v_lshrrev_b32 v4, 1, v3
    v_lshrrev_b32 v5, 1, v2
    v_and_b32 v5, 3, v5
    v_xor_b32 v4, v4, v5
    v_and_b32 v3, 1, v3
    v_lshl_or_b32 v3, v4, 1, v3
    v_and_b32 v4, 3, v2
    v_lshrrev_b32 v5, 2, v2
    v_lshl_add_u32 v4, v5, 3, v4
    v_mul_lo_u32 v4, v4, s92
    v_lshl_add_u32 v4, v3, 4, v4
    s_mul_i32 s94, s92, 0
    s_add_u32 s94, s94, s93
    buffer_load_dwordx4 v[144:147], v4, s[44:47], s94 offen
    s_mul_i32 s94, s92, 4
    s_add_u32 s94, s94, s93
    buffer_load_dwordx4 v[148:151], v4, s[44:47], s94 offen
    s_mul_i32 s94, s92, 16
    s_add_u32 s94, s94, s93
    buffer_load_dwordx4 v[152:155], v4, s[44:47], s94 offen
    s_mul_i32 s94, s92, 20
    s_add_u32 s94, s94, s93
    buffer_load_dwordx4 v[156:159], v4, s[44:47], s94 offen
    s_mul_i32 s94, s92, 32
    s_add_u32 s94, s94, s93
    buffer_load_dwordx4 v[160:163], v4, s[44:47], s94 offen
    s_mul_i32 s94, s92, 36
    s_add_u32 s94, s94, s93
    buffer_load_dwordx4 v[164:167], v4, s[44:47], s94 offen
    s_mul_i32 s94, s92, 48
    s_add_u32 s94, s94, s93
    buffer_load_dwordx4 v[168:171], v4, s[44:47], s94 offen
    s_mul_i32 s94, s92, 52
    s_add_u32 s94, s94, s93
    buffer_load_dwordx4 v[172:175], v4, s[44:47], s94 offen
    s_lshl_b32 s94, s22, 12
    s_add_u32 s94, s94, 65536
    v_lshlrev_b32 v2, 4, v0
    v_add_u32 v7, s94, v2
    v_lshrrev_b32 v3, 4, v0
    v_and_b32 v4, 15, v0
    v_lshrrev_b32 v5, 2, v4
    v_and_b32 v6, 1, v3
    v_lshl_add_u32 v6, v6, 2, v5
    v_lshrrev_b32 v3, 1, v3
    v_lshl_add_u32 v3, v3, 4, v6
    v_lshrrev_b32 v6, 1, v6
    v_and_b32 v6, 3, v6
    v_lshlrev_b32 v3, 7, v3
    v_and_b32 v4, 3, v4
    v_lshl_add_u32 v3, v4, 3, v3
    v_add_u32 v3, s94, v3
    v_xor_b32 v8, 0, v6
    v_lshl_add_u32 v10, v8, 5, v3
    v_xor_b32 v8, 1, v6
    v_lshl_add_u32 v11, v8, 5, v3
    v_xor_b32 v8, 2, v6
    v_lshl_add_u32 v12, v8, 5, v3
    v_xor_b32 v8, 3, v6
    v_lshl_add_u32 v13, v8, 5, v3
    s_waitcnt vmcnt(0)
    ds_write_b128 v7, v[144:147] offset:0
    ds_write_b128 v7, v[148:151] offset:1024
    ds_write_b128 v7, v[152:155] offset:2048
    ds_write_b128 v7, v[156:159] offset:3072
    s_waitcnt lgkmcnt(0)
    ds_read_b64_tr_b16 v[112:113], v10
    ds_read_b64_tr_b16 v[114:115], v10 offset:1024
    ds_read_b64_tr_b16 v[120:121], v11
    ds_read_b64_tr_b16 v[122:123], v11 offset:1024
    ds_read_b64_tr_b16 v[128:129], v12
    ds_read_b64_tr_b16 v[130:131], v12 offset:1024
    ds_read_b64_tr_b16 v[136:137], v13
    ds_read_b64_tr_b16 v[138:139], v13 offset:1024
    s_waitcnt lgkmcnt(0)
    ds_write_b128 v7, v[160:163] offset:0
    ds_write_b128 v7, v[164:167] offset:1024
    ds_write_b128 v7, v[168:171] offset:2048
    ds_write_b128 v7, v[172:175] offset:3072
    s_waitcnt lgkmcnt(0)
    ds_read_b64_tr_b16 v[116:117], v10
    ds_read_b64_tr_b16 v[118:119], v10 offset:1024
    ds_read_b64_tr_b16 v[124:125], v11
    ds_read_b64_tr_b16 v[126:127], v11 offset:1024
    ds_read_b64_tr_b16 v[132:133], v12
    ds_read_b64_tr_b16 v[134:135], v12 offset:1024
    ds_read_b64_tr_b16 v[140:141], v13
    ds_read_b64_tr_b16 v[142:143], v13 offset:1024
    s_waitcnt lgkmcnt(0)
    v_mov_b32 v16, 0x3f803f80
    v_mov_b32 v17, 0x3f803f80
    v_mov_b32 v18, 0x3f803f80
    v_mov_b32 v19, 0x3f803f80
    s_nop 1
    v_mfma_f32_16x16x32_bf16 v[176:179], v[112:115], v[16:19], 0
    v_mfma_f32_16x16x32_bf16 v[176:179], v[116:119], v[16:19], v[176:179]
    v_mfma_f32_16x16x32_bf16 v[180:183], v[120:123], v[16:19], 0
    v_mfma_f32_16x16x32_bf16 v[180:183], v[124:127], v[16:19], v[180:183]
    v_mfma_f32_16x16x32_bf16 v[184:187], v[128:131], v[16:19], 0
    v_mfma_f32_16x16x32_bf16 v[184:187], v[132:135], v[16:19], v[184:187]
    v_mfma_f32_16x16x32_bf16 v[188:191], v[136:139], v[16:19], 0
    v_mfma_f32_16x16x32_bf16 v[188:191], v[140:143], v[16:19], v[188:191]
    s_mov_b32 s32, s80
    s_mov_b32 s33, s81
    s_mov_b32 s34, s82
    s_mov_b32 s35, s83
    s_cmp_eq_u32 s32, 0
    s_cbranch_scc1 ps_rtinv_79
    s_add_u32 s36, s20, 43540480
    s_addc_u32 s37, s21, 0
    s_mov_b32 s38, 7454720
    s_mov_b32 s39, 0x20000
    v_lshlrev_b32 v4, 4, v0
    buffer_store_dwordx4 v[112:115], v4, s[36:39], s33 offen offset:0 sc1
    buffer_store_dwordx4 v[116:119], v4, s[36:39], s33 offen offset:1024 sc1
    s_add_u32 s33, s33, s34
    buffer_store_dwordx4 v[120:123], v4, s[36:39], s33 offen offset:0 sc1
    buffer_store_dwordx4 v[124:127], v4, s[36:39], s33 offen offset:1024 sc1
    s_add_u32 s33, s33, s34
    buffer_store_dwordx4 v[128:131], v4, s[36:39], s33 offen offset:0 sc1
    buffer_store_dwordx4 v[132:135], v4, s[36:39], s33 offen offset:1024 sc1
    s_add_u32 s33, s33, s34
    buffer_store_dwordx4 v[136:139], v4, s[36:39], s33 offen offset:0 sc1
    buffer_store_dwordx4 v[140:143], v4, s[36:39], s33 offen offset:1024 sc1
    s_add_u32 s33, s33, s34
    s_cmp_eq_u32 s35, -1
    s_cbranch_scc1 ps_rtinv_79
    s_add_u32 s44, s20, 50995200
    s_addc_u32 s45, s21, 0
    s_mov_b32 s46, 138240
    s_mov_b32 s47, 0x20000
    v_lshrrev_b32 v5, 4, v0
    v_lshlrev_b32 v5, 4, v5
    s_mov_b32 exec_lo, 0x00010001
    s_mov_b32 exec_hi, 0x00010001
    buffer_store_dwordx4 v[176:179], v5, s[44:47], s35 offen offset:0 sc1
    buffer_store_dwordx4 v[180:183], v5, s[44:47], s35 offen offset:64 sc1
    buffer_store_dwordx4 v[184:187], v5, s[44:47], s35 offen offset:128 sc1
    buffer_store_dwordx4 v[188:191], v5, s[44:47], s35 offen offset:192 sc1
    s_mov_b64 exec, -1
ps_rtinv_79:
    s_waitcnt vmcnt(0)
    v_mov_b32 v2, 159768
    ds_read_b64 v[2:3], v2
    v_mov_b32 v4, 159744
    v_mov_b32 v5, 7
    s_mov_b64 exec, 1
    ds_inc_rtn_u32 v6, v4, v5
    s_waitcnt lgkmcnt(0)
    v_readfirstlane_b32 s61, v6
    s_mov_b64 exec, -1
    s_nop 2
    s_cmp_lg_u32 s61, 7
    s_cbranch_scc1 ps_spj_80
    s_add_u32 s48, s20, 51134464
    s_addc_u32 s49, s21, 0
    s_mov_b32 s50, 65536
    s_mov_b32 s51, 0x20000
    s_lshl_b32 s62, s23, 12
    s_lshl_b32 s63, s96, 7
    s_add_u32 s62, s62, s63
    s_add_u32 s62, s62, 32768
    v_add_u32 v8, 1, v2
    v_mov_b32 v9, v3
    v_mov_b32 v7, s62
    s_mov_b64 exec, 1
    buffer_store_dwordx2 v[8:9], v7, s[48:51], 0 offen sc1
    s_mov_b64 exec, -1
    s_add_u32 s48, s20, 51134464
    s_addc_u32 s49, s21, 0
    s_mov_b32 s50, 65536
    s_mov_b32 s51, 0x20000
    s_lshl_b32 s62, s23, 12
    s_lshl_b32 s63, s96, 7
    s_add_u32 s62, s62, s63
    v_mov_b32 v6, s62
    s_getreg_b32 s63, hwreg(HW_REG_XCC_ID)
    s_and_b32 s63, s63, 15
    v_add_u32 v2, 2, v2
    v_mov_b32 v4, s63
    v_mov_b32 v5, 0
    s_mov_b64 exec, 1
    buffer_store_dwordx4 v[2:5], v6, s[48:51], 0 offen sc1
    s_mov_b64 exec, -1
ps_spj_80:
    s_cmp_lg_u32 s22, 4
    s_cbranch_scc1 ps_spm_81
    s_mov_b32 s60, 1
    s_add_u32 s48, s20, 51134464
    s_addc_u32 s49, s21, 0
    s_mov_b32 s50, 65536
    s_mov_b32 s51, 0x20000
    v_mov_b32 v50, 159768
    ds_read_b64 v[50:51], v50
    s_lshl_b32 s62, s23, 12
    v_and_b32 v48, 31, v0
    v_lshlrev_b32 v48, 7, v48
    v_add_u32 v48, s62, v48
    s_mov_b32 s42, 0
    s_waitcnt lgkmcnt(0)
ps_gw_82:
    buffer_load_dwordx4 v[52:55], v48, s[48:51], 0 offen sc1
    s_waitcnt vmcnt(0)
    v_sub_u32 v49, v52, v50
    v_subrev_u32 v49, s60, v49
    s_sub_u32 s63, 16, s60
    v_cmp_eq_u32 s[40:41], v53, v51
    v_cmp_gt_u32 vcc, s63, v49
    s_nop 3
    s_and_b64 vcc, vcc, s[40:41]
    s_cmp_eq_u64 vcc, -1
    s_cbranch_scc1 ps_gok_83
ps_ga_84:
    s_sleep 1
    s_add_u32 s42, s42, 1
    s_cmp_lt_u32 s42, 0x20000
    s_cbranch_scc1 ps_gw_82
ps_gok_83:
    s_getreg_b32 s62, hwreg(HW_REG_XCC_ID)
    s_and_b32 s62, s62, 15
    v_cmp_ne_u32 vcc, s62, v54
    s_nop 3
    s_cmp_eq_u32 vcc_lo, 0
    s_cselect_b32 s63, 1, 0
    v_mov_b32 v48, 159752
    v_mov_b32 v49, s63
    ds_write_b32 v48, v49
    s_waitcnt lgkmcnt(0)
ps_spm_81:
    s_cmp_ge_u32 s22, 4
    s_cbranch_scc1 ps_att
    s_lshl_b32 s88, s23, 5
    s_add_u32 s88, s88, s96
    s_lshl_b32 s89, s22, 8
    s_add_u32 s88, s88, s89
    s_add_u32 s88, s88, 100
    s_cmp_lt_u32 s88, 910
    s_cselect_b32 s80, 1, 0
    s_min_u32 s88, s88, 909
    s_cmp_ge_u32 s88, 640
    s_cbranch_scc1 ps_mat_89
    s_cmp_ge_u32 s88, 370
    s_cbranch_scc1 ps_mat_88
    s_cmp_ge_u32 s88, 100
    s_cbranch_scc1 ps_mat_87
ps_mat_86:
    s_mov_b32 s44, s8
    s_mov_b32 s45, s9
    s_mov_b32 s46, 819200
    s_mov_b32 s47, 0x20000
    s_sub_u32 s89, s88, 0
    s_mul_i32 s90, s89, 6554
    s_lshr_b32 s90, s90, 16
    s_mul_i32 s91, s90, 10
    s_sub_u32 s91, s89, s91
    s_mov_b32 s92, 1280
    s_mov_b32 s82, 20480
    s_mov_b32 s84, 0
    s_mov_b32 s83, -1
    s_branch ps_tgo_85
ps_mat_87:
    s_mov_b32 s44, s16
    s_mov_b32 s45, s17
    s_mov_b32 s46, 2211840
    s_mov_b32 s47, 0x20000
    s_sub_u32 s89, s88, 100
    s_mul_i32 s90, s89, 6554
    s_lshr_b32 s90, s90, 16
    s_mul_i32 s91, s90, 10
    s_sub_u32 s91, s89, s91
    s_mov_b32 s92, 1280
    s_mov_b32 s82, 55296
    s_mov_b32 s84, 819200
    s_mov_b32 s83, -1
    s_branch ps_tgo_85
ps_mat_88:
    s_mov_b32 s44, s12
    s_mov_b32 s45, s13
    s_mov_b32 s46, 2211840
    s_mov_b32 s47, 0x20000
    s_sub_u32 s89, s88, 370
    s_mul_i32 s90, s89, 2428
    s_lshr_b32 s90, s90, 16
    s_mul_i32 s91, s90, 27
    s_sub_u32 s91, s89, s91
    s_mov_b32 s92, 3456
    s_mov_b32 s82, 20480
    s_mov_b32 s84, 3031040
    s_mul_i32 s83, s90, 13824
    s_lshl_b32 s94, s91, 8
    s_add_u32 s83, s83, s94
    s_add_u32 s83, s83, 0
    s_branch ps_tgo_85
ps_mat_89:
    s_mov_b32 s44, s14
    s_mov_b32 s45, s15
    s_mov_b32 s46, 2211840
    s_mov_b32 s47, 0x20000
    s_sub_u32 s89, s88, 640
    s_mul_i32 s90, s89, 2428
    s_lshr_b32 s90, s90, 16
    s_mul_i32 s91, s90, 27
    s_sub_u32 s91, s89, s91
    s_mov_b32 s92, 3456
    s_mov_b32 s82, 20480
    s_mov_b32 s84, 5242880
    s_mul_i32 s83, s90, 13824
    s_lshl_b32 s94, s91, 8
    s_add_u32 s83, s83, s94
    s_add_u32 s83, s83, 6912
ps_tgo_85:
    s_mul_i32 s93, s90, s92
    s_lshl_b32 s93, s93, 6
    s_lshl_b32 s94, s91, 7
    s_add_u32 s93, s93, s94
    s_lshl_b32 s81, s91, 2
    s_mul_i32 s81, s81, s82
    s_lshl_b32 s94, s90, 11
    s_add_u32 s81, s81, s94
    s_add_u32 s81, s81, s84
    v_lshrrev_b32 v2, 3, v0
    v_and_b32 v3, 7, v0
    v_lshrrev_b32 v4, 1, v3
    v_lshrrev_b32 v5, 1, v2
    v_and_b32 v5, 3, v5
    v_xor_b32 v4, v4, v5
    v_and_b32 v3, 1, v3
    v_lshl_or_b32 v3, v4, 1, v3
    v_and_b32 v4, 3, v2
    v_lshrrev_b32 v5, 2, v2
    v_lshl_add_u32 v4, v5, 3, v4
    v_mul_lo_u32 v4, v4, s92
    v_lshl_add_u32 v4, v3, 4, v4
    s_mul_i32 s94, s92, 0
    s_add_u32 s94, s94, s93
    buffer_load_dwordx4 v[144:147], v4, s[44:47], s94 offen
    s_mul_i32 s94, s92, 4
    s_add_u32 s94, s94, s93
    buffer_load_dwordx4 v[148:151], v4, s[44:47], s94 offen
    s_mul_i32 s94, s92, 16
    s_add_u32 s94, s94, s93
    buffer_load_dwordx4 v[152:155], v4, s[44:47], s94 offen
    s_mul_i32 s94, s92, 20
    s_add_u32 s94, s94, s93
    buffer_load_dwordx4 v[156:159], v4, s[44:47], s94 offen
    s_mul_i32 s94, s92, 32
    s_add_u32 s94, s94, s93
    buffer_load_dwordx4 v[160:163], v4, s[44:47], s94 offen
    s_mul_i32 s94, s92, 36
    s_add_u32 s94, s94, s93
    buffer_load_dwordx4 v[164:167], v4, s[44:47], s94 offen
    s_mul_i32 s94, s92, 48
    s_add_u32 s94, s94, s93
    buffer_load_dwordx4 v[168:171], v4, s[44:47], s94 offen
    s_mul_i32 s94, s92, 52
    s_add_u32 s94, s94, s93
    buffer_load_dwordx4 v[172:175], v4, s[44:47], s94 offen
    s_lshl_b32 s94, s22, 12
    s_add_u32 s94, s94, 65536
    v_lshlrev_b32 v2, 4, v0
    v_add_u32 v7, s94, v2
    v_lshrrev_b32 v3, 4, v0
    v_and_b32 v4, 15, v0
    v_lshrrev_b32 v5, 2, v4
    v_and_b32 v6, 1, v3
    v_lshl_add_u32 v6, v6, 2, v5
    v_lshrrev_b32 v3, 1, v3
    v_lshl_add_u32 v3, v3, 4, v6
    v_lshrrev_b32 v6, 1, v6
    v_and_b32 v6, 3, v6
    v_lshlrev_b32 v3, 7, v3
    v_and_b32 v4, 3, v4
    v_lshl_add_u32 v3, v4, 3, v3
    v_add_u32 v3, s94, v3
    v_xor_b32 v8, 0, v6
    v_lshl_add_u32 v10, v8, 5, v3
    v_xor_b32 v8, 1, v6
    v_lshl_add_u32 v11, v8, 5, v3
    v_xor_b32 v8, 2, v6
    v_lshl_add_u32 v12, v8, 5, v3
    v_xor_b32 v8, 3, v6
    v_lshl_add_u32 v13, v8, 5, v3
    s_waitcnt vmcnt(0)
    ds_write_b128 v7, v[144:147] offset:0
    ds_write_b128 v7, v[148:151] offset:1024
    ds_write_b128 v7, v[152:155] offset:2048
    ds_write_b128 v7, v[156:159] offset:3072
    s_waitcnt lgkmcnt(0)
    ds_read_b64_tr_b16 v[112:113], v10
    ds_read_b64_tr_b16 v[114:115], v10 offset:1024
    ds_read_b64_tr_b16 v[120:121], v11
    ds_read_b64_tr_b16 v[122:123], v11 offset:1024
    ds_read_b64_tr_b16 v[128:129], v12
    ds_read_b64_tr_b16 v[130:131], v12 offset:1024
    ds_read_b64_tr_b16 v[136:137], v13
    ds_read_b64_tr_b16 v[138:139], v13 offset:1024
    s_waitcnt lgkmcnt(0)
    ds_write_b128 v7, v[160:163] offset:0
    ds_write_b128 v7, v[164:167] offset:1024
    ds_write_b128 v7, v[168:171] offset:2048
    ds_write_b128 v7, v[172:175] offset:3072
    s_waitcnt lgkmcnt(0)
    ds_read_b64_tr_b16 v[116:117], v10
    ds_read_b64_tr_b16 v[118:119], v10 offset:1024
    ds_read_b64_tr_b16 v[124:125], v11
    ds_read_b64_tr_b16 v[126:127], v11 offset:1024
    ds_read_b64_tr_b16 v[132:133], v12
    ds_read_b64_tr_b16 v[134:135], v12 offset:1024
    ds_read_b64_tr_b16 v[140:141], v13
    ds_read_b64_tr_b16 v[142:143], v13 offset:1024
    s_waitcnt lgkmcnt(0)
    v_mov_b32 v16, 0x3f803f80
    v_mov_b32 v17, 0x3f803f80
    v_mov_b32 v18, 0x3f803f80
    v_mov_b32 v19, 0x3f803f80
    s_nop 1
    v_mfma_f32_16x16x32_bf16 v[176:179], v[112:115], v[16:19], 0
    v_mfma_f32_16x16x32_bf16 v[176:179], v[116:119], v[16:19], v[176:179]
    v_mfma_f32_16x16x32_bf16 v[180:183], v[120:123], v[16:19], 0
    v_mfma_f32_16x16x32_bf16 v[180:183], v[124:127], v[16:19], v[180:183]
    v_mfma_f32_16x16x32_bf16 v[184:187], v[128:131], v[16:19], 0
    v_mfma_f32_16x16x32_bf16 v[184:187], v[132:135], v[16:19], v[184:187]
    v_mfma_f32_16x16x32_bf16 v[188:191], v[136:139], v[16:19], 0
    v_mfma_f32_16x16x32_bf16 v[188:191], v[140:143], v[16:19], v[188:191]
    s_mov_b32 s32, s80
    s_mov_b32 s33, s81
    s_mov_b32 s34, s82
    s_mov_b32 s35, s83
    s_branch ps_att
ps_sp1_63:
    s_waitcnt vmcnt(0)
    s_barrier
    s_cmp_lg_u32 s22, 0
    s_cbranch_scc1 ps_att
    v_mov_b32 v2, 159768
    ds_read_b64 v[2:3], v2
    s_waitcnt lgkmcnt(0)
    s_add_u32 s48, s20, 51134464
    s_addc_u32 s49, s21, 0
    s_mov_b32 s50, 65536
    s_mov_b32 s51, 0x20000
    s_lshl_b32 s62, s23, 12
    s_lshl_b32 s63, s96, 7
    s_add_u32 s62, s62, s63
    s_add_u32 s62, s62, 32768
    v_add_u32 v8, 6, v2
    v_mov_b32 v9, v3
    v_mov_b32 v7, s62
    s_mov_b64 exec, 1
    s_cmp_eq_u32 s0, 0
    s_cbranch_scc1 ps_glob_90
    buffer_store_dwordx2 v[8:9], v7, s[48:51], 0 offen
    s_branch ps_dual_91
ps_glob_90:
    buffer_store_dwordx2 v[8:9], v7, s[48:51], 0 offen sc1
ps_dual_91:
    s_mov_b64 exec, -1
    s_add_u32 s48, s20, 51134464
    s_addc_u32 s49, s21, 0
    s_mov_b32 s50, 65536
    s_mov_b32 s51, 0x20000
    s_lshl_b32 s62, s23, 12
    s_lshl_b32 s63, s96, 7
    s_add_u32 s62, s62, s63
    v_mov_b32 v6, s62
    s_getreg_b32 s63, hwreg(HW_REG_XCC_ID)
    s_and_b32 s63, s63, 15
    v_add_u32 v2, 4, v2
    v_mov_b32 v4, s63
    v_mov_b32 v5, 0
    s_mov_b64 exec, 1
    buffer_store_dwordx4 v[2:5], v6, s[48:51], 0 offen sc1
    s_mov_b64 exec, -1
ps_att:
    s_waitcnt lgkmcnt(0)
    s_mul_i32 s26, s3, 7864320
    s_add_u32 s26, s26, 0
    s_add_u32 s24, s20, s26
    s_addc_u32 s25, s21, 0
    s_mov_b32 s26, 7864320
    s_mov_b32 s27, 0x20000
    s_add_u32 s28, s20, 15728640
    s_addc_u32 s29, s21, 0
    s_mov_b32 s30, 2621440
    s_mov_b32 s31, 0x20000
    s_mul_i32 s52, s96, 81920
    s_lshl_b32 s53, s23, 8
    v_and_b32 v28, 31, v0
    v_lshrrev_b32 v29, 5, v0
    s_sub_u32 s60, 11, s22
    s_cmp_lt_u32 s22, 4
    s_cselect_b32 s60, s22, s60
    s_lshl_b32 s59, s60, 5
    s_add_u32 s58, s59, s53
    v_add_u32 v30, s58, v28
    v_lshlrev_b32 v10, 3, v30
    v_add_u32 v10, s52, v10
    v_lshl_add_u32 v11, v29, 15, v10
    s_and_b32 s54, s22, 3
    s_lshl_b32 s55, s54, 7
    s_add_u32 s55, s55, s53
    s_sub_i32 s55, s55, 256
    v_lshlrev_b32 v15, 1, v0
    v_add_u32 v15, s55, v15
    v_max_i32 v15, 0, v15
    v_lshlrev_b32 v15, 3, v15
    s_lshl_b32 s56, s22, 9
    v_lshlrev_b32 v4, 3, v0
    v_add_u32 v4, s56, v4
    v_mov_b32 v6, 0x3f80
    v_mov_b32 v7, 0
    ds_write_b64 v4, v[6:7] offset:41280
    v_lshlrev_b32 v1, 2, v29
    v_sub_u32 v1, v28, v1
    v_cmp_le_i32 s[64:65], 0, v1
    v_cmp_le_i32 s[66:67], 1, v1
    v_cmp_le_i32 s[68:69], 2, v1
    v_cmp_le_i32 s[70:71], 3, v1
    v_cmp_le_i32 s[72:73], 8, v1
    v_cmp_le_i32 s[74:75], 9, v1
    v_cmp_le_i32 s[76:77], 10, v1
    v_cmp_le_i32 s[78:79], 11, v1
    v_cmp_le_i32 s[80:81], 16, v1
    v_cmp_le_i32 s[82:83], 17, v1
    v_cmp_le_i32 s[84:85], 18, v1
    v_cmp_le_i32 s[86:87], 19, v1
    v_cmp_le_i32 s[88:89], 24, v1
    v_cmp_le_i32 s[90:91], 25, v1
    v_cmp_le_i32 s[92:93], 26, v1
    v_cmp_le_i32 s[94:95], 27, v1
    v_add_u32 v4, s59, v28
    v_lshlrev_b32 v4, 3, v4
    v_mul_u32_u24 v5, 8256, v29
    v_add_u32 v12, v4, v5
    v_add_u32 v13, 16512, v4
    v_and_b32 v4, 15, v0
    v_lshrrev_b32 v5, 2, v4
    v_lshl_add_u32 v5, v29, 2, v5
    v_add_u32 v5, s59, v5
    v_lshlrev_b32 v5, 3, v5
    v_and_b32 v4, 3, v4
    v_lshrrev_b32 v6, 4, v0
    v_and_b32 v6, 1, v6
    v_lshl_add_u32 v4, v6, 2, v4
    v_min_u32 v4, 5, v4
    v_mul_u32_u24 v4, 4128, v4
    v_add_u32 v4, v4, v5
    v_add_u32 v14, 20640, v4
    v_mov_b32 v230, 0
    v_mov_b32 v231, 0
    v_mov_b32 v16, 0
    v_cmp_eq_u32 vcc, 0, v29
    v_mov_b32 v4, 0x3f803f80
    v_mov_b32 v5, 0x3f80
    v_cndmask_b32 v240, 0, v4, vcc
    v_cndmask_b32 v241, 0, v5, vcc
    v_mov_b32 v242, 0
    v_mov_b32 v243, 0
    v_mov_b32 v246, 0
    v_mov_b32 v247, 0
    s_cmp_lg_u32 s22, 4
    s_cbranch_scc1 ps_nopoll_92
    s_cmp_lg_u32 s3, 0
    s_cbranch_scc1 ps_aw1_94
    s_mov_b32 s60, 2
    s_add_u32 s48, s20, 51134464
    s_addc_u32 s49, s21, 0
    s_mov_b32 s50, 65536
    s_mov_b32 s51, 0x20000
    v_mov_b32 v4, 159768
    ds_read_b64 v[4:5], v4
    v_and_b32 v2, 15, v0
    v_lshrrev_b32 v3, 1, v2
    v_lshlrev_b32 v3, 12, v3
    v_and_b32 v2, 1, v2
    v_add_u32 v2, 30, v2
    v_lshl_add_u32 v2, v2, 7, v3
    s_mov_b32 s42, 0
    s_waitcnt lgkmcnt(0)
ps_gw_95:
    buffer_load_dwordx2 v[6:7], v2, s[48:51], 0 offen sc1
    s_waitcnt vmcnt(0)
    v_sub_u32 v3, v6, v4
    v_subrev_u32 v3, s60, v3
    s_sub_u32 s63, 16, s60
    v_cmp_eq_u32 s[40:41], v7, v5
    v_cmp_gt_u32 vcc, s63, v3
    s_nop 3
    s_and_b64 vcc, vcc, s[40:41]
    s_cmp_eq_u64 vcc, -1
    s_cbranch_scc1 ps_gok_96
ps_ga_97:
    s_sleep 1
    s_add_u32 s42, s42, 1
    s_cmp_lt_u32 s42, 0x20000
    s_cbranch_scc1 ps_gw_95
ps_gok_96:
ps_aw1_94:
    s_mul_i32 s60, s3, 5
    s_add_u32 s60, s60, 1
    s_add_u32 s48, s20, 51134464
    s_addc_u32 s49, s21, 0
    s_mov_b32 s50, 65536
    s_mov_b32 s51, 0x20000
    v_mov_b32 v4, 159768
    ds_read_b64 v[4:5], v4
    s_lshl_b32 s62, s23, 12
    s_add_u32 s62, s62, 32768
    v_and_b32 v2, 31, v0
    v_lshlrev_b32 v2, 7, v2
    v_add_u32 v2, s62, v2
    s_mov_b32 s42, 0
    s_waitcnt lgkmcnt(0)
ps_gw_98:
    buffer_load_dwordx2 v[6:7], v2, s[48:51], 0 offen sc1
    s_waitcnt vmcnt(0)
    v_sub_u32 v3, v6, v4
    v_subrev_u32 v3, s60, v3
    s_sub_u32 s63, 16, s60
    v_cmp_eq_u32 s[40:41], v7, v5
    v_cmp_gt_u32 vcc, s63, v3
    s_nop 3
    s_and_b64 vcc, vcc, s[40:41]
    s_cmp_eq_u64 vcc, -1
    s_cbranch_scc1 ps_gok_99
ps_ga_100:
    s_sleep 1
    s_add_u32 s42, s42, 1
    s_cmp_lt_u32 s42, 0x20000
    s_cbranch_scc1 ps_gw_98
ps_gok_99:
ps_nopoll_92:
    s_waitcnt lgkmcnt(0)
    s_barrier
    s_lshr_b32 s56, s22, 2
    s_lshl_b32 s57, s54, 10
    s_cmp_lt_u32 s54, 2
    s_cbranch_scc1 ps_stp_101
    s_add_u32 s60, s56, 0
    s_cmp_ge_u32 s60, 5
    s_cselect_b32 s61, 2539520, 0
    s_lshl_b32 s62, s60, 14
    s_add_u32 s61, s61, s62
    s_add_u32 s61, s61, s52
    s_add_u32 s61, s61, 2621440
    s_mul_i32 s62, s60, 4128
    s_add_u32 m0, s62, s57
    s_nop 0
    buffer_load_dwordx4 v15, s[24:27], s61 offen sc1 lds
    s_add_u32 s60, s56, 2
    s_cmp_ge_u32 s60, 5
    s_cselect_b32 s61, 2539520, 0
    s_lshl_b32 s62, s60, 14
    s_add_u32 s61, s61, s62
    s_add_u32 s61, s61, s52
    s_add_u32 s61, s61, 2621440
    s_mul_i32 s62, s60, 4128
    s_add_u32 m0, s62, s57
    s_nop 0
    buffer_load_dwordx4 v15, s[24:27], s61 offen sc1 lds
    s_add_u32 s60, s56, 4
    s_cmp_ge_u32 s60, 5
    s_cselect_b32 s61, 2539520, 0
    s_lshl_b32 s62, s60, 14
    s_add_u32 s61, s61, s62
    s_add_u32 s61, s61, s52
    s_add_u32 s61, s61, 2621440
    s_mul_i32 s62, s60, 4128
    s_add_u32 m0, s62, s57
    s_nop 0
    buffer_load_dwordx4 v15, s[24:27], s61 offen sc1 lds
    s_add_u32 s60, s56, 6
    s_cmp_ge_u32 s60, 5
    s_cselect_b32 s61, 2539520, 0
    s_lshl_b32 s62, s60, 14
    s_add_u32 s61, s61, s62
    s_add_u32 s61, s61, s52
    s_add_u32 s61, s61, 2621440
    s_mul_i32 s62, s60, 4128
    s_add_u32 m0, s62, s57
    s_nop 0
    buffer_load_dwordx4 v15, s[24:27], s61 offen sc1 lds
    s_add_u32 s60, s56, 8
    s_cmp_ge_u32 s60, 5
    s_cselect_b32 s61, 2539520, 0
    s_lshl_b32 s62, s60, 14
    s_add_u32 s61, s61, s62
    s_add_u32 s61, s61, s52
    s_add_u32 s61, s61, 2621440
    s_mul_i32 s62, s60, 4128
    s_add_u32 m0, s62, s57
    s_nop 0
    buffer_load_dwordx4 v15, s[24:27], s61 offen sc1 lds
    buffer_load_dwordx2 v[224:225], v11, s[24:27], 0 offen sc1
    s_mov_b32 s60, 16384
    s_mov_b32 s61, 65536
    buffer_load_dwordx2 v[226:227], v11, s[24:27], s60 offen sc1
    buffer_load_dwordx2 v[228:229], v10, s[24:27], s61 offen sc1
    v_mov_b32 v2, 159752
    ds_read_b32 v3, v2
    s_waitcnt lgkmcnt(0)
    v_readfirstlane_b32 s0, v3
    s_waitcnt vmcnt(0)
    s_branch ps_stj_102
ps_stp_101:
    buffer_load_dwordx2 v[224:225], v11, s[24:27], 0 offen sc1
    s_mov_b32 s60, 16384
    s_mov_b32 s61, 65536
    buffer_load_dwordx2 v[226:227], v11, s[24:27], s60 offen sc1
    buffer_load_dwordx2 v[228:229], v10, s[24:27], s61 offen sc1
    s_cmp_eq_u32 s23, 0
    s_cbranch_scc1 ps_stg_103
    s_cmp_lg_u32 s22, 0
    s_cbranch_scc1 ps_stw_104
    s_lshl_b32 s60, s3, 1
    s_add_u32 s60, s60, 2
    s_add_u32 s48, s20, 51134464
    s_addc_u32 s49, s21, 0
    s_mov_b32 s50, 65536
    s_mov_b32 s51, 0x20000
    v_mov_b32 v4, 159768
    ds_read_b64 v[4:5], v4
    s_lshl_b32 s62, s23, 12
    v_and_b32 v2, 31, v0
    v_lshlrev_b32 v2, 7, v2
    v_add_u32 v2, s62, v2
    v_subrev_u32 v2, 4096, v2
    s_mov_b32 s42, 0
    s_waitcnt lgkmcnt(0)
ps_gw_105:
    buffer_load_dwordx2 v[6:7], v2, s[48:51], 0 offen sc1
    s_waitcnt vmcnt(0)
    v_sub_u32 v3, v6, v4
    v_subrev_u32 v3, s60, v3
    s_sub_u32 s63, 16, s60
    v_cmp_eq_u32 s[40:41], v7, v5
    v_cmp_gt_u32 vcc, s63, v3
    s_nop 3
    s_and_b64 vcc, vcc, s[40:41]
    s_cmp_eq_u64 vcc, -1
    s_cbranch_scc1 ps_gok_106
ps_ga_107:
    s_sleep 1
    s_add_u32 s42, s42, 1
    s_cmp_lt_u32 s42, 0x20000
    s_cbranch_scc1 ps_gw_105
ps_gok_106:
    s_add_u32 s60, s3, 1
    v_mov_b32 v2, 159764
    v_mov_b32 v3, s60
    ds_write_b32 v2, v3
    s_branch ps_stg_103
ps_stw_104:
    s_add_u32 s60, s3, 1
    v_mov_b32 v2, 159764
    s_mov_b32 s42, 0
ps_lw_108:
    ds_read_b32 v3, v2
    s_add_u32 s42, s42, 1
    s_waitcnt lgkmcnt(0)
    v_cmp_gt_u32 vcc, s60, v3
    s_cbranch_vccz ps_lok_109
    s_sleep 1
    s_cmp_lt_u32 s42, 0x200000
    s_cbranch_scc1 ps_lw_108
ps_lok_109:
ps_stg_103:
    s_add_u32 s60, s56, 0
    s_cmp_ge_u32 s60, 5
    s_cselect_b32 s61, 2539520, 0
    s_lshl_b32 s62, s60, 14
    s_add_u32 s61, s61, s62
    s_add_u32 s61, s61, s52
    s_add_u32 s61, s61, 2621440
    s_mul_i32 s62, s60, 4128
    s_add_u32 m0, s62, s57
    s_nop 0
    buffer_load_dwordx4 v15, s[24:27], s61 offen sc1 lds
    s_add_u32 s60, s56, 2
    s_cmp_ge_u32 s60, 5
    s_cselect_b32 s61, 2539520, 0
    s_lshl_b32 s62, s60, 14
    s_add_u32 s61, s61, s62
    s_add_u32 s61, s61, s52
    s_add_u32 s61, s61, 2621440
    s_mul_i32 s62, s60, 4128
    s_add_u32 m0, s62, s57
    s_nop 0
    buffer_load_dwordx4 v15, s[24:27], s61 offen sc1 lds
    s_add_u32 s60, s56, 4
    s_cmp_ge_u32 s60, 5
    s_cselect_b32 s61, 2539520, 0
    s_lshl_b32 s62, s60, 14
    s_add_u32 s61, s61, s62
    s_add_u32 s61, s61, s52
    s_add_u32 s61, s61, 2621440
    s_mul_i32 s62, s60, 4128
    s_add_u32 m0, s62, s57
    s_nop 0
    buffer_load_dwordx4 v15, s[24:27], s61 offen sc1 lds
    s_add_u32 s60, s56, 6
    s_cmp_ge_u32 s60, 5
    s_cselect_b32 s61, 2539520, 0
    s_lshl_b32 s62, s60, 14
    s_add_u32 s61, s61, s62
    s_add_u32 s61, s61, s52
    s_add_u32 s61, s61, 2621440
    s_mul_i32 s62, s60, 4128
    s_add_u32 m0, s62, s57
    s_nop 0
    buffer_load_dwordx4 v15, s[24:27], s61 offen sc1 lds
    s_add_u32 s60, s56, 8
    s_cmp_ge_u32 s60, 5
    s_cselect_b32 s61, 2539520, 0
    s_lshl_b32 s62, s60, 14
    s_add_u32 s61, s61, s62
    s_add_u32 s61, s61, s52
    s_add_u32 s61, s61, 2621440
    s_mul_i32 s62, s60, 4128
    s_add_u32 m0, s62, s57
    s_nop 0
    buffer_load_dwordx4 v15, s[24:27], s61 offen sc1 lds
    v_mov_b32 v2, 159752
    ds_read_b32 v3, v2
    s_waitcnt lgkmcnt(0)
    v_readfirstlane_b32 s0, v3
    s_waitcnt vmcnt(5)
ps_stj_102:
    v_cmp_eq_u32 vcc, 0, v29
    s_nop 1
    v_cndmask_b32 v228, 0, v228, vcc
    v_cndmask_b32 v229, 0, v229, vcc
    s_cmp_lg_u32 s3, 0
    s_cbranch_scc1 ps_rtinv_110
    s_cmp_ge_u32 s22, 4
    s_cbranch_scc1 ps_rtinv_110
    s_cmp_eq_u32 s32, 0
    s_cbranch_scc1 ps_rtinv_110
    s_add_u32 s36, s20, 43540480
    s_addc_u32 s37, s21, 0
    s_mov_b32 s38, 7454720
    s_mov_b32 s39, 0x20000
    v_lshlrev_b32 v4, 4, v0
    buffer_store_dwordx4 v[112:115], v4, s[36:39], s33 offen offset:0 sc1
    buffer_store_dwordx4 v[116:119], v4, s[36:39], s33 offen offset:1024 sc1
    s_add_u32 s33, s33, s34
    buffer_store_dwordx4 v[120:123], v4, s[36:39], s33 offen offset:0 sc1
    buffer_store_dwordx4 v[124:127], v4, s[36:39], s33 offen offset:1024 sc1
    s_add_u32 s33, s33, s34
    buffer_store_dwordx4 v[128:131], v4, s[36:39], s33 offen offset:0 sc1
    buffer_store_dwordx4 v[132:135], v4, s[36:39], s33 offen offset:1024 sc1
    s_add_u32 s33, s33, s34
    buffer_store_dwordx4 v[136:139], v4, s[36:39], s33 offen offset:0 sc1
    buffer_store_dwordx4 v[140:143], v4, s[36:39], s33 offen offset:1024 sc1
    s_add_u32 s33, s33, s34
    s_cmp_eq_u32 s35, -1
    s_cbranch_scc1 ps_rtinv_110
    s_add_u32 s44, s20, 50995200
    s_addc_u32 s45, s21, 0
    s_mov_b32 s46, 138240
    s_mov_b32 s47, 0x20000
    v_lshrrev_b32 v5, 4, v0
    v_lshlrev_b32 v5, 4, v5
    s_mov_b32 exec_lo, 0x00010001
    s_mov_b32 exec_hi, 0x00010001
    buffer_store_dwordx4 v[176:179], v5, s[44:47], s35 offen offset:0 sc1
    buffer_store_dwordx4 v[180:183], v5, s[44:47], s35 offen offset:64 sc1
    buffer_store_dwordx4 v[184:187], v5, s[44:47], s35 offen offset:128 sc1
    buffer_store_dwordx4 v[188:191], v5, s[44:47], s35 offen offset:192 sc1
    s_mov_b64 exec, -1
ps_rtinv_110:
    v_mov_b32 v182, 0
    v_mov_b32 v183, 0
    v_mov_b32 v190, 0
    v_mov_b32 v191, 0
    s_barrier
    s_add_u32 s36, s20, 43540480
    s_addc_u32 s37, s21, 0
    s_mov_b32 s38, 819200
    s_mov_b32 s39, 0x20000
    s_lshr_b32 s44, s96, 2
    s_mul_i32 s44, s44, 102400
    v_lshlrev_b32 v17, 4, v0
    v_add_u32 v17, s44, v17
    s_lshr_b32 s44, s22, 1
    s_mul_i32 s44, s44, 20480
    s_and_b32 s45, s22, 1
    s_lshl_b32 s46, s45, 10
    s_add_u32 s44, s44, s46
    s_lshr_b32 s47, s22, 1
    s_lshl_b32 s43, s47, 11
    s_add_u32 s46, s46, s43
    s_add_u32 s46, s46, 81920
    s_mul_i32 s47, s47, 10240
    s_lshl_b32 s45, s45, 10
    s_add_u32 s47, s47, s45
    s_add_u32 s47, s47, 57344
    s_lshl_b32 s45, s22, 10
    s_add_u32 s45, s45, 49152
    s_sub_u32 s43, 11, s22
    s_cmp_lt_u32 s22, 4
    s_cselect_b32 s43, s22, s43
    ds_read_b64 v[176:177], v12 offset:2048
    ds_read_b64 v[178:179], v12 offset:6176
    ds_read_b64 v[180:181], v13 offset:2048
    ds_read_b64 v[184:185], v12 offset:1792
    ds_read_b64 v[186:187], v12 offset:5920
    ds_read_b64 v[188:189], v13 offset:1792
    s_waitcnt lgkmcnt(3)
    v_mfma_f32_32x32x16_bf16 v[160:175], v[176:179], v[224:227], 0
    v_mfma_f32_32x32x16_bf16 v[160:175], v[180:183], v[228:231], v[160:175]
    s_cmp_eq_u32 s43, 0
    s_cbranch_scc1 ps_qkx_113
    ds_read_b64 v[176:177], v12 offset:1536
    ds_read_b64 v[178:179], v12 offset:5664
    ds_read_b64 v[180:181], v13 offset:1536
    s_waitcnt lgkmcnt(3)
    v_mfma_f32_32x32x16_bf16 v[144:159], v[184:187], v[224:227], 0
    v_mfma_f32_32x32x16_bf16 v[144:159], v[188:191], v[228:231], v[144:159]
    s_cmp_eq_u32 s43, 1
    s_cbranch_scc1 ps_qkx_113
    ds_read_b64 v[184:185], v12 offset:1280
    ds_read_b64 v[186:187], v12 offset:5408
    ds_read_b64 v[188:189], v13 offset:1280
    s_waitcnt lgkmcnt(3)
    v_mfma_f32_32x32x16_bf16 v[128:143], v[176:179], v[224:227], 0
    v_mfma_f32_32x32x16_bf16 v[128:143], v[180:183], v[228:231], v[128:143]
    s_cmp_eq_u32 s43, 2
    s_cbranch_scc1 ps_qkx_113
    ds_read_b64 v[176:177], v12 offset:1024
    ds_read_b64 v[178:179], v12 offset:5152
    ds_read_b64 v[180:181], v13 offset:1024
    s_waitcnt lgkmcnt(3)
    v_mfma_f32_32x32x16_bf16 v[112:127], v[184:187], v[224:227], 0
    v_mfma_f32_32x32x16_bf16 v[112:127], v[188:191], v[228:231], v[112:127]
    s_cmp_eq_u32 s43, 3
    s_cbranch_scc1 ps_qkx_113
    ds_read_b64 v[184:185], v12 offset:768
    ds_read_b64 v[186:187], v12 offset:4896
    ds_read_b64 v[188:189], v13 offset:768
    s_waitcnt lgkmcnt(3)
    v_mfma_f32_32x32x16_bf16 v[96:111], v[176:179], v[224:227], 0
    v_mfma_f32_32x32x16_bf16 v[96:111], v[180:183], v[228:231], v[96:111]
    s_cmp_eq_u32 s43, 4
    s_cbranch_scc1 ps_qkx_113
    ds_read_b64 v[176:177], v12 offset:512
    ds_read_b64 v[178:179], v12 offset:4640
    ds_read_b64 v[180:181], v13 offset:512
    s_waitcnt lgkmcnt(3)
    v_mfma_f32_32x32x16_bf16 v[80:95], v[184:187], v[224:227], 0
    v_mfma_f32_32x32x16_bf16 v[80:95], v[188:191], v[228:231], v[80:95]
    s_cmp_eq_u32 s43, 5
    s_cbranch_scc1 ps_qkx_113
    ds_read_b64 v[184:185], v12 offset:256
    ds_read_b64 v[186:187], v12 offset:4384
    ds_read_b64 v[188:189], v13 offset:256
    s_waitcnt lgkmcnt(3)
    v_mfma_f32_32x32x16_bf16 v[64:79], v[176:179], v[224:227], 0
    v_mfma_f32_32x32x16_bf16 v[64:79], v[180:183], v[228:231], v[64:79]
    s_cmp_eq_u32 s43, 6
    s_cbranch_scc1 ps_qkx_113
    s_waitcnt lgkmcnt(0)
    v_mfma_f32_32x32x16_bf16 v[48:63], v[184:187], v[224:227], 0
    v_mfma_f32_32x32x16_bf16 v[48:63], v[188:191], v[228:231], v[48:63]
ps_qkx_113:
    s_waitcnt lgkmcnt(0)
    s_cmp_ge_u32 s54, 2
    s_cbranch_scc1 ps_wd_117
    s_cmp_lg_u32 s3, 0
    s_cbranch_scc1 ps_w0_116
    s_cmp_ge_u32 s22, 4
    s_cbranch_scc1 ps_w0_116
    s_cmp_eq_u32 s32, 0
    s_cbranch_scc1 ps_w0_116
    s_cmp_eq_u32 s35, -1
    s_cbranch_scc1 ps_w8_115
    s_waitcnt vmcnt(12)
    s_branch ps_wd_117
ps_w8_115:
    s_waitcnt vmcnt(8)
    s_branch ps_wd_117
ps_w0_116:
    s_waitcnt vmcnt(0)
ps_wd_117:
    s_barrier
    s_mul_i32 s61, s96, 5
    s_lshr_b32 s61, s61, 1
    s_lshl_b32 s61, s61, 8
    s_lshr_b32 s62, s58, 4
    s_mul_i32 s62, s62, 20480
    s_add_u32 s61, s61, s62
    v_lshrrev_b32 v4, 3, v0
    v_mul_u32_u24 v4, 20480, v4
    v_and_b32 v5, 7, v0
    v_lshl_add_u32 v4, v5, 7, v4
    v_add_u32 v4, s61, v4
    s_mov_b64 exec, 0x3f3f
    buffer_load_dword v250, v4, s[28:31], 0 offen sc1
    s_mov_b64 exec, -1
ps_not0_118:
    s_sub_u32 s60, 7, s43
    ds_read_b64 v[176:177], v12 offset:0
    ds_read_b64 v[178:179], v12 offset:4128
    ds_read_b64 v[180:181], v13 offset:0
    ds_read_b64 v[184:185], v12 offset:256
    ds_read_b64 v[186:187], v12 offset:4384
    ds_read_b64 v[188:189], v13 offset:256
    s_waitcnt lgkmcnt(3)
    v_mfma_f32_32x32x16_bf16 v[32:47], v[176:179], v[224:227], 0
    v_mfma_f32_32x32x16_bf16 v[32:47], v[180:183], v[228:231], v[32:47]
    s_cmp_eq_u32 s60, 0
    s_cbranch_scc1 ps_qkx_119
    ds_read_b64 v[176:177], v12 offset:512
    ds_read_b64 v[178:179], v12 offset:4640
    ds_read_b64 v[180:181], v13 offset:512
    s_waitcnt lgkmcnt(3)
    v_mfma_f32_32x32x16_bf16 v[48:63], v[184:187], v[224:227], 0
    v_mfma_f32_32x32x16_bf16 v[48:63], v[188:191], v[228:231], v[48:63]
    s_cmp_eq_u32 s60, 1
    s_cbranch_scc1 ps_qkx_119
    ds_read_b64 v[184:185], v12 offset:768
    ds_read_b64 v[186:187], v12 offset:4896
    ds_read_b64 v[188:189], v13 offset:768
    s_waitcnt lgkmcnt(3)
    v_mfma_f32_32x32x16_bf16 v[64:79], v[176:179], v[224:227], 0
    v_mfma_f32_32x32x16_bf16 v[64:79], v[180:183], v[228:231], v[64:79]
    s_cmp_eq_u32 s60, 2
    s_cbranch_scc1 ps_qkx_119
    ds_read_b64 v[176:177], v12 offset:1024
    ds_read_b64 v[178:179], v12 offset:5152
    ds_read_b64 v[180:181], v13 offset:1024
    s_waitcnt lgkmcnt(3)
    v_mfma_f32_32x32x16_bf16 v[80:95], v[184:187], v[224:227], 0
    v_mfma_f32_32x32x16_bf16 v[80:95], v[188:191], v[228:231], v[80:95]
    s_cmp_eq_u32 s60, 3
    s_cbranch_scc1 ps_qkx_119
    ds_read_b64 v[184:185], v12 offset:1280
    ds_read_b64 v[186:187], v12 offset:5408
    ds_read_b64 v[188:189], v13 offset:1280
    s_waitcnt lgkmcnt(3)
    v_mfma_f32_32x32x16_bf16 v[96:111], v[176:179], v[224:227], 0
    v_mfma_f32_32x32x16_bf16 v[96:111], v[180:183], v[228:231], v[96:111]
    s_cmp_eq_u32 s60, 4
    s_cbranch_scc1 ps_qkx_119
    ds_read_b64 v[176:177], v12 offset:1536
    ds_read_b64 v[178:179], v12 offset:5664
    ds_read_b64 v[180:181], v13 offset:1536
    s_waitcnt lgkmcnt(3)
    v_mfma_f32_32x32x16_bf16 v[112:127], v[184:187], v[224:227], 0
    v_mfma_f32_32x32x16_bf16 v[112:127], v[188:191], v[228:231], v[112:127]
    s_cmp_eq_u32 s60, 5
    s_cbranch_scc1 ps_qkx_119
    ds_read_b64 v[184:185], v12 offset:1792
    ds_read_b64 v[186:187], v12 offset:5920
    ds_read_b64 v[188:189], v13 offset:1792
    s_waitcnt lgkmcnt(3)
    v_mfma_f32_32x32x16_bf16 v[128:143], v[176:179], v[224:227], 0
    v_mfma_f32_32x32x16_bf16 v[128:143], v[180:183], v[228:231], v[128:143]
    s_cmp_eq_u32 s60, 6
    s_cbranch_scc1 ps_qkx_119
    s_waitcnt lgkmcnt(0)
    v_mfma_f32_32x32x16_bf16 v[144:159], v[184:187], v[224:227], 0
    v_mfma_f32_32x32x16_bf16 v[144:159], v[188:191], v[228:231], v[144:159]
ps_qkx_119:
    s_waitcnt lgkmcnt(0)
    ds_read_b64_tr_b16 v[192:193], v14 offset:0
    ds_read_b64_tr_b16 v[194:195], v14 offset:64
    ds_read_b64_tr_b16 v[196:197], v14 offset:128
    ds_read_b64_tr_b16 v[198:199], v14 offset:192
    s_cmp_lg_u32 s23, 0
    s_cbranch_scc1 ps_valid_120
    s_sub_u32 s60, 8, s43
    s_nop 7
    s_nop 3
    s_cmp_le_u32 s60, 0
    s_cbranch_scc1 ps_valid_120
    v_mov_b32 v32, 0xff800000
    v_mov_b32 v33, 0xff800000
    v_mov_b32 v34, 0xff800000
    v_mov_b32 v35, 0xff800000
    v_mov_b32 v36, 0xff800000
    v_mov_b32 v37, 0xff800000
    v_mov_b32 v38, 0xff800000
    v_mov_b32 v39, 0xff800000
    v_mov_b32 v40, 0xff800000
    v_mov_b32 v41, 0xff800000
    v_mov_b32 v42, 0xff800000
    v_mov_b32 v43, 0xff800000
    v_mov_b32 v44, 0xff800000
    v_mov_b32 v45, 0xff800000
    v_mov_b32 v46, 0xff800000
    v_mov_b32 v47, 0xff800000
    s_cmp_le_u32 s60, 1
    s_cbranch_scc1 ps_valid_120
    v_mov_b32 v48, 0xff800000
    v_mov_b32 v49, 0xff800000
    v_mov_b32 v50, 0xff800000
    v_mov_b32 v51, 0xff800000
    v_mov_b32 v52, 0xff800000
    v_mov_b32 v53, 0xff800000
    v_mov_b32 v54, 0xff800000
    v_mov_b32 v55, 0xff800000
    v_mov_b32 v56, 0xff800000
    v_mov_b32 v57, 0xff800000
    v_mov_b32 v58, 0xff800000
    v_mov_b32 v59, 0xff800000
    v_mov_b32 v60, 0xff800000
    v_mov_b32 v61, 0xff800000
    v_mov_b32 v62, 0xff800000
    v_mov_b32 v63, 0xff800000
    s_cmp_le_u32 s60, 2
    s_cbranch_scc1 ps_valid_120
    v_mov_b32 v64, 0xff800000
    v_mov_b32 v65, 0xff800000
    v_mov_b32 v66, 0xff800000
    v_mov_b32 v67, 0xff800000
    v_mov_b32 v68, 0xff800000
    v_mov_b32 v69, 0xff800000
    v_mov_b32 v70, 0xff800000
    v_mov_b32 v71, 0xff800000
    v_mov_b32 v72, 0xff800000
    v_mov_b32 v73, 0xff800000
    v_mov_b32 v74, 0xff800000
    v_mov_b32 v75, 0xff800000
    v_mov_b32 v76, 0xff800000
    v_mov_b32 v77, 0xff800000
    v_mov_b32 v78, 0xff800000
    v_mov_b32 v79, 0xff800000
    s_cmp_le_u32 s60, 3
    s_cbranch_scc1 ps_valid_120
    v_mov_b32 v80, 0xff800000
    v_mov_b32 v81, 0xff800000
    v_mov_b32 v82, 0xff800000
    v_mov_b32 v83, 0xff800000
    v_mov_b32 v84, 0xff800000
    v_mov_b32 v85, 0xff800000
    v_mov_b32 v86, 0xff800000
    v_mov_b32 v87, 0xff800000
    v_mov_b32 v88, 0xff800000
    v_mov_b32 v89, 0xff800000
    v_mov_b32 v90, 0xff800000
    v_mov_b32 v91, 0xff800000
    v_mov_b32 v92, 0xff800000
    v_mov_b32 v93, 0xff800000
    v_mov_b32 v94, 0xff800000
    v_mov_b32 v95, 0xff800000
    s_cmp_le_u32 s60, 4
    s_cbranch_scc1 ps_valid_120
    v_mov_b32 v96, 0xff800000
    v_mov_b32 v97, 0xff800000
    v_mov_b32 v98, 0xff800000
    v_mov_b32 v99, 0xff800000
    v_mov_b32 v100, 0xff800000
    v_mov_b32 v101, 0xff800000
    v_mov_b32 v102, 0xff800000
    v_mov_b32 v103, 0xff800000
    v_mov_b32 v104, 0xff800000
    v_mov_b32 v105, 0xff800000
    v_mov_b32 v106, 0xff800000
    v_mov_b32 v107, 0xff800000
    v_mov_b32 v108, 0xff800000
    v_mov_b32 v109, 0xff800000
    v_mov_b32 v110, 0xff800000
    v_mov_b32 v111, 0xff800000
    s_cmp_le_u32 s60, 5
    s_cbranch_scc1 ps_valid_120
    v_mov_b32 v112, 0xff800000
    v_mov_b32 v113, 0xff800000
    v_mov_b32 v114, 0xff800000
    v_mov_b32 v115, 0xff800000
    v_mov_b32 v116, 0xff800000
    v_mov_b32 v117, 0xff800000
    v_mov_b32 v118, 0xff800000
    v_mov_b32 v119, 0xff800000
    v_mov_b32 v120, 0xff800000
    v_mov_b32 v121, 0xff800000
    v_mov_b32 v122, 0xff800000
    v_mov_b32 v123, 0xff800000
    v_mov_b32 v124, 0xff800000
    v_mov_b32 v125, 0xff800000
    v_mov_b32 v126, 0xff800000
    v_mov_b32 v127, 0xff800000
    s_cmp_le_u32 s60, 6
    s_cbranch_scc1 ps_valid_120
    v_mov_b32 v128, 0xff800000
    v_mov_b32 v129, 0xff800000
    v_mov_b32 v130, 0xff800000
    v_mov_b32 v131, 0xff800000
    v_mov_b32 v132, 0xff800000
    v_mov_b32 v133, 0xff800000
    v_mov_b32 v134, 0xff800000
    v_mov_b32 v135, 0xff800000
    v_mov_b32 v136, 0xff800000
    v_mov_b32 v137, 0xff800000
    v_mov_b32 v138, 0xff800000
    v_mov_b32 v139, 0xff800000
    v_mov_b32 v140, 0xff800000
    v_mov_b32 v141, 0xff800000
    v_mov_b32 v142, 0xff800000
    v_mov_b32 v143, 0xff800000
    s_cmp_le_u32 s60, 7
    s_cbranch_scc1 ps_valid_120
    v_mov_b32 v144, 0xff800000
    v_mov_b32 v145, 0xff800000
    v_mov_b32 v146, 0xff800000
    v_mov_b32 v147, 0xff800000
    v_mov_b32 v148, 0xff800000
    v_mov_b32 v149, 0xff800000
    v_mov_b32 v150, 0xff800000
    v_mov_b32 v151, 0xff800000
    v_mov_b32 v152, 0xff800000
    v_mov_b32 v153, 0xff800000
    v_mov_b32 v154, 0xff800000
    v_mov_b32 v155, 0xff800000
    v_mov_b32 v156, 0xff800000
    v_mov_b32 v157, 0xff800000
    v_mov_b32 v158, 0xff800000
    v_mov_b32 v159, 0xff800000
ps_valid_120:
    s_nop 7
    s_nop 3
    v_max_f32 v232, v48, v49
    v_max_f32 v233, v50, v51
    v_max3_f32 v232, v232, v52, v53
    v_max3_f32 v233, v233, v54, v55
    v_max3_f32 v232, v232, v56, v57
    v_max3_f32 v233, v233, v58, v59
    v_max3_f32 v232, v232, v60, v61
    v_max3_f32 v233, v233, v62, v63
    v_max3_f32 v232, v232, v64, v65
    v_max3_f32 v233, v233, v66, v67
    v_max3_f32 v232, v232, v68, v69
    v_max3_f32 v233, v233, v70, v71
    v_max3_f32 v232, v232, v72, v73
    v_max3_f32 v233, v233, v74, v75
    v_max3_f32 v232, v232, v76, v77
    v_max3_f32 v233, v233, v78, v79
    v_max3_f32 v232, v232, v80, v81
    v_max3_f32 v233, v233, v82, v83
    v_max3_f32 v232, v232, v84, v85
    v_max3_f32 v233, v233, v86, v87
    v_max3_f32 v232, v232, v88, v89
    v_max3_f32 v233, v233, v90, v91
    v_max3_f32 v232, v232, v92, v93
    v_max3_f32 v233, v233, v94, v95
    v_max3_f32 v232, v232, v96, v97
    v_max3_f32 v233, v233, v98, v99
    v_max3_f32 v232, v232, v100, v101
    v_max3_f32 v233, v233, v102, v103
    v_max3_f32 v232, v232, v104, v105
    v_max3_f32 v233, v233, v106, v107
    v_max3_f32 v232, v232, v108, v109
    v_max3_f32 v233, v233, v110, v111
    v_max3_f32 v232, v232, v112, v113
    v_max3_f32 v233, v233, v114, v115
    v_max3_f32 v232, v232, v116, v117
    v_max3_f32 v233, v233, v118, v119
    v_max3_f32 v232, v232, v120, v121
    v_max3_f32 v233, v233, v122, v123
    v_max3_f32 v232, v232, v124, v125
    v_max3_f32 v233, v233, v126, v127
    v_max3_f32 v232, v232, v128, v129
    v_max3_f32 v233, v233, v130, v131
    v_max3_f32 v232, v232, v132, v133
    v_max3_f32 v233, v233, v134, v135
    v_max3_f32 v232, v232, v136, v137
    v_max3_f32 v233, v233, v138, v139
    v_max3_f32 v232, v232, v140, v141
    v_max3_f32 v233, v233, v142, v143
    v_max3_f32 v232, v232, v144, v145
    v_max3_f32 v233, v233, v146, v147
    v_max3_f32 v232, v232, v148, v149
    v_max3_f32 v233, v233, v150, v151
    v_max3_f32 v232, v232, v152, v153
    v_max3_f32 v233, v233, v154, v155
    v_max3_f32 v232, v232, v156, v157
    v_max3_f32 v233, v233, v158, v159
ps_amax_112:
    s_nop 7
    s_mov_b64 vcc, s[64:65]
    v_cndmask_b32 v32, v32, v160, vcc
    s_mov_b64 vcc, s[66:67]
    v_cndmask_b32 v33, v33, v161, vcc
    s_mov_b64 vcc, s[68:69]
    v_cndmask_b32 v34, v34, v162, vcc
    s_mov_b64 vcc, s[70:71]
    v_cndmask_b32 v35, v35, v163, vcc
    s_mov_b64 vcc, s[72:73]
    v_cndmask_b32 v36, v36, v164, vcc
    s_mov_b64 vcc, s[74:75]
    v_cndmask_b32 v37, v37, v165, vcc
    s_mov_b64 vcc, s[76:77]
    v_cndmask_b32 v38, v38, v166, vcc
    s_mov_b64 vcc, s[78:79]
    v_cndmask_b32 v39, v39, v167, vcc
    s_mov_b64 vcc, s[80:81]
    v_cndmask_b32 v40, v40, v168, vcc
    s_mov_b64 vcc, s[82:83]
    v_cndmask_b32 v41, v41, v169, vcc
    s_mov_b64 vcc, s[84:85]
    v_cndmask_b32 v42, v42, v170, vcc
    s_mov_b64 vcc, s[86:87]
    v_cndmask_b32 v43, v43, v171, vcc
    s_mov_b64 vcc, s[88:89]
    v_cndmask_b32 v44, v44, v172, vcc
    s_mov_b64 vcc, s[90:91]
    v_cndmask_b32 v45, v45, v173, vcc
    s_mov_b64 vcc, s[92:93]
    v_cndmask_b32 v46, v46, v174, vcc
    s_mov_b64 vcc, s[94:95]
    v_cndmask_b32 v47, v47, v175, vcc
    v_max3_f32 v232, v232, v32, v33
    v_max3_f32 v233, v233, v34, v35
    v_max3_f32 v232, v232, v36, v37
    v_max3_f32 v233, v233, v38, v39
    v_max3_f32 v232, v232, v40, v41
    v_max3_f32 v233, v233, v42, v43
    v_max3_f32 v232, v232, v44, v45
    v_max3_f32 v233, v233, v46, v47
    v_max_f32 v232, v232, v233
    v_mov_b32 v233, v232
    s_nop 1
    v_permlane32_swap_b32 v233, v232
    v_max_f32 v232, v232, v233
    s_cmp_lg_u32 s3, 0
    s_cbranch_scc1 ps_rtd_121
    s_cmp_ge_u32 s22, 4
    s_cbranch_scc1 ps_rtd_121
    s_waitcnt vmcnt(0)
    v_mov_b32 v4, 159768
    ds_read_b64 v[4:5], v4
    v_mov_b32 v6, 159760
    v_mov_b32 v7, 3
    s_mov_b64 exec, 1
    ds_inc_rtn_u32 v8, v6, v7
    s_waitcnt lgkmcnt(0)
    v_readfirstlane_b32 s61, v8
    s_mov_b64 exec, -1
    s_nop 2
    s_cmp_lg_u32 s61, 3
    s_cbranch_scc1 ps_rtd_121
    s_add_u32 s48, s20, 51134464
    s_addc_u32 s49, s21, 0
    s_mov_b32 s50, 65536
    s_mov_b32 s51, 0x20000
    s_lshl_b32 s62, s23, 12
    s_lshl_b32 s63, s96, 7
    s_add_u32 s62, s62, s63
    v_mov_b32 v8, s62
    s_getreg_b32 s63, hwreg(HW_REG_XCC_ID)
    s_and_b32 s63, s63, 15
    v_add_u32 v4, 3, v4
    v_mov_b32 v6, s63
    v_mov_b32 v7, 0
    s_mov_b64 exec, 1
    buffer_store_dwordx4 v[4:7], v8, s[48:51], 0 offen sc1
    s_mov_b64 exec, -1
ps_rtd_121:
    v_sub_f32 v232, 0, v232
    v_and_b32 v233, 0xffff0000, v232
    v_sub_f32 v234, v232, v233
    v_and_b32 v235, 0xffff0000, v234
    v_sub_f32 v234, v234, v235
    v_lshrrev_b32 v233, 16, v233
    v_or_b32 v233, v233, v235
    v_lshrrev_b32 v234, 16, v234
    v_cmp_eq_u32 vcc, 0, v29
    s_nop 1
    v_cndmask_b32 v244, 0, v233, vcc
    v_cndmask_b32 v245, 0, v234, vcc
    s_nop 1
    v_mfma_f32_32x32x16_bf16 v[32:47], v[240:243], v[244:247], v[32:47]
    v_mfma_f32_32x32x16_bf16 v[48:63], v[240:243], v[244:247], v[48:63]
    v_mfma_f32_32x32x16_bf16 v[64:79], v[240:243], v[244:247], v[64:79]
    v_mfma_f32_32x32x16_bf16 v[80:95], v[240:243], v[244:247], v[80:95]
    v_mfma_f32_32x32x16_bf16 v[96:111], v[240:243], v[244:247], v[96:111]
    v_mfma_f32_32x32x16_bf16 v[112:127], v[240:243], v[244:247], v[112:127]
    v_mfma_f32_32x32x16_bf16 v[128:143], v[240:243], v[244:247], v[128:143]
    v_mfma_f32_32x32x16_bf16 v[144:159], v[240:243], v[244:247], v[144:159]
    s_nop 4
    v_exp_f32 v32, v32
    v_exp_f32 v33, v33
    v_exp_f32 v34, v34
    v_exp_f32 v35, v35
    v_exp_f32 v36, v36
    v_exp_f32 v37, v37
    v_exp_f32 v38, v38
    v_exp_f32 v39, v39
    v_exp_f32 v40, v40
    v_exp_f32 v41, v41
    v_exp_f32 v42, v42
    v_exp_f32 v43, v43
    v_exp_f32 v44, v44
    v_exp_f32 v45, v45
    v_exp_f32 v46, v46
    v_exp_f32 v47, v47
    s_mov_b64 vcc, s[64:65]
    v_cndmask_b32 v160, 0, v32, vcc
    v_cndmask_b32 v32, v32, v16, vcc
    s_mov_b64 vcc, s[66:67]
    v_cndmask_b32 v161, 0, v33, vcc
    v_cndmask_b32 v33, v33, v16, vcc
    s_mov_b64 vcc, s[68:69]
    v_cndmask_b32 v162, 0, v34, vcc
    v_cndmask_b32 v34, v34, v16, vcc
    s_mov_b64 vcc, s[70:71]
    v_cndmask_b32 v163, 0, v35, vcc
    v_cndmask_b32 v35, v35, v16, vcc
    s_mov_b64 vcc, s[72:73]
    v_cndmask_b32 v164, 0, v36, vcc
    v_cndmask_b32 v36, v36, v16, vcc
    s_mov_b64 vcc, s[74:75]
    v_cndmask_b32 v165, 0, v37, vcc
    v_cndmask_b32 v37, v37, v16, vcc
    s_mov_b64 vcc, s[76:77]
    v_cndmask_b32 v166, 0, v38, vcc
    v_cndmask_b32 v38, v38, v16, vcc
    s_mov_b64 vcc, s[78:79]
    v_cndmask_b32 v167, 0, v39, vcc
    v_cndmask_b32 v39, v39, v16, vcc
    s_mov_b64 vcc, s[80:81]
    v_cndmask_b32 v168, 0, v40, vcc
    v_cndmask_b32 v40, v40, v16, vcc
    s_mov_b64 vcc, s[82:83]
    v_cndmask_b32 v169, 0, v41, vcc
    v_cndmask_b32 v41, v41, v16, vcc
    s_mov_b64 vcc, s[84:85]
    v_cndmask_b32 v170, 0, v42, vcc
    v_cndmask_b32 v42, v42, v16, vcc
    s_mov_b64 vcc, s[86:87]
    v_cndmask_b32 v171, 0, v43, vcc
    v_cndmask_b32 v43, v43, v16, vcc
    s_mov_b64 vcc, s[88:89]
    v_cndmask_b32 v172, 0, v44, vcc
    v_cndmask_b32 v44, v44, v16, vcc
    s_mov_b64 vcc, s[90:91]
    v_cndmask_b32 v173, 0, v45, vcc
    v_cndmask_b32 v45, v45, v16, vcc
    s_mov_b64 vcc, s[92:93]
    v_cndmask_b32 v174, 0, v46, vcc
    v_cndmask_b32 v46, v46, v16, vcc
    s_mov_b64 vcc, s[94:95]
    v_cndmask_b32 v175, 0, v47, vcc
    v_cndmask_b32 v47, v47, v16, vcc
    v_cvt_pk_bf16_f32 v32, v32, v33
    v_cvt_pk_bf16_f32 v33, v34, v35
    v_cvt_pk_bf16_f32 v34, v36, v37
    v_cvt_pk_bf16_f32 v35, v38, v39
    v_cvt_pk_bf16_f32 v36, v40, v41
    v_cvt_pk_bf16_f32 v37, v42, v43
    v_cvt_pk_bf16_f32 v38, v44, v45
    v_cvt_pk_bf16_f32 v39, v46, v47
    v_cvt_pk_bf16_f32 v160, v160, v161
    v_cvt_pk_bf16_f32 v161, v162, v163
    v_cvt_pk_bf16_f32 v162, v164, v165
    v_cvt_pk_bf16_f32 v163, v166, v167
    v_cvt_pk_bf16_f32 v164, v168, v169
    v_cvt_pk_bf16_f32 v165, v170, v171
    v_cvt_pk_bf16_f32 v166, v172, v173
    v_cvt_pk_bf16_f32 v167, v174, v175
    ds_read_b64_tr_b16 v[200:201], v14 offset:256
    ds_read_b64_tr_b16 v[202:203], v14 offset:320
    ds_read_b64_tr_b16 v[204:205], v14 offset:384
    ds_read_b64_tr_b16 v[206:207], v14 offset:448
    s_mov_b32 m0, s45
    s_add_u32 s45, s45, 10240
    buffer_load_dwordx4 v17, s[36:39], s44 offen lds
    s_add_u32 s44, s44, 2048
    s_mov_b32 m0, s45
    s_add_u32 s45, s45, 10240
    buffer_load_dwordx4 v17, s[36:39], s44 offen lds
    s_add_u32 s44, s44, 2048
    s_waitcnt lgkmcnt(4)
    v_mfma_f32_32x32x16_bf16 v[208:223], v[192:195], v[32:35], 0
    v_mfma_f32_32x32x16_bf16 v[208:223], v[196:199], v[36:39], v[208:223]
    v_exp_f32 v48, v48
    v_exp_f32 v49, v49
    v_exp_f32 v50, v50
    v_exp_f32 v51, v51
    v_exp_f32 v52, v52
    v_exp_f32 v53, v53
    v_exp_f32 v54, v54
    v_exp_f32 v55, v55
    v_exp_f32 v56, v56
    v_exp_f32 v57, v57
    v_exp_f32 v58, v58
    v_exp_f32 v59, v59
    v_exp_f32 v60, v60
    v_exp_f32 v61, v61
    v_exp_f32 v62, v62
    v_exp_f32 v63, v63
    v_cvt_pk_bf16_f32 v48, v48, v49
    v_cvt_pk_bf16_f32 v49, v50, v51
    v_cvt_pk_bf16_f32 v50, v52, v53
    v_cvt_pk_bf16_f32 v51, v54, v55
    v_cvt_pk_bf16_f32 v52, v56, v57
    v_cvt_pk_bf16_f32 v53, v58, v59
    v_cvt_pk_bf16_f32 v54, v60, v61
    v_cvt_pk_bf16_f32 v55, v62, v63
    ds_read_b64_tr_b16 v[192:193], v14 offset:512
    ds_read_b64_tr_b16 v[194:195], v14 offset:576
    ds_read_b64_tr_b16 v[196:197], v14 offset:640
    ds_read_b64_tr_b16 v[198:199], v14 offset:704
    s_mov_b32 m0, s45
    s_add_u32 s45, s45, 10240
    buffer_load_dwordx4 v17, s[36:39], s44 offen lds
    s_add_u32 s44, s44, 2048
    s_mov_b32 m0, s45
    s_add_u32 s45, s45, 10240
    buffer_load_dwordx4 v17, s[36:39], s44 offen lds
    s_add_u32 s44, s44, 2048
    s_waitcnt lgkmcnt(4)
    v_mfma_f32_32x32x16_bf16 v[208:223], v[200:203], v[48:51], v[208:223]
    v_mfma_f32_32x32x16_bf16 v[208:223], v[204:207], v[52:55], v[208:223]
    v_exp_f32 v64, v64
    v_exp_f32 v65, v65
    v_exp_f32 v66, v66
    v_exp_f32 v67, v67
    v_exp_f32 v68, v68
    v_exp_f32 v69, v69
    v_exp_f32 v70, v70
    v_exp_f32 v71, v71
    v_exp_f32 v72, v72
    v_exp_f32 v73, v73
    v_exp_f32 v74, v74
    v_exp_f32 v75, v75
    v_exp_f32 v76, v76
    v_exp_f32 v77, v77
    v_exp_f32 v78, v78
    v_exp_f32 v79, v79
    v_cvt_pk_bf16_f32 v64, v64, v65
    v_cvt_pk_bf16_f32 v65, v66, v67
    v_cvt_pk_bf16_f32 v66, v68, v69
    v_cvt_pk_bf16_f32 v67, v70, v71
    v_cvt_pk_bf16_f32 v68, v72, v73
    v_cvt_pk_bf16_f32 v69, v74, v75
    v_cvt_pk_bf16_f32 v70, v76, v77
    v_cvt_pk_bf16_f32 v71, v78, v79
    ds_read_b64_tr_b16 v[200:201], v14 offset:768
    ds_read_b64_tr_b16 v[202:203], v14 offset:832
    ds_read_b64_tr_b16 v[204:205], v14 offset:896
    ds_read_b64_tr_b16 v[206:207], v14 offset:960
    s_mov_b32 m0, s45
    s_add_u32 s45, s45, 10240
    buffer_load_dwordx4 v17, s[36:39], s44 offen lds
    s_add_u32 s44, s44, 2048
    s_mov_b32 m0, s45
    s_add_u32 s45, s45, 10240
    buffer_load_dwordx4 v17, s[36:39], s44 offen lds
    s_add_u32 s44, s44, 2048
    s_waitcnt lgkmcnt(4)
    v_mfma_f32_32x32x16_bf16 v[208:223], v[192:195], v[64:67], v[208:223]
    v_mfma_f32_32x32x16_bf16 v[208:223], v[196:199], v[68:71], v[208:223]
    v_exp_f32 v80, v80
    v_exp_f32 v81, v81
    v_exp_f32 v82, v82
    v_exp_f32 v83, v83
    v_exp_f32 v84, v84
    v_exp_f32 v85, v85
    v_exp_f32 v86, v86
    v_exp_f32 v87, v87
    v_exp_f32 v88, v88
    v_exp_f32 v89, v89
    v_exp_f32 v90, v90
    v_exp_f32 v91, v91
    v_exp_f32 v92, v92
    v_exp_f32 v93, v93
    v_exp_f32 v94, v94
    v_exp_f32 v95, v95
    v_cvt_pk_bf16_f32 v80, v80, v81
    v_cvt_pk_bf16_f32 v81, v82, v83
    v_cvt_pk_bf16_f32 v82, v84, v85
    v_cvt_pk_bf16_f32 v83, v86, v87
    v_cvt_pk_bf16_f32 v84, v88, v89
    v_cvt_pk_bf16_f32 v85, v90, v91
    v_cvt_pk_bf16_f32 v86, v92, v93
    v_cvt_pk_bf16_f32 v87, v94, v95
    ds_read_b64_tr_b16 v[192:193], v14 offset:1024
    ds_read_b64_tr_b16 v[194:195], v14 offset:1088
    ds_read_b64_tr_b16 v[196:197], v14 offset:1152
    ds_read_b64_tr_b16 v[198:199], v14 offset:1216
    s_mov_b32 m0, s45
    s_add_u32 s45, s45, 10240
    buffer_load_dwordx4 v17, s[36:39], s44 offen lds
    s_add_u32 s44, s44, 2048
    s_mov_b32 m0, s45
    s_add_u32 s45, s45, 10240
    buffer_load_dwordx4 v17, s[36:39], s44 offen lds
    s_add_u32 s44, s44, 2048
    s_waitcnt lgkmcnt(4)
    v_mfma_f32_32x32x16_bf16 v[208:223], v[200:203], v[80:83], v[208:223]
    v_mfma_f32_32x32x16_bf16 v[208:223], v[204:207], v[84:87], v[208:223]
    v_exp_f32 v96, v96
    v_exp_f32 v97, v97
    v_exp_f32 v98, v98
    v_exp_f32 v99, v99
    v_exp_f32 v100, v100
    v_exp_f32 v101, v101
    v_exp_f32 v102, v102
    v_exp_f32 v103, v103
    v_exp_f32 v104, v104
    v_exp_f32 v105, v105
    v_exp_f32 v106, v106
    v_exp_f32 v107, v107
    v_exp_f32 v108, v108
    v_exp_f32 v109, v109
    v_exp_f32 v110, v110
    v_exp_f32 v111, v111
    v_cvt_pk_bf16_f32 v96, v96, v97
    v_cvt_pk_bf16_f32 v97, v98, v99
    v_cvt_pk_bf16_f32 v98, v100, v101
    v_cvt_pk_bf16_f32 v99, v102, v103
    v_cvt_pk_bf16_f32 v100, v104, v105
    v_cvt_pk_bf16_f32 v101, v106, v107
    v_cvt_pk_bf16_f32 v102, v108, v109
    v_cvt_pk_bf16_f32 v103, v110, v111
    ds_read_b64_tr_b16 v[200:201], v14 offset:1280
    ds_read_b64_tr_b16 v[202:203], v14 offset:1344
    ds_read_b64_tr_b16 v[204:205], v14 offset:1408
    ds_read_b64_tr_b16 v[206:207], v14 offset:1472
    s_mov_b32 m0, s45
    s_add_u32 s45, s45, 10240
    buffer_load_dwordx4 v17, s[36:39], s44 offen lds
    s_add_u32 s44, s44, 2048
    s_mov_b32 m0, s45
    s_add_u32 s45, s45, 10240
    buffer_load_dwordx4 v17, s[36:39], s44 offen lds
    s_add_u32 s44, s44, 2048
    s_waitcnt lgkmcnt(4)
    v_mfma_f32_32x32x16_bf16 v[208:223], v[192:195], v[96:99], v[208:223]
    v_mfma_f32_32x32x16_bf16 v[208:223], v[196:199], v[100:103], v[208:223]
    v_exp_f32 v112, v112
    v_exp_f32 v113, v113
    v_exp_f32 v114, v114
    v_exp_f32 v115, v115
    v_exp_f32 v116, v116
    v_exp_f32 v117, v117
    v_exp_f32 v118, v118
    v_exp_f32 v119, v119
    v_exp_f32 v120, v120
    v_exp_f32 v121, v121
    v_exp_f32 v122, v122
    v_exp_f32 v123, v123
    v_exp_f32 v124, v124
    v_exp_f32 v125, v125
    v_exp_f32 v126, v126
    v_exp_f32 v127, v127
    v_cvt_pk_bf16_f32 v112, v112, v113
    v_cvt_pk_bf16_f32 v113, v114, v115
    v_cvt_pk_bf16_f32 v114, v116, v117
    v_cvt_pk_bf16_f32 v115, v118, v119
    v_cvt_pk_bf16_f32 v116, v120, v121
    v_cvt_pk_bf16_f32 v117, v122, v123
    v_cvt_pk_bf16_f32 v118, v124, v125
    v_cvt_pk_bf16_f32 v119, v126, v127
    ds_read_b64_tr_b16 v[192:193], v14 offset:1536
    ds_read_b64_tr_b16 v[194:195], v14 offset:1600
    ds_read_b64_tr_b16 v[196:197], v14 offset:1664
    ds_read_b64_tr_b16 v[198:199], v14 offset:1728
    s_mov_b32 m0, s47
    s_add_u32 s47, s47, 40960
    buffer_load_dwordx4 v17, s[36:39], s46 offen lds
    s_add_u32 s46, s46, 8192
ps_wod_122:
    s_mov_b32 m0, s47
    s_add_u32 s47, s47, 40960
    buffer_load_dwordx4 v17, s[36:39], s46 offen lds
    s_add_u32 s46, s46, 8192
ps_wod_123:
    s_waitcnt lgkmcnt(4)
    v_mfma_f32_32x32x16_bf16 v[208:223], v[200:203], v[112:115], v[208:223]
    v_mfma_f32_32x32x16_bf16 v[208:223], v[204:207], v[116:119], v[208:223]
    v_exp_f32 v128, v128
    v_exp_f32 v129, v129
    v_exp_f32 v130, v130
    v_exp_f32 v131, v131
    v_exp_f32 v132, v132
    v_exp_f32 v133, v133
    v_exp_f32 v134, v134
    v_exp_f32 v135, v135
    v_exp_f32 v136, v136
    v_exp_f32 v137, v137
    v_exp_f32 v138, v138
    v_exp_f32 v139, v139
    v_exp_f32 v140, v140
    v_exp_f32 v141, v141
    v_exp_f32 v142, v142
    v_exp_f32 v143, v143
    v_cvt_pk_bf16_f32 v128, v128, v129
    v_cvt_pk_bf16_f32 v129, v130, v131
    v_cvt_pk_bf16_f32 v130, v132, v133
    v_cvt_pk_bf16_f32 v131, v134, v135
    v_cvt_pk_bf16_f32 v132, v136, v137
    v_cvt_pk_bf16_f32 v133, v138, v139
    v_cvt_pk_bf16_f32 v134, v140, v141
    v_cvt_pk_bf16_f32 v135, v142, v143
    ds_read_b64_tr_b16 v[200:201], v14 offset:1792
    ds_read_b64_tr_b16 v[202:203], v14 offset:1856
    ds_read_b64_tr_b16 v[204:205], v14 offset:1920
    ds_read_b64_tr_b16 v[206:207], v14 offset:1984
    s_cmp_ge_u32 s22, 4
    s_cbranch_scc1 ps_wod_124
    s_mov_b32 m0, s47
    s_add_u32 s47, s47, 40960
    buffer_load_dwordx4 v17, s[36:39], s46 offen lds
    s_add_u32 s46, s46, 8192
ps_wod_124:
    s_waitcnt lgkmcnt(4)
    v_mfma_f32_32x32x16_bf16 v[208:223], v[192:195], v[128:131], v[208:223]
    v_mfma_f32_32x32x16_bf16 v[208:223], v[196:199], v[132:135], v[208:223]
    v_exp_f32 v144, v144
    v_exp_f32 v145, v145
    v_exp_f32 v146, v146
    v_exp_f32 v147, v147
    v_exp_f32 v148, v148
    v_exp_f32 v149, v149
    v_exp_f32 v150, v150
    v_exp_f32 v151, v151
    v_exp_f32 v152, v152
    v_exp_f32 v153, v153
    v_exp_f32 v154, v154
    v_exp_f32 v155, v155
    v_exp_f32 v156, v156
    v_exp_f32 v157, v157
    v_exp_f32 v158, v158
    v_exp_f32 v159, v159
    v_cvt_pk_bf16_f32 v144, v144, v145
    v_cvt_pk_bf16_f32 v145, v146, v147
    v_cvt_pk_bf16_f32 v146, v148, v149
    v_cvt_pk_bf16_f32 v147, v150, v151
    v_cvt_pk_bf16_f32 v148, v152, v153
    v_cvt_pk_bf16_f32 v149, v154, v155
    v_cvt_pk_bf16_f32 v150, v156, v157
    v_cvt_pk_bf16_f32 v151, v158, v159
    ds_read_b64_tr_b16 v[192:193], v14 offset:2048
    ds_read_b64_tr_b16 v[194:195], v14 offset:2112
    ds_read_b64_tr_b16 v[196:197], v14 offset:2176
    ds_read_b64_tr_b16 v[198:199], v14 offset:2240
    s_waitcnt lgkmcnt(4)
    v_mfma_f32_32x32x16_bf16 v[208:223], v[200:203], v[144:147], v[208:223]
    v_mfma_f32_32x32x16_bf16 v[208:223], v[204:207], v[148:151], v[208:223]
    s_waitcnt lgkmcnt(0)
    s_barrier
    v_mfma_f32_32x32x16_bf16 v[208:223], v[192:195], v[160:163], v[208:223]
    v_mfma_f32_32x32x16_bf16 v[208:223], v[196:199], v[164:167], v[208:223]
    s_nop 11
    v_mov_b32 v232, v216
    v_mov_b32 v233, v216
    s_nop 1
    v_permlane32_swap_b32 v232, v233
    v_rcp_f32 v233, v233
    s_nop 0
    v_mul_f32 v208, v208, v233
    v_mul_f32 v209, v209, v233
    v_mul_f32 v210, v210, v233
    v_mul_f32 v211, v211, v233
    v_mul_f32 v212, v212, v233
    v_mul_f32 v213, v213, v233
    v_mul_f32 v214, v214, v233
    v_mul_f32 v215, v215, v233
    v_mul_f32 v216, v216, v233
    v_mul_f32 v217, v217, v233
    v_mul_f32 v218, v218, v233
    v_mul_f32 v219, v219, v233
    v_cvt_pk_bf16_f32 v234, v208, v209
    v_cvt_pk_bf16_f32 v235, v210, v211
    v_cvt_pk_bf16_f32 v236, v212, v213
    v_cvt_pk_bf16_f32 v237, v214, v215
    v_cvt_pk_bf16_f32 v238, v216, v217
    v_cvt_pk_bf16_f32 v239, v218, v219
    v_lshrrev_b32 v4, 4, v30
    v_mul_u32_u24 v4, 20480, v4
    v_and_b32 v5, 15, v30
    v_lshl_add_u32 v4, v5, 4, v4
    s_mul_i32 s61, s96, 5
    v_add_u32 v5, s61, v29
    v_lshrrev_b32 v6, 1, v5
    v_lshl_add_u32 v6, v6, 8, v4
    v_and_b32 v5, 1, v5
    v_lshl_add_u32 v6, v5, 3, v6
    s_cmp_eq_u32 s0, 0
    s_cbranch_scc1 ps_glob_125
    buffer_store_dwordx2 v[234:235], v6, s[28:31], 0 offen
    s_branch ps_dual_126
ps_glob_125:
    buffer_store_dwordx2 v[234:235], v6, s[28:31], 0 offen sc1
ps_dual_126:
    v_add_u32 v5, s61, v29
    v_add_u32 v5, 2, v5
    v_lshrrev_b32 v6, 1, v5
    v_lshl_add_u32 v6, v6, 8, v4
    v_and_b32 v5, 1, v5
    v_lshl_add_u32 v6, v5, 3, v6
    s_cmp_eq_u32 s0, 0
    s_cbranch_scc1 ps_glob_127
    buffer_store_dwordx2 v[236:237], v6, s[28:31], 0 offen
    s_branch ps_dual_128
ps_glob_127:
    buffer_store_dwordx2 v[236:237], v6, s[28:31], 0 offen sc1
ps_dual_128:
    v_add_u32 v5, s61, v29
    v_add_u32 v5, 4, v5
    v_lshrrev_b32 v6, 1, v5
    v_lshl_add_u32 v6, v6, 8, v4
    v_and_b32 v5, 1, v5
    v_lshl_add_u32 v6, v5, 3, v6
    s_mov_b32 exec_hi, 0
    s_cmp_eq_u32 s0, 0
    s_cbranch_scc1 ps_glob_129
    buffer_store_dwordx2 v[238:239], v6, s[28:31], 0 offen
    s_branch ps_dual_130
ps_glob_129:
    buffer_store_dwordx2 v[238:239], v6, s[28:31], 0 offen sc1
ps_dual_130:
    s_mov_b64 exec, -1
    v_mov_b32 v2, 159768
    ds_read_b64 v[2:3], v2
    s_add_u32 s48, s20, 51134464
    s_addc_u32 s49, s21, 0
    s_mov_b32 s50, 65536
    s_mov_b32 s51, 0x20000
    s_lshl_b32 s62, s23, 12
    s_lshl_b32 s63, s96, 7
    s_add_u32 s62, s62, s63
    s_add_u32 s62, s62, 32768
    v_mov_b32 v6, s62
    v_mov_b32 v7, 159744
    v_mov_b32 v8, 7
    s_mul_i32 s63, s3, 5
    s_add_u32 s63, s63, 2
    s_waitcnt lgkmcnt(0)
    v_add_u32 v2, s63, v2
    s_mov_b64 exec, 1
    s_waitcnt vmcnt(0)
    ds_inc_rtn_u32 v9, v7, v8
    s_waitcnt lgkmcnt(0)
    v_readfirstlane_b32 s61, v9
    s_nop 3
    s_cmp_lg_u32 s61, 7
    s_cbranch_scc1 ps_nosig_131
    s_cmp_eq_u32 s0, 0
    s_cbranch_scc1 ps_glob_132
    buffer_store_dwordx2 v[2:3], v6, s[48:51], 0 offen
    s_branch ps_dual_133
ps_glob_132:
    buffer_store_dwordx2 v[2:3], v6, s[48:51], 0 offen sc1
ps_dual_133:
ps_nosig_131:
    s_mov_b64 exec, -1
    s_cmp_lt_u32 s22, 4
    s_cbranch_scc1 ps_rc_134
    s_cmp_eq_u32 s22, 4
    s_cbranch_scc1 ps_rx0_135
    s_cmp_eq_u32 s22, 5
    s_cbranch_scc1 ps_rx1_136
    s_cmp_eq_u32 s22, 6
    s_cbranch_scc1 ps_rw0_137
    s_branch ps_rw1_138
ps_rc_134:
    s_and_b32 s62, s96, 3
    s_lshl_b32 s63, s23, 2
    s_add_u32 s62, s62, s63
    s_lshl_b32 s52, s62, 6
    s_lshr_b32 s61, s96, 2
    s_mul_i32 s53, s61, 80
    s_add_u32 s40, s4, 0
    s_addc_u32 s41, s5, 0
    s_add_u32 s42, s20, 26214400
    s_addc_u32 s43, s21, 0
    s_cmp_eq_u32 s3, 0
    s_cselect_b32 s40, s40, s42
    s_cselect_b32 s41, s41, s43
    s_mov_b32 s42, 2621440
    s_mov_b32 s43, 0x20000
    s_add_u32 s36, s20, 20971520
    s_addc_u32 s37, s21, 0
    s_mov_b32 s38, 2621440
    s_mov_b32 s39, 0x20000
    s_add_u32 s44, s20, 43253760
    s_addc_u32 s45, s21, 0
    s_mov_b32 s46, 131072
    s_mov_b32 s47, 0x20000
    s_lshl_b32 s68, s22, 4
    s_add_u32 s68, s68, s52
    v_and_b32 v4, 15, v0
    v_add_u32 v4, s68, v4
    v_lshlrev_b32 v7, 6, v4
    v_mul_u32_u24 v4, 1280, v4
    v_lshrrev_b32 v5, 4, v0
    v_lshlrev_b32 v5, 3, v5
    s_lshl_b32 s75, s53, 1
    v_add3_u32 v150, v4, v5, s75
    s_lshl_b32 s75, s61, 3
    v_add_u32 v152, s75, v7
    v_and_b32 v2, 15, v0
    v_lshrrev_b32 v3, 4, v0
    v_lshrrev_b32 v4, 1, v3
    v_lshlrev_b32 v4, 8, v4
    v_lshl_add_u32 v4, v2, 4, v4
    v_and_b32 v3, 1, v3
    v_lshl_add_u32 v151, v3, 3, v4
    s_lshr_b32 s74, s68, 4
    s_mul_i32 s74, s74, 20480
    s_lshl_b32 s75, s53, 5
    s_add_u32 s74, s74, s75
    v_add_u32 v151, s74, v151
    s_cmp_eq_u32 s3, 0
    s_cbranch_scc1 ps_raw_140
    buffer_load_dwordx2 v[140:141], v151, s[40:43], 0 offen offset:0 sc1
    buffer_load_dwordx2 v[142:143], v151, s[40:43], 0 offen offset:512 sc1
    buffer_load_dwordx2 v[144:145], v151, s[40:43], 0 offen offset:1024 sc1
    buffer_load_dwordx2 v[146:147], v151, s[40:43], 0 offen offset:1536 sc1
    buffer_load_dwordx2 v[148:149], v151, s[40:43], 0 offen offset:2048 sc1
    s_branch ps_join_141
ps_raw_140:
    buffer_load_dwordx2 v[140:141], v150, s[40:43], 0 offen offset:0 sc1
    buffer_load_dwordx2 v[142:143], v150, s[40:43], 0 offen offset:32 sc1
    buffer_load_dwordx2 v[144:145], v150, s[40:43], 0 offen offset:64 sc1
    buffer_load_dwordx2 v[146:147], v150, s[40:43], 0 offen offset:96 sc1
    buffer_load_dwordx2 v[148:149], v150, s[40:43], 0 offen offset:128 sc1
ps_join_141:
    s_mov_b32 s76, s22
    s_lshl_b32 s62, s76, 11
    v_lshlrev_b32 v4, 4, v0
    v_add_u32 v136, s62, v4
    v_add_u32 v137, 1024, v136
    v_lshlrev_b32 v138, 4, v0
    v_add_u32 v138, 49152, v138
    v_add_u32 v139, 51200, v138
    v_mov_b32 v16, 0
    v_mov_b32 v17, 0
    v_mov_b32 v18, 0
    v_mov_b32 v19, 0
    v_mov_b32 v20, 0
    v_mov_b32 v21, 0
    v_mov_b32 v22, 0
    v_mov_b32 v23, 0
    v_mov_b32 v24, 0
    v_mov_b32 v25, 0
    v_mov_b32 v26, 0
    v_mov_b32 v27, 0
    v_mov_b32 v28, 0
    v_mov_b32 v29, 0
    v_mov_b32 v30, 0
    v_mov_b32 v31, 0
    v_mov_b32 v32, 0
    v_mov_b32 v33, 0
    v_mov_b32 v34, 0
    v_mov_b32 v35, 0
    s_barrier
    ds_read_b128 v[80:83], v136 offset:0
    ds_read_b128 v[40:43], v138 offset:0
    ds_read_b128 v[44:47], v138 offset:2048
    ds_read_b128 v[48:51], v138 offset:4096
    ds_read_b128 v[52:55], v138 offset:6144
    ds_read_b128 v[56:59], v138 offset:8192
    ds_read_b128 v[84:87], v137 offset:0
    ds_read_b128 v[60:63], v138 offset:1024
    ds_read_b128 v[64:67], v138 offset:3072
    ds_read_b128 v[68:71], v138 offset:5120
    ds_read_b128 v[72:75], v138 offset:7168
    ds_read_b128 v[76:79], v138 offset:9216
    s_waitcnt lgkmcnt(0)
    s_barrier
    v_mfma_f32_16x16x32_bf16 v[16:19], v[40:43], v[80:83], v[16:19]
    ds_read_b128 v[128:131], v136 offset:8192
    ds_read_b128 v[88:91], v138 offset:10240
    v_mfma_f32_16x16x32_bf16 v[20:23], v[44:47], v[80:83], v[20:23]
    ds_read_b128 v[92:95], v138 offset:12288
    v_mfma_f32_16x16x32_bf16 v[24:27], v[48:51], v[80:83], v[24:27]
    ds_read_b128 v[96:99], v138 offset:14336
    ds_read_b128 v[100:103], v138 offset:16384
    v_mfma_f32_16x16x32_bf16 v[28:31], v[52:55], v[80:83], v[28:31]
    ds_read_b128 v[104:107], v138 offset:18432
    v_mfma_f32_16x16x32_bf16 v[32:35], v[56:59], v[80:83], v[32:35]
    ds_read_b128 v[132:135], v137 offset:8192
    ds_read_b128 v[108:111], v138 offset:11264
    v_mfma_f32_16x16x32_bf16 v[16:19], v[60:63], v[84:87], v[16:19]
    ds_read_b128 v[112:115], v138 offset:13312
    v_mfma_f32_16x16x32_bf16 v[20:23], v[64:67], v[84:87], v[20:23]
    ds_read_b128 v[116:119], v138 offset:15360
    ds_read_b128 v[120:123], v138 offset:17408
    v_mfma_f32_16x16x32_bf16 v[24:27], v[68:71], v[84:87], v[24:27]
    ds_read_b128 v[124:127], v138 offset:19456
    v_mfma_f32_16x16x32_bf16 v[28:31], v[72:75], v[84:87], v[28:31]
    v_mfma_f32_16x16x32_bf16 v[32:35], v[76:79], v[84:87], v[32:35]
    s_waitcnt lgkmcnt(0)
    s_barrier
    v_mfma_f32_16x16x32_bf16 v[16:19], v[88:91], v[128:131], v[16:19]
    ds_read_b128 v[80:83], v136 offset:16384
    ds_read_b128 v[40:43], v138 offset:20480
    v_mfma_f32_16x16x32_bf16 v[20:23], v[92:95], v[128:131], v[20:23]
    ds_read_b128 v[44:47], v138 offset:22528
    v_mfma_f32_16x16x32_bf16 v[24:27], v[96:99], v[128:131], v[24:27]
    ds_read_b128 v[48:51], v138 offset:24576
    ds_read_b128 v[52:55], v138 offset:26624
    v_mfma_f32_16x16x32_bf16 v[28:31], v[100:103], v[128:131], v[28:31]
    ds_read_b128 v[56:59], v138 offset:28672
    v_mfma_f32_16x16x32_bf16 v[32:35], v[104:107], v[128:131], v[32:35]
    ds_read_b128 v[84:87], v137 offset:16384
    ds_read_b128 v[60:63], v138 offset:21504
    v_mfma_f32_16x16x32_bf16 v[16:19], v[108:111], v[132:135], v[16:19]
    ds_read_b128 v[64:67], v138 offset:23552
    v_mfma_f32_16x16x32_bf16 v[20:23], v[112:115], v[132:135], v[20:23]
    ds_read_b128 v[68:71], v138 offset:25600
    ds_read_b128 v[72:75], v138 offset:27648
    v_mfma_f32_16x16x32_bf16 v[24:27], v[116:119], v[132:135], v[24:27]
    ds_read_b128 v[76:79], v138 offset:29696
    v_mfma_f32_16x16x32_bf16 v[28:31], v[120:123], v[132:135], v[28:31]
    v_mfma_f32_16x16x32_bf16 v[32:35], v[124:127], v[132:135], v[32:35]
    s_waitcnt lgkmcnt(0)
    s_barrier
    v_mfma_f32_16x16x32_bf16 v[16:19], v[40:43], v[80:83], v[16:19]
    ds_read_b128 v[128:131], v136 offset:24576
    ds_read_b128 v[88:91], v138 offset:30720
    v_mfma_f32_16x16x32_bf16 v[20:23], v[44:47], v[80:83], v[20:23]
    ds_read_b128 v[92:95], v138 offset:32768
    v_mfma_f32_16x16x32_bf16 v[24:27], v[48:51], v[80:83], v[24:27]
    ds_read_b128 v[96:99], v138 offset:34816
    ds_read_b128 v[100:103], v138 offset:36864
    v_mfma_f32_16x16x32_bf16 v[28:31], v[52:55], v[80:83], v[28:31]
    ds_read_b128 v[104:107], v138 offset:38912
    v_mfma_f32_16x16x32_bf16 v[32:35], v[56:59], v[80:83], v[32:35]
    ds_read_b128 v[132:135], v137 offset:24576
    ds_read_b128 v[108:111], v138 offset:31744
    v_mfma_f32_16x16x32_bf16 v[16:19], v[60:63], v[84:87], v[16:19]
    ds_read_b128 v[112:115], v138 offset:33792
    v_mfma_f32_16x16x32_bf16 v[20:23], v[64:67], v[84:87], v[20:23]
    ds_read_b128 v[116:119], v138 offset:35840
    ds_read_b128 v[120:123], v138 offset:37888
    v_mfma_f32_16x16x32_bf16 v[24:27], v[68:71], v[84:87], v[24:27]
    ds_read_b128 v[124:127], v138 offset:39936
    v_mfma_f32_16x16x32_bf16 v[28:31], v[72:75], v[84:87], v[28:31]
    v_mfma_f32_16x16x32_bf16 v[32:35], v[76:79], v[84:87], v[32:35]
    s_waitcnt lgkmcnt(0)
    s_barrier
    v_mfma_f32_16x16x32_bf16 v[16:19], v[88:91], v[128:131], v[16:19]
    ds_read_b128 v[80:83], v136 offset:32768
    ds_read_b128 v[40:43], v138 offset:40960
    v_mfma_f32_16x16x32_bf16 v[20:23], v[92:95], v[128:131], v[20:23]
    ds_read_b128 v[44:47], v138 offset:43008
    v_mfma_f32_16x16x32_bf16 v[24:27], v[96:99], v[128:131], v[24:27]
    ds_read_b128 v[48:51], v138 offset:45056
    ds_read_b128 v[52:55], v138 offset:47104
    v_mfma_f32_16x16x32_bf16 v[28:31], v[100:103], v[128:131], v[28:31]
    ds_read_b128 v[56:59], v138 offset:49152
    v_mfma_f32_16x16x32_bf16 v[32:35], v[104:107], v[128:131], v[32:35]
    ds_read_b128 v[84:87], v137 offset:32768
    ds_read_b128 v[60:63], v138 offset:41984
    v_mfma_f32_16x16x32_bf16 v[16:19], v[108:111], v[132:135], v[16:19]
    ds_read_b128 v[64:67], v138 offset:44032
    v_mfma_f32_16x16x32_bf16 v[20:23], v[112:115], v[132:135], v[20:23]
    ds_read_b128 v[68:71], v138 offset:46080
    ds_read_b128 v[72:75], v138 offset:48128
    v_mfma_f32_16x16x32_bf16 v[24:27], v[116:119], v[132:135], v[24:27]
    ds_read_b128 v[76:79], v138 offset:50176
    v_mfma_f32_16x16x32_bf16 v[28:31], v[120:123], v[132:135], v[28:31]
    v_mfma_f32_16x16x32_bf16 v[32:35], v[124:127], v[132:135], v[32:35]
    s_waitcnt lgkmcnt(0)
    s_barrier
    v_mfma_f32_16x16x32_bf16 v[16:19], v[40:43], v[80:83], v[16:19]
    ds_read_b128 v[128:131], v136 offset:40960
    ds_read_b128 v[88:91], v139 offset:0
    v_mfma_f32_16x16x32_bf16 v[20:23], v[44:47], v[80:83], v[20:23]
    ds_read_b128 v[92:95], v139 offset:2048
    v_mfma_f32_16x16x32_bf16 v[24:27], v[48:51], v[80:83], v[24:27]
    ds_read_b128 v[96:99], v139 offset:4096
    ds_read_b128 v[100:103], v139 offset:6144
    v_mfma_f32_16x16x32_bf16 v[28:31], v[52:55], v[80:83], v[28:31]
    ds_read_b128 v[104:107], v139 offset:8192
    v_mfma_f32_16x16x32_bf16 v[32:35], v[56:59], v[80:83], v[32:35]
    ds_read_b128 v[132:135], v137 offset:40960
    ds_read_b128 v[108:111], v139 offset:1024
    v_mfma_f32_16x16x32_bf16 v[16:19], v[60:63], v[84:87], v[16:19]
    ds_read_b128 v[112:115], v139 offset:3072
    v_mfma_f32_16x16x32_bf16 v[20:23], v[64:67], v[84:87], v[20:23]
    ds_read_b128 v[116:119], v139 offset:5120
    ds_read_b128 v[120:123], v139 offset:7168
    v_mfma_f32_16x16x32_bf16 v[24:27], v[68:71], v[84:87], v[24:27]
    ds_read_b128 v[124:127], v139 offset:9216
    v_mfma_f32_16x16x32_bf16 v[28:31], v[72:75], v[84:87], v[28:31]
    v_mfma_f32_16x16x32_bf16 v[32:35], v[76:79], v[84:87], v[32:35]
    v_lshlrev_b32 v153, 7, v0
    v_add_u32 v153, s74, v153
    s_mov_b64 exec, 0xfffff
    buffer_load_dword v154, v153, s[36:39], 0 offen sc1
    s_mov_b64 exec, 0xffff
    buffer_load_dword v154, v152, s[44:47], 0 offen sc1
    s_mov_b64 exec, -1
ps_notouch_142:
    s_waitcnt lgkmcnt(0)
    s_barrier
    v_mfma_f32_16x16x32_bf16 v[16:19], v[88:91], v[128:131], v[16:19]
    ds_read_b128 v[80:83], v136 offset:0
    ds_read_b128 v[40:43], v139 offset:10240
    v_mfma_f32_16x16x32_bf16 v[20:23], v[92:95], v[128:131], v[20:23]
    ds_read_b128 v[44:47], v139 offset:12288
    v_mfma_f32_16x16x32_bf16 v[24:27], v[96:99], v[128:131], v[24:27]
    ds_read_b128 v[48:51], v139 offset:14336
    ds_read_b128 v[52:55], v139 offset:16384
    v_mfma_f32_16x16x32_bf16 v[28:31], v[100:103], v[128:131], v[28:31]
    ds_read_b128 v[56:59], v139 offset:18432
    v_mfma_f32_16x16x32_bf16 v[32:35], v[104:107], v[128:131], v[32:35]
    ds_read_b128 v[84:87], v137 offset:0
    ds_read_b128 v[60:63], v139 offset:11264
    v_mfma_f32_16x16x32_bf16 v[16:19], v[108:111], v[132:135], v[16:19]
    ds_read_b128 v[64:67], v139 offset:13312
    v_mfma_f32_16x16x32_bf16 v[20:23], v[112:115], v[132:135], v[20:23]
    ds_read_b128 v[68:71], v139 offset:15360
    ds_read_b128 v[72:75], v139 offset:17408
    v_mfma_f32_16x16x32_bf16 v[24:27], v[116:119], v[132:135], v[24:27]
    ds_read_b128 v[76:79], v139 offset:19456
    v_mfma_f32_16x16x32_bf16 v[28:31], v[120:123], v[132:135], v[28:31]
    v_mfma_f32_16x16x32_bf16 v[32:35], v[124:127], v[132:135], v[32:35]
    s_waitcnt lgkmcnt(0)
    s_barrier
    v_mfma_f32_16x16x32_bf16 v[16:19], v[40:43], v[80:83], v[16:19]
    ds_read_b128 v[128:131], v136 offset:8192
    ds_read_b128 v[88:91], v139 offset:20480
    v_mfma_f32_16x16x32_bf16 v[20:23], v[44:47], v[80:83], v[20:23]
    ds_read_b128 v[92:95], v139 offset:22528
    v_mfma_f32_16x16x32_bf16 v[24:27], v[48:51], v[80:83], v[24:27]
    ds_read_b128 v[96:99], v139 offset:24576
    ds_read_b128 v[100:103], v139 offset:26624
    v_mfma_f32_16x16x32_bf16 v[28:31], v[52:55], v[80:83], v[28:31]
    ds_read_b128 v[104:107], v139 offset:28672
    v_mfma_f32_16x16x32_bf16 v[32:35], v[56:59], v[80:83], v[32:35]
    ds_read_b128 v[132:135], v137 offset:8192
    ds_read_b128 v[108:111], v139 offset:21504
    v_mfma_f32_16x16x32_bf16 v[16:19], v[60:63], v[84:87], v[16:19]
    ds_read_b128 v[112:115], v139 offset:23552
    v_mfma_f32_16x16x32_bf16 v[20:23], v[64:67], v[84:87], v[20:23]
    ds_read_b128 v[116:119], v139 offset:25600
    ds_read_b128 v[120:123], v139 offset:27648
    v_mfma_f32_16x16x32_bf16 v[24:27], v[68:71], v[84:87], v[24:27]
    ds_read_b128 v[124:127], v139 offset:29696
    v_mfma_f32_16x16x32_bf16 v[28:31], v[72:75], v[84:87], v[28:31]
    v_mfma_f32_16x16x32_bf16 v[32:35], v[76:79], v[84:87], v[32:35]
    s_waitcnt lgkmcnt(0)
    s_barrier
    v_mfma_f32_16x16x32_bf16 v[16:19], v[88:91], v[128:131], v[16:19]
    ds_read_b128 v[80:83], v136 offset:16384
    ds_read_b128 v[40:43], v139 offset:30720
    v_mfma_f32_16x16x32_bf16 v[20:23], v[92:95], v[128:131], v[20:23]
    ds_read_b128 v[44:47], v139 offset:32768
    v_mfma_f32_16x16x32_bf16 v[24:27], v[96:99], v[128:131], v[24:27]
    ds_read_b128 v[48:51], v139 offset:34816
    ds_read_b128 v[52:55], v139 offset:36864
    v_mfma_f32_16x16x32_bf16 v[28:31], v[100:103], v[128:131], v[28:31]
    ds_read_b128 v[56:59], v139 offset:38912
    v_mfma_f32_16x16x32_bf16 v[32:35], v[104:107], v[128:131], v[32:35]
    ds_read_b128 v[84:87], v137 offset:16384
    ds_read_b128 v[60:63], v139 offset:31744
    v_mfma_f32_16x16x32_bf16 v[16:19], v[108:111], v[132:135], v[16:19]
    ds_read_b128 v[64:67], v139 offset:33792
    v_mfma_f32_16x16x32_bf16 v[20:23], v[112:115], v[132:135], v[20:23]
    ds_read_b128 v[68:71], v139 offset:35840
    ds_read_b128 v[72:75], v139 offset:37888
    v_mfma_f32_16x16x32_bf16 v[24:27], v[116:119], v[132:135], v[24:27]
    ds_read_b128 v[76:79], v139 offset:39936
    v_mfma_f32_16x16x32_bf16 v[28:31], v[120:123], v[132:135], v[28:31]
    v_mfma_f32_16x16x32_bf16 v[32:35], v[124:127], v[132:135], v[32:35]
    s_waitcnt lgkmcnt(0)
    s_barrier
    v_mfma_f32_16x16x32_bf16 v[16:19], v[40:43], v[80:83], v[16:19]
    ds_read_b128 v[128:131], v136 offset:24576
    ds_read_b128 v[88:91], v139 offset:40960
    v_mfma_f32_16x16x32_bf16 v[20:23], v[44:47], v[80:83], v[20:23]
    ds_read_b128 v[92:95], v139 offset:43008
    v_mfma_f32_16x16x32_bf16 v[24:27], v[48:51], v[80:83], v[24:27]
    ds_read_b128 v[96:99], v139 offset:45056
    ds_read_b128 v[100:103], v139 offset:47104
    v_mfma_f32_16x16x32_bf16 v[28:31], v[52:55], v[80:83], v[28:31]
    ds_read_b128 v[104:107], v139 offset:49152
    v_mfma_f32_16x16x32_bf16 v[32:35], v[56:59], v[80:83], v[32:35]
    ds_read_b128 v[132:135], v137 offset:24576
    ds_read_b128 v[108:111], v139 offset:41984
    v_mfma_f32_16x16x32_bf16 v[16:19], v[60:63], v[84:87], v[16:19]
    ds_read_b128 v[112:115], v139 offset:44032
    v_mfma_f32_16x16x32_bf16 v[20:23], v[64:67], v[84:87], v[20:23]
    ds_read_b128 v[116:119], v139 offset:46080
    ds_read_b128 v[120:123], v139 offset:48128
    v_mfma_f32_16x16x32_bf16 v[24:27], v[68:71], v[84:87], v[24:27]
    ds_read_b128 v[124:127], v139 offset:50176
    v_mfma_f32_16x16x32_bf16 v[28:31], v[72:75], v[84:87], v[28:31]
    v_mfma_f32_16x16x32_bf16 v[32:35], v[76:79], v[84:87], v[32:35]
    s_waitcnt lgkmcnt(0)
    s_barrier
    v_mfma_f32_16x16x32_bf16 v[16:19], v[88:91], v[128:131], v[16:19]
    v_mfma_f32_16x16x32_bf16 v[20:23], v[92:95], v[128:131], v[20:23]
    v_mfma_f32_16x16x32_bf16 v[24:27], v[96:99], v[128:131], v[24:27]
    v_mfma_f32_16x16x32_bf16 v[28:31], v[100:103], v[128:131], v[28:31]
    v_mfma_f32_16x16x32_bf16 v[32:35], v[104:107], v[128:131], v[32:35]
    v_mfma_f32_16x16x32_bf16 v[16:19], v[108:111], v[132:135], v[16:19]
    v_mfma_f32_16x16x32_bf16 v[20:23], v[112:115], v[132:135], v[20:23]
    v_mfma_f32_16x16x32_bf16 v[24:27], v[116:119], v[132:135], v[24:27]
    v_mfma_f32_16x16x32_bf16 v[28:31], v[120:123], v[132:135], v[28:31]
    v_mfma_f32_16x16x32_bf16 v[32:35], v[124:127], v[132:135], v[32:35]
    s_waitcnt vmcnt(0)
    v_lshlrev_b32 v40, 16, v140
    v_and_b32 v41, 0xffff0000, v140
    v_lshlrev_b32 v42, 16, v141
    v_and_b32 v43, 0xffff0000, v141
    v_lshlrev_b32 v44, 16, v142
    v_and_b32 v45, 0xffff0000, v142
    v_lshlrev_b32 v46, 16, v143
    v_and_b32 v47, 0xffff0000, v143
    v_lshlrev_b32 v48, 16, v144
    v_and_b32 v49, 0xffff0000, v144
    v_lshlrev_b32 v50, 16, v145
    v_and_b32 v51, 0xffff0000, v145
    v_lshlrev_b32 v52, 16, v146
    v_and_b32 v53, 0xffff0000, v146
    v_lshlrev_b32 v54, 16, v147
    v_and_b32 v55, 0xffff0000, v147
    v_lshlrev_b32 v56, 16, v148
    v_and_b32 v57, 0xffff0000, v148
    v_lshlrev_b32 v58, 16, v149
    v_and_b32 v59, 0xffff0000, v149
    v_pk_add_f32 v[40:41], v[40:41], v[16:17]
    v_pk_add_f32 v[42:43], v[42:43], v[18:19]
    v_pk_add_f32 v[44:45], v[44:45], v[20:21]
    v_pk_add_f32 v[46:47], v[46:47], v[22:23]
    v_pk_add_f32 v[48:49], v[48:49], v[24:25]
    v_pk_add_f32 v[50:51], v[50:51], v[26:27]
    v_pk_add_f32 v[52:53], v[52:53], v[28:29]
    v_pk_add_f32 v[54:55], v[54:55], v[30:31]
    v_pk_add_f32 v[56:57], v[56:57], v[32:33]
    v_pk_add_f32 v[58:59], v[58:59], v[34:35]
    v_cvt_pk_bf16_f32 v60, v40, v41
    v_cvt_pk_bf16_f32 v61, v42, v43
    v_cvt_pk_bf16_f32 v62, v44, v45
    v_cvt_pk_bf16_f32 v63, v46, v47
    v_cvt_pk_bf16_f32 v64, v48, v49
    v_cvt_pk_bf16_f32 v65, v50, v51
    v_cvt_pk_bf16_f32 v66, v52, v53
    v_cvt_pk_bf16_f32 v67, v54, v55
    v_cvt_pk_bf16_f32 v68, v56, v57
    v_cvt_pk_bf16_f32 v69, v58, v59
    s_cmp_eq_u32 s0, 0
    s_cbranch_scc1 ps_glob_144
    buffer_store_dwordx2 v[60:61], v151, s[36:39], 0 offen offset:0
    buffer_store_dwordx2 v[62:63], v151, s[36:39], 0 offen offset:512
    buffer_store_dwordx2 v[64:65], v151, s[36:39], 0 offen offset:1024
    buffer_store_dwordx2 v[66:67], v151, s[36:39], 0 offen offset:1536
    buffer_store_dwordx2 v[68:69], v151, s[36:39], 0 offen offset:2048
    s_branch ps_dual_145
ps_glob_144:
    buffer_store_dwordx2 v[60:61], v151, s[36:39], 0 offen offset:0 sc1
    buffer_store_dwordx2 v[62:63], v151, s[36:39], 0 offen offset:512 sc1
    buffer_store_dwordx2 v[64:65], v151, s[36:39], 0 offen offset:1024 sc1
    buffer_store_dwordx2 v[66:67], v151, s[36:39], 0 offen offset:1536 sc1
    buffer_store_dwordx2 v[68:69], v151, s[36:39], 0 offen offset:2048 sc1
ps_dual_145:
    v_lshlrev_b32 v40, 16, v60
    v_and_b32 v41, 0xffff0000, v60
    v_lshlrev_b32 v42, 16, v61
    v_and_b32 v43, 0xffff0000, v61
    v_lshlrev_b32 v44, 16, v62
    v_and_b32 v45, 0xffff0000, v62
    v_lshlrev_b32 v46, 16, v63
    v_and_b32 v47, 0xffff0000, v63
    v_lshlrev_b32 v48, 16, v64
    v_and_b32 v49, 0xffff0000, v64
    v_lshlrev_b32 v50, 16, v65
    v_and_b32 v51, 0xffff0000, v65
    v_lshlrev_b32 v52, 16, v66
    v_and_b32 v53, 0xffff0000, v66
    v_lshlrev_b32 v54, 16, v67
    v_and_b32 v55, 0xffff0000, v67
    v_lshlrev_b32 v56, 16, v68
    v_and_b32 v57, 0xffff0000, v68
    v_lshlrev_b32 v58, 16, v69
    v_and_b32 v59, 0xffff0000, v69
    v_pk_add_f32 v[78:79], v[40:41], v[42:43]
    v_pk_add_f32 v[80:81], v[44:45], v[46:47]
    v_pk_add_f32 v[78:79], v[78:79], v[80:81]
    v_pk_add_f32 v[80:81], v[48:49], v[50:51]
    v_pk_add_f32 v[78:79], v[78:79], v[80:81]
    v_pk_add_f32 v[80:81], v[52:53], v[54:55]
    v_pk_add_f32 v[78:79], v[78:79], v[80:81]
    v_pk_add_f32 v[80:81], v[56:57], v[58:59]
    v_pk_add_f32 v[78:79], v[78:79], v[80:81]
    v_add_f32 v72, v78, v79
    v_mov_b32 v76, v72
    s_nop 1
    v_permlane16_swap_b32 v76, v72
    v_add_f32 v72, v72, v76
    v_mov_b32 v76, v72
    s_nop 1
    v_permlane32_swap_b32 v76, v72
    v_add_f32 v72, v72, v76
    v_mul_f32 v74, 0xbc4ccccd, v72
    v_pk_add_f32 v[40:41], v[40:41], v[74:75] op_sel_hi:[1,0]
    v_pk_add_f32 v[42:43], v[42:43], v[74:75] op_sel_hi:[1,0]
    v_pk_add_f32 v[44:45], v[44:45], v[74:75] op_sel_hi:[1,0]
    v_pk_add_f32 v[46:47], v[46:47], v[74:75] op_sel_hi:[1,0]
    v_pk_add_f32 v[48:49], v[48:49], v[74:75] op_sel_hi:[1,0]
    v_pk_add_f32 v[50:51], v[50:51], v[74:75] op_sel_hi:[1,0]
    v_pk_add_f32 v[52:53], v[52:53], v[74:75] op_sel_hi:[1,0]
    v_pk_add_f32 v[54:55], v[54:55], v[74:75] op_sel_hi:[1,0]
    v_pk_add_f32 v[56:57], v[56:57], v[74:75] op_sel_hi:[1,0]
    v_pk_add_f32 v[58:59], v[58:59], v[74:75] op_sel_hi:[1,0]
    v_pk_mul_f32 v[78:79], v[40:41], v[40:41]
    v_pk_mul_f32 v[80:81], v[42:43], v[42:43]
    v_pk_fma_f32 v[78:79], v[44:45], v[44:45], v[78:79]
    v_pk_fma_f32 v[80:81], v[46:47], v[46:47], v[80:81]
    v_pk_fma_f32 v[78:79], v[48:49], v[48:49], v[78:79]
    v_pk_fma_f32 v[80:81], v[50:51], v[50:51], v[80:81]
    v_pk_fma_f32 v[78:79], v[52:53], v[52:53], v[78:79]
    v_pk_fma_f32 v[80:81], v[54:55], v[54:55], v[80:81]
    v_pk_fma_f32 v[78:79], v[56:57], v[56:57], v[78:79]
    v_pk_fma_f32 v[80:81], v[58:59], v[58:59], v[80:81]
    v_pk_add_f32 v[78:79], v[78:79], v[80:81]
    v_add_f32 v73, v78, v79
    v_mov_b32 v76, v73
    s_nop 1
    v_permlane16_swap_b32 v76, v73
    v_add_f32 v73, v73, v76
    v_mov_b32 v76, v73
    s_nop 1
    v_permlane32_swap_b32 v76, v73
    v_add_f32 v73, v73, v76
    s_mov_b64 exec, 0xffff
    s_cmp_eq_u32 s0, 0
    s_cbranch_scc1 ps_glob_146
    buffer_store_dwordx2 v[72:73], v152, s[44:47], 0 offen
    s_branch ps_dual_147
ps_glob_146:
    buffer_store_dwordx2 v[72:73], v152, s[44:47], 0 offen sc1
ps_dual_147:
    s_mov_b64 exec, -1
ps_resdone_143:
    v_mov_b32 v2, 159768
    ds_read_b64 v[2:3], v2
    s_add_u32 s48, s20, 51134464
    s_addc_u32 s49, s21, 0
    s_mov_b32 s50, 65536
    s_mov_b32 s51, 0x20000
    s_lshl_b32 s62, s23, 12
    s_lshl_b32 s63, s96, 7
    s_add_u32 s62, s62, s63
    s_add_u32 s62, s62, 32768
    v_mov_b32 v6, s62
    v_mov_b32 v7, 159744
    v_mov_b32 v8, 3
    s_mul_i32 s63, s3, 5
    s_add_u32 s63, s63, 3
    s_waitcnt lgkmcnt(0)
    v_add_u32 v2, s63, v2
    s_mov_b64 exec, 1
    s_waitcnt vmcnt(0)
    ds_inc_rtn_u32 v9, v7, v8
    s_waitcnt lgkmcnt(0)
    v_readfirstlane_b32 s61, v9
    s_nop 3
    s_cmp_lg_u32 s61, 3
    s_cbranch_scc1 ps_nosig_148
    s_cmp_eq_u32 s0, 0
    s_cbranch_scc1 ps_glob_149
    buffer_store_dwordx2 v[2:3], v6, s[48:51], 0 offen
    s_branch ps_dual_150
ps_glob_149:
    buffer_store_dwordx2 v[2:3], v6, s[48:51], 0 offen sc1
ps_dual_150:
ps_nosig_148:
    s_mov_b64 exec, -1
    s_and_b32 s62, s96, 1
    s_lshl_b32 s63, s23, 1
    s_add_u32 s62, s62, s63
    s_lshl_b32 s52, s62, 7
    s_lshr_b32 s61, s96, 1
    s_mul_i32 s53, s61, 112
    s_min_u32 s53, s53, 1616
    s_add_u32 s36, s20, 28835840
    s_addc_u32 s37, s21, 0
    s_mov_b32 s38, 7077888
    s_mov_b32 s39, 0x20000
    s_lshl_b32 s70, s22, 5
    s_add_u32 s71, s70, s52
    v_and_b32 v2, 15, v0
    v_lshrrev_b32 v3, 4, v0
    v_lshrrev_b32 v4, 1, v3
    v_lshlrev_b32 v4, 8, v4
    v_lshl_add_u32 v4, v2, 4, v4
    v_and_b32 v3, 1, v3
    v_lshl_add_u32 v228, v3, 3, v4
    s_lshr_b32 s74, s71, 4
    s_mul_i32 s74, s74, 55296
    s_lshl_b32 s75, s53, 5
    s_add_u32 s74, s74, s75
    v_add_u32 v228, s74, v228
    s_lshl_b32 s76, s22, 1
    s_lshl_b32 s62, s76, 11
    v_lshlrev_b32 v4, 4, v0
    v_add_u32 v164, s62, v4
    v_add_u32 v165, 1024, v164
    v_lshlrev_b32 v166, 4, v0
    v_add_u32 v166, 49152, v166
    v_add_u32 v167, 57344, v166
    v_mov_b32 v8, 0
    v_mov_b32 v9, 0
    v_mov_b32 v10, 0
    v_mov_b32 v11, 0
    v_mov_b32 v12, 0
    v_mov_b32 v13, 0
    v_mov_b32 v14, 0
    v_mov_b32 v15, 0
    v_mov_b32 v16, 0
    v_mov_b32 v17, 0
    v_mov_b32 v18, 0
    v_mov_b32 v19, 0
    v_mov_b32 v20, 0
    v_mov_b32 v21, 0
    v_mov_b32 v22, 0
    v_mov_b32 v23, 0
    v_mov_b32 v24, 0
    v_mov_b32 v25, 0
    v_mov_b32 v26, 0
    v_mov_b32 v27, 0
    v_mov_b32 v28, 0
    v_mov_b32 v29, 0
    v_mov_b32 v30, 0
    v_mov_b32 v31, 0
    v_mov_b32 v32, 0
    v_mov_b32 v33, 0
    v_mov_b32 v34, 0
    v_mov_b32 v35, 0
    v_mov_b32 v36, 0
    v_mov_b32 v37, 0
    v_mov_b32 v38, 0
    v_mov_b32 v39, 0
    v_mov_b32 v40, 0
    v_mov_b32 v41, 0
    v_mov_b32 v42, 0
    v_mov_b32 v43, 0
    v_mov_b32 v44, 0
    v_mov_b32 v45, 0
    v_mov_b32 v46, 0
    v_mov_b32 v47, 0
    v_mov_b32 v48, 0
    v_mov_b32 v49, 0
    v_mov_b32 v50, 0
    v_mov_b32 v51, 0
    v_mov_b32 v52, 0
    v_mov_b32 v53, 0
    v_mov_b32 v54, 0
    v_mov_b32 v55, 0
    v_mov_b32 v56, 0
    v_mov_b32 v57, 0
    v_mov_b32 v58, 0
    v_mov_b32 v59, 0
    v_mov_b32 v60, 0
    v_mov_b32 v61, 0
    v_mov_b32 v62, 0
    v_mov_b32 v63, 0
    v_mov_b32 v64, 0
    v_mov_b32 v65, 0
    v_mov_b32 v66, 0
    v_mov_b32 v67, 0
    v_mov_b32 v68, 0
    v_mov_b32 v69, 0
    v_mov_b32 v70, 0
    v_mov_b32 v71, 0
    v_mov_b32 v72, 0
    v_mov_b32 v73, 0
    v_mov_b32 v74, 0
    v_mov_b32 v75, 0
    v_mov_b32 v76, 0
    v_mov_b32 v77, 0
    v_mov_b32 v78, 0
    v_mov_b32 v79, 0
    v_mov_b32 v80, 0
    v_mov_b32 v81, 0
    v_mov_b32 v82, 0
    v_mov_b32 v83, 0
    v_mov_b32 v84, 0
    v_mov_b32 v85, 0
    v_mov_b32 v86, 0
    v_mov_b32 v87, 0
    v_mov_b32 v88, 0
    v_mov_b32 v89, 0
    v_mov_b32 v90, 0
    v_mov_b32 v91, 0
    v_mov_b32 v92, 0
    v_mov_b32 v93, 0
    v_mov_b32 v94, 0
    v_mov_b32 v95, 0
    v_mov_b32 v96, 0
    v_mov_b32 v97, 0
    v_mov_b32 v98, 0
    v_mov_b32 v99, 0
    v_mov_b32 v100, 0
    v_mov_b32 v101, 0
    v_mov_b32 v102, 0
    v_mov_b32 v103, 0
    v_mov_b32 v104, 0
    v_mov_b32 v105, 0
    v_mov_b32 v106, 0
    v_mov_b32 v107, 0
    v_mov_b32 v108, 0
    v_mov_b32 v109, 0
    v_mov_b32 v110, 0
    v_mov_b32 v111, 0
    v_mov_b32 v112, 0
    v_mov_b32 v113, 0
    v_mov_b32 v114, 0
    v_mov_b32 v115, 0
    v_mov_b32 v116, 0
    v_mov_b32 v117, 0
    v_mov_b32 v118, 0
    v_mov_b32 v119, 0
    s_barrier
    ds_read_b128 v[120:123], v166 offset:0
    ds_read_b128 v[148:151], v164 offset:0
    ds_read_b128 v[124:127], v166 offset:2048
    ds_read_b128 v[152:155], v164 offset:2048
    ds_read_b128 v[128:131], v166 offset:4096
    ds_read_b128 v[132:135], v166 offset:6144
    ds_read_b128 v[136:139], v166 offset:8192
    ds_read_b128 v[140:143], v166 offset:10240
    s_mov_b32 s57, 3
ps_mm_151:
    s_waitcnt lgkmcnt(4)
    v_mfma_f32_16x16x32_bf16 v[8:11], v[120:123], v[148:151], v[8:11]
    ds_read_b128 v[144:147], v166 offset:12288
    v_mfma_f32_16x16x32_bf16 v[12:15], v[120:123], v[152:155], v[12:15]
    v_mfma_f32_16x16x32_bf16 v[16:19], v[124:127], v[148:151], v[16:19]
    ds_read_b128 v[120:123], v166 offset:14336
    v_mfma_f32_16x16x32_bf16 v[20:23], v[124:127], v[152:155], v[20:23]
    s_waitcnt lgkmcnt(5)
    v_mfma_f32_16x16x32_bf16 v[24:27], v[128:131], v[148:151], v[24:27]
    ds_read_b128 v[124:127], v166 offset:16384
    v_mfma_f32_16x16x32_bf16 v[28:31], v[128:131], v[152:155], v[28:31]
    ds_read_b128 v[156:159], v165 offset:0
    s_waitcnt lgkmcnt(6)
    v_mfma_f32_16x16x32_bf16 v[32:35], v[132:135], v[148:151], v[32:35]
    ds_read_b128 v[128:131], v166 offset:18432
    v_mfma_f32_16x16x32_bf16 v[36:39], v[132:135], v[152:155], v[36:39]
    ds_read_b128 v[160:163], v165 offset:2048
    s_waitcnt lgkmcnt(7)
    v_mfma_f32_16x16x32_bf16 v[40:43], v[136:139], v[148:151], v[40:43]
    ds_read_b128 v[132:135], v166 offset:20480
    v_mfma_f32_16x16x32_bf16 v[44:47], v[136:139], v[152:155], v[44:47]
    s_waitcnt lgkmcnt(7)
    v_mfma_f32_16x16x32_bf16 v[48:51], v[140:143], v[148:151], v[48:51]
    ds_read_b128 v[136:139], v166 offset:22528
    v_mfma_f32_16x16x32_bf16 v[52:55], v[140:143], v[152:155], v[52:55]
    s_waitcnt lgkmcnt(7)
    v_mfma_f32_16x16x32_bf16 v[56:59], v[144:147], v[148:151], v[56:59]
    ds_read_b128 v[140:143], v166 offset:24576
    v_mfma_f32_16x16x32_bf16 v[60:63], v[144:147], v[152:155], v[60:63]
    s_waitcnt lgkmcnt(7)
    v_mfma_f32_16x16x32_bf16 v[64:67], v[120:123], v[148:151], v[64:67]
    ds_read_b128 v[144:147], v166 offset:26624
    v_mfma_f32_16x16x32_bf16 v[68:71], v[120:123], v[152:155], v[68:71]
    s_waitcnt lgkmcnt(7)
    v_mfma_f32_16x16x32_bf16 v[72:75], v[124:127], v[148:151], v[72:75]
    ds_read_b128 v[120:123], v166 offset:1024
    v_mfma_f32_16x16x32_bf16 v[76:79], v[124:127], v[152:155], v[76:79]
    s_waitcnt lgkmcnt(6)
    v_mfma_f32_16x16x32_bf16 v[80:83], v[128:131], v[148:151], v[80:83]
    ds_read_b128 v[124:127], v166 offset:3072
    v_mfma_f32_16x16x32_bf16 v[84:87], v[128:131], v[152:155], v[84:87]
    s_waitcnt lgkmcnt(5)
    v_mfma_f32_16x16x32_bf16 v[88:91], v[132:135], v[148:151], v[88:91]
    ds_read_b128 v[128:131], v166 offset:5120
    v_mfma_f32_16x16x32_bf16 v[92:95], v[132:135], v[152:155], v[92:95]
    s_waitcnt lgkmcnt(5)
    v_mfma_f32_16x16x32_bf16 v[96:99], v[136:139], v[148:151], v[96:99]
    ds_read_b128 v[132:135], v166 offset:7168
    v_mfma_f32_16x16x32_bf16 v[100:103], v[136:139], v[152:155], v[100:103]
    s_waitcnt lgkmcnt(5)
    v_mfma_f32_16x16x32_bf16 v[104:107], v[140:143], v[148:151], v[104:107]
    ds_read_b128 v[136:139], v166 offset:9216
    v_mfma_f32_16x16x32_bf16 v[108:111], v[140:143], v[152:155], v[108:111]
    s_waitcnt lgkmcnt(5)
    v_mfma_f32_16x16x32_bf16 v[112:115], v[144:147], v[148:151], v[112:115]
    ds_read_b128 v[140:143], v166 offset:11264
    v_mfma_f32_16x16x32_bf16 v[116:119], v[144:147], v[152:155], v[116:119]
    s_waitcnt lgkmcnt(5)
    v_mfma_f32_16x16x32_bf16 v[8:11], v[120:123], v[156:159], v[8:11]
    ds_read_b128 v[144:147], v166 offset:13312
    v_mfma_f32_16x16x32_bf16 v[12:15], v[120:123], v[160:163], v[12:15]
    s_waitcnt lgkmcnt(5)
    v_mfma_f32_16x16x32_bf16 v[16:19], v[124:127], v[156:159], v[16:19]
    ds_read_b128 v[120:123], v166 offset:15360
    v_mfma_f32_16x16x32_bf16 v[20:23], v[124:127], v[160:163], v[20:23]
    s_waitcnt lgkmcnt(5)
    v_mfma_f32_16x16x32_bf16 v[24:27], v[128:131], v[156:159], v[24:27]
    ds_read_b128 v[124:127], v166 offset:17408
    v_mfma_f32_16x16x32_bf16 v[28:31], v[128:131], v[160:163], v[28:31]
    s_waitcnt lgkmcnt(5)
    v_mfma_f32_16x16x32_bf16 v[32:35], v[132:135], v[156:159], v[32:35]
    ds_read_b128 v[128:131], v166 offset:19456
    v_mfma_f32_16x16x32_bf16 v[36:39], v[132:135], v[160:163], v[36:39]
    s_waitcnt lgkmcnt(5)
    v_mfma_f32_16x16x32_bf16 v[40:43], v[136:139], v[156:159], v[40:43]
    ds_read_b128 v[132:135], v166 offset:21504
    v_mfma_f32_16x16x32_bf16 v[44:47], v[136:139], v[160:163], v[44:47]
    s_waitcnt lgkmcnt(5)
    v_mfma_f32_16x16x32_bf16 v[48:51], v[140:143], v[156:159], v[48:51]
    ds_read_b128 v[136:139], v166 offset:23552
    v_mfma_f32_16x16x32_bf16 v[52:55], v[140:143], v[160:163], v[52:55]
    s_waitcnt lgkmcnt(5)
    v_mfma_f32_16x16x32_bf16 v[56:59], v[144:147], v[156:159], v[56:59]
    ds_read_b128 v[140:143], v166 offset:25600
    v_mfma_f32_16x16x32_bf16 v[60:63], v[144:147], v[160:163], v[60:63]
    s_waitcnt lgkmcnt(5)
    v_mfma_f32_16x16x32_bf16 v[64:67], v[120:123], v[156:159], v[64:67]
    ds_read_b128 v[144:147], v166 offset:27648
    v_mfma_f32_16x16x32_bf16 v[68:71], v[120:123], v[160:163], v[68:71]
    s_waitcnt lgkmcnt(5)
    v_mfma_f32_16x16x32_bf16 v[72:75], v[124:127], v[156:159], v[72:75]
    v_mfma_f32_16x16x32_bf16 v[76:79], v[124:127], v[160:163], v[76:79]
    s_waitcnt lgkmcnt(4)
    v_mfma_f32_16x16x32_bf16 v[80:83], v[128:131], v[156:159], v[80:83]
    v_mfma_f32_16x16x32_bf16 v[84:87], v[128:131], v[160:163], v[84:87]
    s_waitcnt lgkmcnt(0)
    s_cmp_lg_u32 s57, 1
    s_barrier
    s_cbranch_scc1 ps_tl_152
ps_tl_152:
    v_mfma_f32_16x16x32_bf16 v[88:91], v[132:135], v[156:159], v[88:91]
    ds_read_b128 v[120:123], v166 offset:28672
    ds_read_b128 v[148:151], v164 offset:16384
    ds_read_b128 v[124:127], v166 offset:30720
    v_mfma_f32_16x16x32_bf16 v[92:95], v[132:135], v[160:163], v[92:95]
    ds_read_b128 v[152:155], v164 offset:18432
    ds_read_b128 v[128:131], v166 offset:32768
    v_mfma_f32_16x16x32_bf16 v[96:99], v[136:139], v[156:159], v[96:99]
    ds_read_b128 v[132:135], v166 offset:34816
    v_mfma_f32_16x16x32_bf16 v[100:103], v[136:139], v[160:163], v[100:103]
    v_mfma_f32_16x16x32_bf16 v[104:107], v[140:143], v[156:159], v[104:107]
    ds_read_b128 v[136:139], v166 offset:36864
    v_mfma_f32_16x16x32_bf16 v[108:111], v[140:143], v[160:163], v[108:111]
    v_mfma_f32_16x16x32_bf16 v[112:115], v[144:147], v[156:159], v[112:115]
    ds_read_b128 v[140:143], v166 offset:38912
    v_mfma_f32_16x16x32_bf16 v[116:119], v[144:147], v[160:163], v[116:119]
    s_waitcnt lgkmcnt(4)
    v_mfma_f32_16x16x32_bf16 v[8:11], v[120:123], v[148:151], v[8:11]
    ds_read_b128 v[144:147], v166 offset:40960
    v_mfma_f32_16x16x32_bf16 v[12:15], v[120:123], v[152:155], v[12:15]
    v_mfma_f32_16x16x32_bf16 v[16:19], v[124:127], v[148:151], v[16:19]
    ds_read_b128 v[120:123], v166 offset:43008
    v_mfma_f32_16x16x32_bf16 v[20:23], v[124:127], v[152:155], v[20:23]
    s_waitcnt lgkmcnt(5)
    v_mfma_f32_16x16x32_bf16 v[24:27], v[128:131], v[148:151], v[24:27]
    ds_read_b128 v[124:127], v166 offset:45056
    v_mfma_f32_16x16x32_bf16 v[28:31], v[128:131], v[152:155], v[28:31]
    ds_read_b128 v[156:159], v165 offset:16384
    s_waitcnt lgkmcnt(6)
    v_mfma_f32_16x16x32_bf16 v[32:35], v[132:135], v[148:151], v[32:35]
    ds_read_b128 v[128:131], v166 offset:47104
    v_mfma_f32_16x16x32_bf16 v[36:39], v[132:135], v[152:155], v[36:39]
    ds_read_b128 v[160:163], v165 offset:18432
    s_waitcnt lgkmcnt(7)
    v_mfma_f32_16x16x32_bf16 v[40:43], v[136:139], v[148:151], v[40:43]
    ds_read_b128 v[132:135], v166 offset:49152
    v_mfma_f32_16x16x32_bf16 v[44:47], v[136:139], v[152:155], v[44:47]
    s_waitcnt lgkmcnt(7)
    v_mfma_f32_16x16x32_bf16 v[48:51], v[140:143], v[148:151], v[48:51]
    ds_read_b128 v[136:139], v166 offset:51200
    v_mfma_f32_16x16x32_bf16 v[52:55], v[140:143], v[152:155], v[52:55]
    s_waitcnt lgkmcnt(7)
    v_mfma_f32_16x16x32_bf16 v[56:59], v[144:147], v[148:151], v[56:59]
    ds_read_b128 v[140:143], v166 offset:53248
    v_mfma_f32_16x16x32_bf16 v[60:63], v[144:147], v[152:155], v[60:63]
    s_waitcnt lgkmcnt(7)
    v_mfma_f32_16x16x32_bf16 v[64:67], v[120:123], v[148:151], v[64:67]
    ds_read_b128 v[144:147], v166 offset:55296
    v_mfma_f32_16x16x32_bf16 v[68:71], v[120:123], v[152:155], v[68:71]
    s_waitcnt lgkmcnt(7)
    v_mfma_f32_16x16x32_bf16 v[72:75], v[124:127], v[148:151], v[72:75]
    ds_read_b128 v[120:123], v166 offset:29696
    v_mfma_f32_16x16x32_bf16 v[76:79], v[124:127], v[152:155], v[76:79]
    s_waitcnt lgkmcnt(6)
    v_mfma_f32_16x16x32_bf16 v[80:83], v[128:131], v[148:151], v[80:83]
    ds_read_b128 v[124:127], v166 offset:31744
    v_mfma_f32_16x16x32_bf16 v[84:87], v[128:131], v[152:155], v[84:87]
    s_waitcnt lgkmcnt(5)
    v_mfma_f32_16x16x32_bf16 v[88:91], v[132:135], v[148:151], v[88:91]
    ds_read_b128 v[128:131], v166 offset:33792
    v_mfma_f32_16x16x32_bf16 v[92:95], v[132:135], v[152:155], v[92:95]
    s_waitcnt lgkmcnt(5)
    v_mfma_f32_16x16x32_bf16 v[96:99], v[136:139], v[148:151], v[96:99]
    ds_read_b128 v[132:135], v166 offset:35840
    v_mfma_f32_16x16x32_bf16 v[100:103], v[136:139], v[152:155], v[100:103]
    s_waitcnt lgkmcnt(5)
    v_mfma_f32_16x16x32_bf16 v[104:107], v[140:143], v[148:151], v[104:107]
    ds_read_b128 v[136:139], v166 offset:37888
    v_mfma_f32_16x16x32_bf16 v[108:111], v[140:143], v[152:155], v[108:111]
    s_waitcnt lgkmcnt(5)
    v_mfma_f32_16x16x32_bf16 v[112:115], v[144:147], v[148:151], v[112:115]
    ds_read_b128 v[140:143], v166 offset:39936
    v_mfma_f32_16x16x32_bf16 v[116:119], v[144:147], v[152:155], v[116:119]
    s_waitcnt lgkmcnt(5)
    v_mfma_f32_16x16x32_bf16 v[8:11], v[120:123], v[156:159], v[8:11]
    ds_read_b128 v[144:147], v166 offset:41984
    v_mfma_f32_16x16x32_bf16 v[12:15], v[120:123], v[160:163], v[12:15]
    s_waitcnt lgkmcnt(5)
    v_mfma_f32_16x16x32_bf16 v[16:19], v[124:127], v[156:159], v[16:19]
    ds_read_b128 v[120:123], v166 offset:44032
    v_mfma_f32_16x16x32_bf16 v[20:23], v[124:127], v[160:163], v[20:23]
    s_waitcnt lgkmcnt(5)
    v_mfma_f32_16x16x32_bf16 v[24:27], v[128:131], v[156:159], v[24:27]
    ds_read_b128 v[124:127], v166 offset:46080
    v_mfma_f32_16x16x32_bf16 v[28:31], v[128:131], v[160:163], v[28:31]
    s_waitcnt lgkmcnt(5)
    v_mfma_f32_16x16x32_bf16 v[32:35], v[132:135], v[156:159], v[32:35]
    ds_read_b128 v[128:131], v166 offset:48128
    v_mfma_f32_16x16x32_bf16 v[36:39], v[132:135], v[160:163], v[36:39]
    s_waitcnt lgkmcnt(5)
    v_mfma_f32_16x16x32_bf16 v[40:43], v[136:139], v[156:159], v[40:43]
    ds_read_b128 v[132:135], v166 offset:50176
    v_mfma_f32_16x16x32_bf16 v[44:47], v[136:139], v[160:163], v[44:47]
    s_waitcnt lgkmcnt(5)
    v_mfma_f32_16x16x32_bf16 v[48:51], v[140:143], v[156:159], v[48:51]
    ds_read_b128 v[136:139], v166 offset:52224
    v_mfma_f32_16x16x32_bf16 v[52:55], v[140:143], v[160:163], v[52:55]
    s_waitcnt lgkmcnt(5)
    v_mfma_f32_16x16x32_bf16 v[56:59], v[144:147], v[156:159], v[56:59]
    ds_read_b128 v[140:143], v166 offset:54272
    v_mfma_f32_16x16x32_bf16 v[60:63], v[144:147], v[160:163], v[60:63]
    s_waitcnt lgkmcnt(5)
    v_mfma_f32_16x16x32_bf16 v[64:67], v[120:123], v[156:159], v[64:67]
    ds_read_b128 v[144:147], v166 offset:56320
    v_mfma_f32_16x16x32_bf16 v[68:71], v[120:123], v[160:163], v[68:71]
    s_waitcnt lgkmcnt(5)
    v_mfma_f32_16x16x32_bf16 v[72:75], v[124:127], v[156:159], v[72:75]
    v_mfma_f32_16x16x32_bf16 v[76:79], v[124:127], v[160:163], v[76:79]
    s_waitcnt lgkmcnt(4)
    v_mfma_f32_16x16x32_bf16 v[80:83], v[128:131], v[156:159], v[80:83]
    v_mfma_f32_16x16x32_bf16 v[84:87], v[128:131], v[160:163], v[84:87]
    s_waitcnt lgkmcnt(0)
    s_barrier
    v_mfma_f32_16x16x32_bf16 v[88:91], v[132:135], v[156:159], v[88:91]
    ds_read_b128 v[120:123], v167 offset:0
    ds_read_b128 v[148:151], v164 offset:32768
    ds_read_b128 v[124:127], v167 offset:2048
    v_mfma_f32_16x16x32_bf16 v[92:95], v[132:135], v[160:163], v[92:95]
    ds_read_b128 v[152:155], v164 offset:34816
    ds_read_b128 v[128:131], v167 offset:4096
    v_mfma_f32_16x16x32_bf16 v[96:99], v[136:139], v[156:159], v[96:99]
    ds_read_b128 v[132:135], v167 offset:6144
    v_mfma_f32_16x16x32_bf16 v[100:103], v[136:139], v[160:163], v[100:103]
    v_mfma_f32_16x16x32_bf16 v[104:107], v[140:143], v[156:159], v[104:107]
    ds_read_b128 v[136:139], v167 offset:8192
    v_mfma_f32_16x16x32_bf16 v[108:111], v[140:143], v[160:163], v[108:111]
    v_mfma_f32_16x16x32_bf16 v[112:115], v[144:147], v[156:159], v[112:115]
    ds_read_b128 v[140:143], v167 offset:10240
    v_mfma_f32_16x16x32_bf16 v[116:119], v[144:147], v[160:163], v[116:119]
    s_waitcnt lgkmcnt(4)
    v_mfma_f32_16x16x32_bf16 v[8:11], v[120:123], v[148:151], v[8:11]
    ds_read_b128 v[144:147], v167 offset:12288
    v_mfma_f32_16x16x32_bf16 v[12:15], v[120:123], v[152:155], v[12:15]
    v_mfma_f32_16x16x32_bf16 v[16:19], v[124:127], v[148:151], v[16:19]
    ds_read_b128 v[120:123], v167 offset:14336
    v_mfma_f32_16x16x32_bf16 v[20:23], v[124:127], v[152:155], v[20:23]
    s_waitcnt lgkmcnt(5)
    v_mfma_f32_16x16x32_bf16 v[24:27], v[128:131], v[148:151], v[24:27]
    ds_read_b128 v[124:127], v167 offset:16384
    v_mfma_f32_16x16x32_bf16 v[28:31], v[128:131], v[152:155], v[28:31]
    ds_read_b128 v[156:159], v165 offset:32768
    s_waitcnt lgkmcnt(6)
    v_mfma_f32_16x16x32_bf16 v[32:35], v[132:135], v[148:151], v[32:35]
    ds_read_b128 v[128:131], v167 offset:18432
    v_mfma_f32_16x16x32_bf16 v[36:39], v[132:135], v[152:155], v[36:39]
    ds_read_b128 v[160:163], v165 offset:34816
    s_waitcnt lgkmcnt(7)
    v_mfma_f32_16x16x32_bf16 v[40:43], v[136:139], v[148:151], v[40:43]
    ds_read_b128 v[132:135], v167 offset:20480
    v_mfma_f32_16x16x32_bf16 v[44:47], v[136:139], v[152:155], v[44:47]
    s_waitcnt lgkmcnt(7)
    v_mfma_f32_16x16x32_bf16 v[48:51], v[140:143], v[148:151], v[48:51]
    ds_read_b128 v[136:139], v167 offset:22528
    v_mfma_f32_16x16x32_bf16 v[52:55], v[140:143], v[152:155], v[52:55]
    s_waitcnt lgkmcnt(7)
    v_mfma_f32_16x16x32_bf16 v[56:59], v[144:147], v[148:151], v[56:59]
    ds_read_b128 v[140:143], v167 offset:24576
    v_mfma_f32_16x16x32_bf16 v[60:63], v[144:147], v[152:155], v[60:63]
    s_waitcnt lgkmcnt(7)
    v_mfma_f32_16x16x32_bf16 v[64:67], v[120:123], v[148:151], v[64:67]
    ds_read_b128 v[144:147], v167 offset:26624
    v_mfma_f32_16x16x32_bf16 v[68:71], v[120:123], v[152:155], v[68:71]
    s_waitcnt lgkmcnt(7)
    v_mfma_f32_16x16x32_bf16 v[72:75], v[124:127], v[148:151], v[72:75]
    ds_read_b128 v[120:123], v167 offset:1024
    v_mfma_f32_16x16x32_bf16 v[76:79], v[124:127], v[152:155], v[76:79]
    s_waitcnt lgkmcnt(6)
    v_mfma_f32_16x16x32_bf16 v[80:83], v[128:131], v[148:151], v[80:83]
    ds_read_b128 v[124:127], v167 offset:3072
    v_mfma_f32_16x16x32_bf16 v[84:87], v[128:131], v[152:155], v[84:87]
    s_waitcnt lgkmcnt(5)
    v_mfma_f32_16x16x32_bf16 v[88:91], v[132:135], v[148:151], v[88:91]
    ds_read_b128 v[128:131], v167 offset:5120
    v_mfma_f32_16x16x32_bf16 v[92:95], v[132:135], v[152:155], v[92:95]
    s_waitcnt lgkmcnt(5)
    v_mfma_f32_16x16x32_bf16 v[96:99], v[136:139], v[148:151], v[96:99]
    ds_read_b128 v[132:135], v167 offset:7168
    v_mfma_f32_16x16x32_bf16 v[100:103], v[136:139], v[152:155], v[100:103]
    s_waitcnt lgkmcnt(5)
    v_mfma_f32_16x16x32_bf16 v[104:107], v[140:143], v[148:151], v[104:107]
    ds_read_b128 v[136:139], v167 offset:9216
    v_mfma_f32_16x16x32_bf16 v[108:111], v[140:143], v[152:155], v[108:111]
    s_waitcnt lgkmcnt(5)
    v_mfma_f32_16x16x32_bf16 v[112:115], v[144:147], v[148:151], v[112:115]
    ds_read_b128 v[140:143], v167 offset:11264
    v_mfma_f32_16x16x32_bf16 v[116:119], v[144:147], v[152:155], v[116:119]
    s_waitcnt lgkmcnt(5)
    v_mfma_f32_16x16x32_bf16 v[8:11], v[120:123], v[156:159], v[8:11]
    ds_read_b128 v[144:147], v167 offset:13312
    v_mfma_f32_16x16x32_bf16 v[12:15], v[120:123], v[160:163], v[12:15]
    s_waitcnt lgkmcnt(5)
    v_mfma_f32_16x16x32_bf16 v[16:19], v[124:127], v[156:159], v[16:19]
    ds_read_b128 v[120:123], v167 offset:15360
    v_mfma_f32_16x16x32_bf16 v[20:23], v[124:127], v[160:163], v[20:23]
    s_waitcnt lgkmcnt(5)
    v_mfma_f32_16x16x32_bf16 v[24:27], v[128:131], v[156:159], v[24:27]
    ds_read_b128 v[124:127], v167 offset:17408
    v_mfma_f32_16x16x32_bf16 v[28:31], v[128:131], v[160:163], v[28:31]
    s_waitcnt lgkmcnt(5)
    v_mfma_f32_16x16x32_bf16 v[32:35], v[132:135], v[156:159], v[32:35]
    ds_read_b128 v[128:131], v167 offset:19456
    v_mfma_f32_16x16x32_bf16 v[36:39], v[132:135], v[160:163], v[36:39]
    s_waitcnt lgkmcnt(5)
    v_mfma_f32_16x16x32_bf16 v[40:43], v[136:139], v[156:159], v[40:43]
    ds_read_b128 v[132:135], v167 offset:21504
    v_mfma_f32_16x16x32_bf16 v[44:47], v[136:139], v[160:163], v[44:47]
    s_waitcnt lgkmcnt(5)
    v_mfma_f32_16x16x32_bf16 v[48:51], v[140:143], v[156:159], v[48:51]
    ds_read_b128 v[136:139], v167 offset:23552
    v_mfma_f32_16x16x32_bf16 v[52:55], v[140:143], v[160:163], v[52:55]
    s_waitcnt lgkmcnt(5)
    v_mfma_f32_16x16x32_bf16 v[56:59], v[144:147], v[156:159], v[56:59]
    ds_read_b128 v[140:143], v167 offset:25600
    v_mfma_f32_16x16x32_bf16 v[60:63], v[144:147], v[160:163], v[60:63]
    s_waitcnt lgkmcnt(5)
    v_mfma_f32_16x16x32_bf16 v[64:67], v[120:123], v[156:159], v[64:67]
    ds_read_b128 v[144:147], v167 offset:27648
    v_mfma_f32_16x16x32_bf16 v[68:71], v[120:123], v[160:163], v[68:71]
    s_waitcnt lgkmcnt(5)
    v_mfma_f32_16x16x32_bf16 v[72:75], v[124:127], v[156:159], v[72:75]
    v_mfma_f32_16x16x32_bf16 v[76:79], v[124:127], v[160:163], v[76:79]
    s_waitcnt lgkmcnt(4)
    v_mfma_f32_16x16x32_bf16 v[80:83], v[128:131], v[156:159], v[80:83]
    v_mfma_f32_16x16x32_bf16 v[84:87], v[128:131], v[160:163], v[84:87]
    s_waitcnt lgkmcnt(0)
    s_barrier
    v_mfma_f32_16x16x32_bf16 v[88:91], v[132:135], v[156:159], v[88:91]
    ds_read_b128 v[120:123], v166 offset:0
    ds_read_b128 v[148:151], v164 offset:0
    ds_read_b128 v[124:127], v166 offset:2048
    v_mfma_f32_16x16x32_bf16 v[92:95], v[132:135], v[160:163], v[92:95]
    ds_read_b128 v[152:155], v164 offset:2048
    ds_read_b128 v[128:131], v166 offset:4096
    v_mfma_f32_16x16x32_bf16 v[96:99], v[136:139], v[156:159], v[96:99]
    ds_read_b128 v[132:135], v166 offset:6144
    v_mfma_f32_16x16x32_bf16 v[100:103], v[136:139], v[160:163], v[100:103]
    v_mfma_f32_16x16x32_bf16 v[104:107], v[140:143], v[156:159], v[104:107]
    ds_read_b128 v[136:139], v166 offset:8192
    v_mfma_f32_16x16x32_bf16 v[108:111], v[140:143], v[160:163], v[108:111]
    v_mfma_f32_16x16x32_bf16 v[112:115], v[144:147], v[156:159], v[112:115]
    ds_read_b128 v[140:143], v166 offset:10240
    v_mfma_f32_16x16x32_bf16 v[116:119], v[144:147], v[160:163], v[116:119]
    s_sub_u32 s57, s57, 1
    s_cmp_lg_u32 s57, 0
    s_cbranch_scc1 ps_mm_151
    s_waitcnt lgkmcnt(4)
    v_mfma_f32_16x16x32_bf16 v[8:11], v[120:123], v[148:151], v[8:11]
    ds_read_b128 v[144:147], v166 offset:12288
    v_mfma_f32_16x16x32_bf16 v[12:15], v[120:123], v[152:155], v[12:15]
    v_mfma_f32_16x16x32_bf16 v[16:19], v[124:127], v[148:151], v[16:19]
    ds_read_b128 v[120:123], v166 offset:14336
    v_mfma_f32_16x16x32_bf16 v[20:23], v[124:127], v[152:155], v[20:23]
    s_waitcnt lgkmcnt(5)
    v_mfma_f32_16x16x32_bf16 v[24:27], v[128:131], v[148:151], v[24:27]
    ds_read_b128 v[124:127], v166 offset:16384
    v_mfma_f32_16x16x32_bf16 v[28:31], v[128:131], v[152:155], v[28:31]
    ds_read_b128 v[156:159], v165 offset:0
    s_waitcnt lgkmcnt(6)
    v_mfma_f32_16x16x32_bf16 v[32:35], v[132:135], v[148:151], v[32:35]
    ds_read_b128 v[128:131], v166 offset:18432
    v_mfma_f32_16x16x32_bf16 v[36:39], v[132:135], v[152:155], v[36:39]
    ds_read_b128 v[160:163], v165 offset:2048
    s_waitcnt lgkmcnt(7)
    v_mfma_f32_16x16x32_bf16 v[40:43], v[136:139], v[148:151], v[40:43]
    ds_read_b128 v[132:135], v166 offset:20480
    v_mfma_f32_16x16x32_bf16 v[44:47], v[136:139], v[152:155], v[44:47]
    s_waitcnt lgkmcnt(7)
    v_mfma_f32_16x16x32_bf16 v[48:51], v[140:143], v[148:151], v[48:51]
    ds_read_b128 v[136:139], v166 offset:22528
    v_mfma_f32_16x16x32_bf16 v[52:55], v[140:143], v[152:155], v[52:55]
    s_waitcnt lgkmcnt(7)
    v_mfma_f32_16x16x32_bf16 v[56:59], v[144:147], v[148:151], v[56:59]
    ds_read_b128 v[140:143], v166 offset:24576
    v_mfma_f32_16x16x32_bf16 v[60:63], v[144:147], v[152:155], v[60:63]
    s_waitcnt lgkmcnt(7)
    v_mfma_f32_16x16x32_bf16 v[64:67], v[120:123], v[148:151], v[64:67]
    ds_read_b128 v[144:147], v166 offset:26624
    v_mfma_f32_16x16x32_bf16 v[68:71], v[120:123], v[152:155], v[68:71]
    s_waitcnt lgkmcnt(7)
    v_mfma_f32_16x16x32_bf16 v[72:75], v[124:127], v[148:151], v[72:75]
    ds_read_b128 v[120:123], v166 offset:1024
    v_mfma_f32_16x16x32_bf16 v[76:79], v[124:127], v[152:155], v[76:79]
    s_waitcnt lgkmcnt(6)
    v_mfma_f32_16x16x32_bf16 v[80:83], v[128:131], v[148:151], v[80:83]
    ds_read_b128 v[124:127], v166 offset:3072
    v_mfma_f32_16x16x32_bf16 v[84:87], v[128:131], v[152:155], v[84:87]
    s_waitcnt lgkmcnt(5)
    v_mfma_f32_16x16x32_bf16 v[88:91], v[132:135], v[148:151], v[88:91]
    ds_read_b128 v[128:131], v166 offset:5120
    v_mfma_f32_16x16x32_bf16 v[92:95], v[132:135], v[152:155], v[92:95]
    s_waitcnt lgkmcnt(5)
    v_mfma_f32_16x16x32_bf16 v[96:99], v[136:139], v[148:151], v[96:99]
    ds_read_b128 v[132:135], v166 offset:7168
    v_mfma_f32_16x16x32_bf16 v[100:103], v[136:139], v[152:155], v[100:103]
    s_waitcnt lgkmcnt(5)
    v_mfma_f32_16x16x32_bf16 v[104:107], v[140:143], v[148:151], v[104:107]
    ds_read_b128 v[136:139], v166 offset:9216
    v_mfma_f32_16x16x32_bf16 v[108:111], v[140:143], v[152:155], v[108:111]
    s_waitcnt lgkmcnt(5)
    v_mfma_f32_16x16x32_bf16 v[112:115], v[144:147], v[148:151], v[112:115]
    ds_read_b128 v[140:143], v166 offset:11264
    v_mfma_f32_16x16x32_bf16 v[116:119], v[144:147], v[152:155], v[116:119]
    s_waitcnt lgkmcnt(5)
    v_mfma_f32_16x16x32_bf16 v[8:11], v[120:123], v[156:159], v[8:11]
    ds_read_b128 v[144:147], v166 offset:13312
    v_mfma_f32_16x16x32_bf16 v[12:15], v[120:123], v[160:163], v[12:15]
    s_waitcnt lgkmcnt(5)
    v_mfma_f32_16x16x32_bf16 v[16:19], v[124:127], v[156:159], v[16:19]
    ds_read_b128 v[120:123], v166 offset:15360
    v_mfma_f32_16x16x32_bf16 v[20:23], v[124:127], v[160:163], v[20:23]
    s_waitcnt lgkmcnt(5)
    v_mfma_f32_16x16x32_bf16 v[24:27], v[128:131], v[156:159], v[24:27]
    ds_read_b128 v[124:127], v166 offset:17408
    v_mfma_f32_16x16x32_bf16 v[28:31], v[128:131], v[160:163], v[28:31]
    s_waitcnt lgkmcnt(5)
    v_mfma_f32_16x16x32_bf16 v[32:35], v[132:135], v[156:159], v[32:35]
    ds_read_b128 v[128:131], v166 offset:19456
    v_mfma_f32_16x16x32_bf16 v[36:39], v[132:135], v[160:163], v[36:39]
    s_waitcnt lgkmcnt(5)
    v_mfma_f32_16x16x32_bf16 v[40:43], v[136:139], v[156:159], v[40:43]
    ds_read_b128 v[132:135], v166 offset:21504
    v_mfma_f32_16x16x32_bf16 v[44:47], v[136:139], v[160:163], v[44:47]
    s_waitcnt lgkmcnt(5)
    v_mfma_f32_16x16x32_bf16 v[48:51], v[140:143], v[156:159], v[48:51]
    ds_read_b128 v[136:139], v166 offset:23552
    v_mfma_f32_16x16x32_bf16 v[52:55], v[140:143], v[160:163], v[52:55]
    s_waitcnt lgkmcnt(5)
    v_mfma_f32_16x16x32_bf16 v[56:59], v[144:147], v[156:159], v[56:59]
    ds_read_b128 v[140:143], v166 offset:25600
    v_mfma_f32_16x16x32_bf16 v[60:63], v[144:147], v[160:163], v[60:63]
    s_waitcnt lgkmcnt(5)
    v_mfma_f32_16x16x32_bf16 v[64:67], v[120:123], v[156:159], v[64:67]
    ds_read_b128 v[144:147], v166 offset:27648
    v_mfma_f32_16x16x32_bf16 v[68:71], v[120:123], v[160:163], v[68:71]
    s_waitcnt lgkmcnt(5)
    v_mfma_f32_16x16x32_bf16 v[72:75], v[124:127], v[156:159], v[72:75]
    v_mfma_f32_16x16x32_bf16 v[76:79], v[124:127], v[160:163], v[76:79]
    s_waitcnt lgkmcnt(4)
    v_mfma_f32_16x16x32_bf16 v[80:83], v[128:131], v[156:159], v[80:83]
    v_mfma_f32_16x16x32_bf16 v[84:87], v[128:131], v[160:163], v[84:87]
    s_waitcnt lgkmcnt(0)
    s_barrier
    v_mfma_f32_16x16x32_bf16 v[88:91], v[132:135], v[156:159], v[88:91]
    ds_read_b128 v[120:123], v166 offset:28672
    ds_read_b128 v[148:151], v164 offset:16384
    ds_read_b128 v[124:127], v166 offset:30720
    v_mfma_f32_16x16x32_bf16 v[92:95], v[132:135], v[160:163], v[92:95]
    ds_read_b128 v[152:155], v164 offset:18432
    ds_read_b128 v[128:131], v166 offset:32768
    v_mfma_f32_16x16x32_bf16 v[96:99], v[136:139], v[156:159], v[96:99]
    ds_read_b128 v[132:135], v166 offset:34816
    v_mfma_f32_16x16x32_bf16 v[100:103], v[136:139], v[160:163], v[100:103]
    v_mfma_f32_16x16x32_bf16 v[104:107], v[140:143], v[156:159], v[104:107]
    ds_read_b128 v[136:139], v166 offset:36864
    v_mfma_f32_16x16x32_bf16 v[108:111], v[140:143], v[160:163], v[108:111]
    v_mfma_f32_16x16x32_bf16 v[112:115], v[144:147], v[156:159], v[112:115]
    ds_read_b128 v[140:143], v166 offset:38912
    v_mfma_f32_16x16x32_bf16 v[116:119], v[144:147], v[160:163], v[116:119]
    s_waitcnt lgkmcnt(0)
    v_and_b32 v2, 15, v0
    v_add_u32 v2, s70, v2
    v_lshlrev_b32 v2, 3, v2
    v_add_u32 v2, 160000, v2
    ds_read_b64 v[224:225], v2 offset:0
    ds_read_b64 v[226:227], v2 offset:128
    v_lshrrev_b32 v3, 4, v0
    v_lshlrev_b32 v3, 4, v3
    v_add_u32 v3, 161024, v3
    ds_read_b128 v[168:171], v3 offset:0
    ds_read_b128 v[172:175], v3 offset:64
    ds_read_b128 v[176:179], v3 offset:128
    ds_read_b128 v[180:183], v3 offset:192
    ds_read_b128 v[184:187], v3 offset:256
    ds_read_b128 v[188:191], v3 offset:320
    ds_read_b128 v[192:195], v3 offset:384
    ds_read_b128 v[196:199], v3 offset:512
    ds_read_b128 v[200:203], v3 offset:576
    ds_read_b128 v[204:207], v3 offset:640
    ds_read_b128 v[208:211], v3 offset:704
    ds_read_b128 v[212:215], v3 offset:768
    ds_read_b128 v[216:219], v3 offset:832
    ds_read_b128 v[220:223], v3 offset:896
    s_waitcnt lgkmcnt(0)
    s_mov_b32 s77, 55296
    v_pk_fma_f32 v[8:9], v[168:169], v[224:225], v[8:9] op_sel:[0,1,0] op_sel_hi:[1,1,1]
    v_pk_fma_f32 v[64:65], v[196:197], v[224:225], v[64:65] op_sel:[0,1,0] op_sel_hi:[1,1,1]
    v_pk_fma_f32 v[10:11], v[170:171], v[224:225], v[10:11] op_sel:[0,1,0] op_sel_hi:[1,1,1]
    v_pk_fma_f32 v[66:67], v[198:199], v[224:225], v[66:67] op_sel:[0,1,0] op_sel_hi:[1,1,1]
    v_pk_fma_f32 v[16:17], v[172:173], v[224:225], v[16:17] op_sel:[0,1,0] op_sel_hi:[1,1,1]
    v_pk_fma_f32 v[72:73], v[200:201], v[224:225], v[72:73] op_sel:[0,1,0] op_sel_hi:[1,1,1]
    v_pk_fma_f32 v[18:19], v[174:175], v[224:225], v[18:19] op_sel:[0,1,0] op_sel_hi:[1,1,1]
    v_pk_fma_f32 v[74:75], v[202:203], v[224:225], v[74:75] op_sel:[0,1,0] op_sel_hi:[1,1,1]
    v_pk_fma_f32 v[24:25], v[176:177], v[224:225], v[24:25] op_sel:[0,1,0] op_sel_hi:[1,1,1]
    v_pk_fma_f32 v[80:81], v[204:205], v[224:225], v[80:81] op_sel:[0,1,0] op_sel_hi:[1,1,1]
    v_pk_fma_f32 v[26:27], v[178:179], v[224:225], v[26:27] op_sel:[0,1,0] op_sel_hi:[1,1,1]
    v_pk_fma_f32 v[82:83], v[206:207], v[224:225], v[82:83] op_sel:[0,1,0] op_sel_hi:[1,1,1]
    v_pk_fma_f32 v[32:33], v[180:181], v[224:225], v[32:33] op_sel:[0,1,0] op_sel_hi:[1,1,1]
    v_pk_fma_f32 v[88:89], v[208:209], v[224:225], v[88:89] op_sel:[0,1,0] op_sel_hi:[1,1,1]
    v_pk_fma_f32 v[34:35], v[182:183], v[224:225], v[34:35] op_sel:[0,1,0] op_sel_hi:[1,1,1]
    v_pk_fma_f32 v[90:91], v[210:211], v[224:225], v[90:91] op_sel:[0,1,0] op_sel_hi:[1,1,1]
    v_pk_fma_f32 v[40:41], v[184:185], v[224:225], v[40:41] op_sel:[0,1,0] op_sel_hi:[1,1,1]
    v_pk_fma_f32 v[96:97], v[212:213], v[224:225], v[96:97] op_sel:[0,1,0] op_sel_hi:[1,1,1]
    v_pk_fma_f32 v[42:43], v[186:187], v[224:225], v[42:43] op_sel:[0,1,0] op_sel_hi:[1,1,1]
    v_pk_fma_f32 v[98:99], v[214:215], v[224:225], v[98:99] op_sel:[0,1,0] op_sel_hi:[1,1,1]
    v_pk_fma_f32 v[48:49], v[188:189], v[224:225], v[48:49] op_sel:[0,1,0] op_sel_hi:[1,1,1]
    v_pk_fma_f32 v[104:105], v[216:217], v[224:225], v[104:105] op_sel:[0,1,0] op_sel_hi:[1,1,1]
    v_pk_fma_f32 v[50:51], v[190:191], v[224:225], v[50:51] op_sel:[0,1,0] op_sel_hi:[1,1,1]
    v_pk_fma_f32 v[106:107], v[218:219], v[224:225], v[106:107] op_sel:[0,1,0] op_sel_hi:[1,1,1]
    v_pk_fma_f32 v[56:57], v[192:193], v[224:225], v[56:57] op_sel:[0,1,0] op_sel_hi:[1,1,1]
    v_pk_fma_f32 v[112:113], v[220:221], v[224:225], v[112:113] op_sel:[0,1,0] op_sel_hi:[1,1,1]
    v_pk_fma_f32 v[58:59], v[194:195], v[224:225], v[58:59] op_sel:[0,1,0] op_sel_hi:[1,1,1]
    v_pk_fma_f32 v[114:115], v[222:223], v[224:225], v[114:115] op_sel:[0,1,0] op_sel_hi:[1,1,1]
    v_pk_mul_f32 v[8:9], v[8:9], v[224:225] op_sel:[0,0] op_sel_hi:[1,0]
    v_pk_mul_f32 v[10:11], v[10:11], v[224:225] op_sel:[0,0] op_sel_hi:[1,0]
    v_pk_mul_f32 v[16:17], v[16:17], v[224:225] op_sel:[0,0] op_sel_hi:[1,0]
    v_pk_mul_f32 v[18:19], v[18:19], v[224:225] op_sel:[0,0] op_sel_hi:[1,0]
    v_pk_mul_f32 v[24:25], v[24:25], v[224:225] op_sel:[0,0] op_sel_hi:[1,0]
    v_pk_mul_f32 v[26:27], v[26:27], v[224:225] op_sel:[0,0] op_sel_hi:[1,0]
    v_pk_mul_f32 v[32:33], v[32:33], v[224:225] op_sel:[0,0] op_sel_hi:[1,0]
    v_pk_mul_f32 v[34:35], v[34:35], v[224:225] op_sel:[0,0] op_sel_hi:[1,0]
    v_pk_mul_f32 v[40:41], v[40:41], v[224:225] op_sel:[0,0] op_sel_hi:[1,0]
    v_pk_mul_f32 v[42:43], v[42:43], v[224:225] op_sel:[0,0] op_sel_hi:[1,0]
    v_pk_mul_f32 v[48:49], v[48:49], v[224:225] op_sel:[0,0] op_sel_hi:[1,0]
    v_pk_mul_f32 v[50:51], v[50:51], v[224:225] op_sel:[0,0] op_sel_hi:[1,0]
    v_pk_mul_f32 v[56:57], v[56:57], v[224:225] op_sel:[0,0] op_sel_hi:[1,0]
    v_pk_mul_f32 v[58:59], v[58:59], v[224:225] op_sel:[0,0] op_sel_hi:[1,0]
    v_pk_mul_f32 v[8:9], v[8:9], v[64:65]
    v_pk_mul_f32 v[10:11], v[10:11], v[66:67]
    v_pk_mul_f32 v[16:17], v[16:17], v[72:73]
    v_pk_mul_f32 v[18:19], v[18:19], v[74:75]
    v_pk_mul_f32 v[24:25], v[24:25], v[80:81]
    v_pk_mul_f32 v[26:27], v[26:27], v[82:83]
    v_pk_mul_f32 v[32:33], v[32:33], v[88:89]
    v_pk_mul_f32 v[34:35], v[34:35], v[90:91]
    v_pk_mul_f32 v[40:41], v[40:41], v[96:97]
    v_pk_mul_f32 v[42:43], v[42:43], v[98:99]
    v_pk_mul_f32 v[48:49], v[48:49], v[104:105]
    v_pk_mul_f32 v[50:51], v[50:51], v[106:107]
    v_pk_mul_f32 v[56:57], v[56:57], v[112:113]
    v_pk_mul_f32 v[58:59], v[58:59], v[114:115]
    v_cvt_pk_bf16_f32 v120, v8, v9
    v_cvt_pk_bf16_f32 v121, v10, v11
    v_cvt_pk_bf16_f32 v122, v16, v17
    v_cvt_pk_bf16_f32 v123, v18, v19
    v_cvt_pk_bf16_f32 v124, v24, v25
    v_cvt_pk_bf16_f32 v125, v26, v27
    v_cvt_pk_bf16_f32 v126, v32, v33
    v_cvt_pk_bf16_f32 v127, v34, v35
    v_cvt_pk_bf16_f32 v128, v40, v41
    v_cvt_pk_bf16_f32 v129, v42, v43
    v_cvt_pk_bf16_f32 v130, v48, v49
    v_cvt_pk_bf16_f32 v131, v50, v51
    v_cvt_pk_bf16_f32 v132, v56, v57
    v_cvt_pk_bf16_f32 v133, v58, v59
    s_cmp_eq_u32 s3, 0
    s_cbranch_scc1 ps_glob_153
    s_cmp_eq_u32 s0, 0
    s_cbranch_scc1 ps_glob_153
    buffer_store_dwordx2 v[120:121], v228, s[36:39], 0 offen offset:0
    buffer_store_dwordx2 v[122:123], v228, s[36:39], 0 offen offset:512
    buffer_store_dwordx2 v[124:125], v228, s[36:39], 0 offen offset:1024
    buffer_store_dwordx2 v[126:127], v228, s[36:39], 0 offen offset:1536
    buffer_store_dwordx2 v[128:129], v228, s[36:39], 0 offen offset:2048
    buffer_store_dwordx2 v[130:131], v228, s[36:39], 0 offen offset:2560
    buffer_store_dwordx2 v[132:133], v228, s[36:39], 0 offen offset:3072
    s_branch ps_dual_154
ps_glob_153:
    buffer_store_dwordx2 v[120:121], v228, s[36:39], 0 offen offset:0 sc1
    buffer_store_dwordx2 v[122:123], v228, s[36:39], 0 offen offset:512 sc1
    buffer_store_dwordx2 v[124:125], v228, s[36:39], 0 offen offset:1024 sc1
    buffer_store_dwordx2 v[126:127], v228, s[36:39], 0 offen offset:1536 sc1
    buffer_store_dwordx2 v[128:129], v228, s[36:39], 0 offen offset:2048 sc1
    buffer_store_dwordx2 v[130:131], v228, s[36:39], 0 offen offset:2560 sc1
    buffer_store_dwordx2 v[132:133], v228, s[36:39], 0 offen offset:3072 sc1
ps_dual_154:
    v_pk_fma_f32 v[12:13], v[168:169], v[226:227], v[12:13] op_sel:[0,1,0] op_sel_hi:[1,1,1]
    v_pk_fma_f32 v[68:69], v[196:197], v[226:227], v[68:69] op_sel:[0,1,0] op_sel_hi:[1,1,1]
    v_pk_fma_f32 v[14:15], v[170:171], v[226:227], v[14:15] op_sel:[0,1,0] op_sel_hi:[1,1,1]
    v_pk_fma_f32 v[70:71], v[198:199], v[226:227], v[70:71] op_sel:[0,1,0] op_sel_hi:[1,1,1]
    v_pk_fma_f32 v[20:21], v[172:173], v[226:227], v[20:21] op_sel:[0,1,0] op_sel_hi:[1,1,1]
    v_pk_fma_f32 v[76:77], v[200:201], v[226:227], v[76:77] op_sel:[0,1,0] op_sel_hi:[1,1,1]
    v_pk_fma_f32 v[22:23], v[174:175], v[226:227], v[22:23] op_sel:[0,1,0] op_sel_hi:[1,1,1]
    v_pk_fma_f32 v[78:79], v[202:203], v[226:227], v[78:79] op_sel:[0,1,0] op_sel_hi:[1,1,1]
    v_pk_fma_f32 v[28:29], v[176:177], v[226:227], v[28:29] op_sel:[0,1,0] op_sel_hi:[1,1,1]
    v_pk_fma_f32 v[84:85], v[204:205], v[226:227], v[84:85] op_sel:[0,1,0] op_sel_hi:[1,1,1]
    v_pk_fma_f32 v[30:31], v[178:179], v[226:227], v[30:31] op_sel:[0,1,0] op_sel_hi:[1,1,1]
    v_pk_fma_f32 v[86:87], v[206:207], v[226:227], v[86:87] op_sel:[0,1,0] op_sel_hi:[1,1,1]
    v_pk_fma_f32 v[36:37], v[180:181], v[226:227], v[36:37] op_sel:[0,1,0] op_sel_hi:[1,1,1]
    v_pk_fma_f32 v[92:93], v[208:209], v[226:227], v[92:93] op_sel:[0,1,0] op_sel_hi:[1,1,1]
    v_pk_fma_f32 v[38:39], v[182:183], v[226:227], v[38:39] op_sel:[0,1,0] op_sel_hi:[1,1,1]
    v_pk_fma_f32 v[94:95], v[210:211], v[226:227], v[94:95] op_sel:[0,1,0] op_sel_hi:[1,1,1]
    v_pk_fma_f32 v[44:45], v[184:185], v[226:227], v[44:45] op_sel:[0,1,0] op_sel_hi:[1,1,1]
    v_pk_fma_f32 v[100:101], v[212:213], v[226:227], v[100:101] op_sel:[0,1,0] op_sel_hi:[1,1,1]
    v_pk_fma_f32 v[46:47], v[186:187], v[226:227], v[46:47] op_sel:[0,1,0] op_sel_hi:[1,1,1]
    v_pk_fma_f32 v[102:103], v[214:215], v[226:227], v[102:103] op_sel:[0,1,0] op_sel_hi:[1,1,1]
    v_pk_fma_f32 v[52:53], v[188:189], v[226:227], v[52:53] op_sel:[0,1,0] op_sel_hi:[1,1,1]
    v_pk_fma_f32 v[108:109], v[216:217], v[226:227], v[108:109] op_sel:[0,1,0] op_sel_hi:[1,1,1]
    v_pk_fma_f32 v[54:55], v[190:191], v[226:227], v[54:55] op_sel:[0,1,0] op_sel_hi:[1,1,1]
    v_pk_fma_f32 v[110:111], v[218:219], v[226:227], v[110:111] op_sel:[0,1,0] op_sel_hi:[1,1,1]
    v_pk_fma_f32 v[60:61], v[192:193], v[226:227], v[60:61] op_sel:[0,1,0] op_sel_hi:[1,1,1]
    v_pk_fma_f32 v[116:117], v[220:221], v[226:227], v[116:117] op_sel:[0,1,0] op_sel_hi:[1,1,1]
    v_pk_fma_f32 v[62:63], v[194:195], v[226:227], v[62:63] op_sel:[0,1,0] op_sel_hi:[1,1,1]
    v_pk_fma_f32 v[118:119], v[222:223], v[226:227], v[118:119] op_sel:[0,1,0] op_sel_hi:[1,1,1]
    v_pk_mul_f32 v[12:13], v[12:13], v[226:227] op_sel:[0,0] op_sel_hi:[1,0]
    v_pk_mul_f32 v[14:15], v[14:15], v[226:227] op_sel:[0,0] op_sel_hi:[1,0]
    v_pk_mul_f32 v[20:21], v[20:21], v[226:227] op_sel:[0,0] op_sel_hi:[1,0]
    v_pk_mul_f32 v[22:23], v[22:23], v[226:227] op_sel:[0,0] op_sel_hi:[1,0]
    v_pk_mul_f32 v[28:29], v[28:29], v[226:227] op_sel:[0,0] op_sel_hi:[1,0]
    v_pk_mul_f32 v[30:31], v[30:31], v[226:227] op_sel:[0,0] op_sel_hi:[1,0]
    v_pk_mul_f32 v[36:37], v[36:37], v[226:227] op_sel:[0,0] op_sel_hi:[1,0]
    v_pk_mul_f32 v[38:39], v[38:39], v[226:227] op_sel:[0,0] op_sel_hi:[1,0]
    v_pk_mul_f32 v[44:45], v[44:45], v[226:227] op_sel:[0,0] op_sel_hi:[1,0]
    v_pk_mul_f32 v[46:47], v[46:47], v[226:227] op_sel:[0,0] op_sel_hi:[1,0]
    v_pk_mul_f32 v[52:53], v[52:53], v[226:227] op_sel:[0,0] op_sel_hi:[1,0]
    v_pk_mul_f32 v[54:55], v[54:55], v[226:227] op_sel:[0,0] op_sel_hi:[1,0]
    v_pk_mul_f32 v[60:61], v[60:61], v[226:227] op_sel:[0,0] op_sel_hi:[1,0]
    v_pk_mul_f32 v[62:63], v[62:63], v[226:227] op_sel:[0,0] op_sel_hi:[1,0]
    v_pk_mul_f32 v[12:13], v[12:13], v[68:69]
    v_pk_mul_f32 v[14:15], v[14:15], v[70:71]
    v_pk_mul_f32 v[20:21], v[20:21], v[76:77]
    v_pk_mul_f32 v[22:23], v[22:23], v[78:79]
    v_pk_mul_f32 v[28:29], v[28:29], v[84:85]
    v_pk_mul_f32 v[30:31], v[30:31], v[86:87]
    v_pk_mul_f32 v[36:37], v[36:37], v[92:93]
    v_pk_mul_f32 v[38:39], v[38:39], v[94:95]
    v_pk_mul_f32 v[44:45], v[44:45], v[100:101]
    v_pk_mul_f32 v[46:47], v[46:47], v[102:103]
    v_pk_mul_f32 v[52:53], v[52:53], v[108:109]
    v_pk_mul_f32 v[54:55], v[54:55], v[110:111]
    v_pk_mul_f32 v[60:61], v[60:61], v[116:117]
    v_pk_mul_f32 v[62:63], v[62:63], v[118:119]
    v_cvt_pk_bf16_f32 v134, v12, v13
    v_cvt_pk_bf16_f32 v135, v14, v15
    v_cvt_pk_bf16_f32 v136, v20, v21
    v_cvt_pk_bf16_f32 v137, v22, v23
    v_cvt_pk_bf16_f32 v138, v28, v29
    v_cvt_pk_bf16_f32 v139, v30, v31
    v_cvt_pk_bf16_f32 v140, v36, v37
    v_cvt_pk_bf16_f32 v141, v38, v39
    v_cvt_pk_bf16_f32 v142, v44, v45
    v_cvt_pk_bf16_f32 v143, v46, v47
    v_cvt_pk_bf16_f32 v144, v52, v53
    v_cvt_pk_bf16_f32 v145, v54, v55
    v_cvt_pk_bf16_f32 v146, v60, v61
    v_cvt_pk_bf16_f32 v147, v62, v63
    s_cmp_eq_u32 s3, 0
    s_cbranch_scc1 ps_glob_155
    s_cmp_eq_u32 s0, 0
    s_cbranch_scc1 ps_glob_155
    buffer_store_dwordx2 v[134:135], v228, s[36:39], s77 offen offset:0
    buffer_store_dwordx2 v[136:137], v228, s[36:39], s77 offen offset:512
    buffer_store_dwordx2 v[138:139], v228, s[36:39], s77 offen offset:1024
    buffer_store_dwordx2 v[140:141], v228, s[36:39], s77 offen offset:1536
    buffer_store_dwordx2 v[142:143], v228, s[36:39], s77 offen offset:2048
    buffer_store_dwordx2 v[144:145], v228, s[36:39], s77 offen offset:2560
    buffer_store_dwordx2 v[146:147], v228, s[36:39], s77 offen offset:3072
    s_branch ps_dual_156
ps_glob_155:
    buffer_store_dwordx2 v[134:135], v228, s[36:39], s77 offen offset:0 sc1
    buffer_store_dwordx2 v[136:137], v228, s[36:39], s77 offen offset:512 sc1
    buffer_store_dwordx2 v[138:139], v228, s[36:39], s77 offen offset:1024 sc1
    buffer_store_dwordx2 v[140:141], v228, s[36:39], s77 offen offset:1536 sc1
    buffer_store_dwordx2 v[142:143], v228, s[36:39], s77 offen offset:2048 sc1
    buffer_store_dwordx2 v[144:145], v228, s[36:39], s77 offen offset:2560 sc1
    buffer_store_dwordx2 v[146:147], v228, s[36:39], s77 offen offset:3072 sc1
ps_dual_156:
    v_mov_b32 v2, 159768
    ds_read_b64 v[2:3], v2
    s_add_u32 s48, s20, 51134464
    s_addc_u32 s49, s21, 0
    s_mov_b32 s50, 65536
    s_mov_b32 s51, 0x20000
    s_lshl_b32 s62, s23, 12
    s_lshl_b32 s63, s96, 7
    s_add_u32 s62, s62, s63
    s_add_u32 s62, s62, 32768
    v_mov_b32 v6, s62
    v_mov_b32 v7, 159744
    v_mov_b32 v8, 3
    s_mul_i32 s63, s3, 5
    s_add_u32 s63, s63, 4
    s_waitcnt lgkmcnt(0)
    v_add_u32 v2, s63, v2
    s_mov_b64 exec, 1
    s_waitcnt vmcnt(0)
    ds_inc_rtn_u32 v9, v7, v8
    s_waitcnt lgkmcnt(0)
    v_readfirstlane_b32 s61, v9
    s_nop 3
    s_cmp_lg_u32 s61, 3
    s_cbranch_scc1 ps_nosig_157
    s_cmp_eq_u32 s0, 0
    s_cbranch_scc1 ps_glob_158
    buffer_store_dwordx2 v[2:3], v6, s[48:51], 0 offen
    s_branch ps_dual_159
ps_glob_158:
    buffer_store_dwordx2 v[2:3], v6, s[48:51], 0 offen sc1
ps_dual_159:
ps_nosig_157:
    s_mov_b64 exec, -1
    s_and_b32 s62, s96, 3
    s_lshl_b32 s63, s23, 2
    s_add_u32 s62, s62, s63
    s_lshl_b32 s52, s62, 6
    s_lshr_b32 s61, s96, 2
    s_mul_i32 s53, s61, 80
    s_add_u32 s40, s20, 20971520
    s_addc_u32 s41, s21, 0
    s_mov_b32 s42, 2621440
    s_mov_b32 s43, 0x20000
    s_add_u32 s36, s20, 26214400
    s_addc_u32 s37, s21, 0
    s_add_u32 s38, s18, 0
    s_addc_u32 s39, s19, 0
    s_cmp_eq_u32 s3, 0
    s_cselect_b32 s36, s36, s38
    s_cselect_b32 s37, s37, s39
    s_mov_b32 s38, 2621440
    s_mov_b32 s39, 0x20000
    s_add_u32 s44, s20, 43122688
    s_addc_u32 s45, s21, 0
    s_mov_b32 s46, 131072
    s_mov_b32 s47, 0x20000
    s_lshl_b32 s68, s22, 4
    s_add_u32 s68, s68, s52
    v_and_b32 v4, 15, v0
    v_add_u32 v4, s68, v4
    v_lshlrev_b32 v7, 6, v4
    v_mul_u32_u24 v4, 1280, v4
    v_lshrrev_b32 v5, 4, v0
    v_lshlrev_b32 v5, 3, v5
    s_lshl_b32 s75, s53, 1
    v_add3_u32 v150, v4, v5, s75
    s_lshl_b32 s75, s61, 3
    v_add_u32 v152, s75, v7
    v_and_b32 v2, 15, v0
    v_lshrrev_b32 v3, 4, v0
    v_lshrrev_b32 v4, 1, v3
    v_lshlrev_b32 v4, 8, v4
    v_lshl_add_u32 v4, v2, 4, v4
    v_and_b32 v3, 1, v3
    v_lshl_add_u32 v151, v3, 3, v4
    s_lshr_b32 s74, s68, 4
    s_mul_i32 s74, s74, 20480
    s_lshl_b32 s75, s53, 5
    s_add_u32 s74, s74, s75
    v_add_u32 v151, s74, v151
    buffer_load_dwordx2 v[140:141], v151, s[40:43], 0 offen offset:0 sc1
    buffer_load_dwordx2 v[142:143], v151, s[40:43], 0 offen offset:512 sc1
    buffer_load_dwordx2 v[144:145], v151, s[40:43], 0 offen offset:1024 sc1
    buffer_load_dwordx2 v[146:147], v151, s[40:43], 0 offen offset:1536 sc1
    buffer_load_dwordx2 v[148:149], v151, s[40:43], 0 offen offset:2048 sc1
    s_mov_b32 s76, s22
    s_lshl_b32 s62, s76, 11
    v_lshlrev_b32 v4, 4, v0
    v_add_u32 v136, s62, v4
    v_add_u32 v137, 1024, v136
    v_lshlrev_b32 v138, 4, v0
    v_add_u32 v138, 65536, v138
    v_add_u32 v139, 51200, v138
    v_mov_b32 v16, 0
    v_mov_b32 v17, 0
    v_mov_b32 v18, 0
    v_mov_b32 v19, 0
    v_mov_b32 v20, 0
    v_mov_b32 v21, 0
    v_mov_b32 v22, 0
    v_mov_b32 v23, 0
    v_mov_b32 v24, 0
    v_mov_b32 v25, 0
    v_mov_b32 v26, 0
    v_mov_b32 v27, 0
    v_mov_b32 v28, 0
    v_mov_b32 v29, 0
    v_mov_b32 v30, 0
    v_mov_b32 v31, 0
    v_mov_b32 v32, 0
    v_mov_b32 v33, 0
    v_mov_b32 v34, 0
    v_mov_b32 v35, 0
    s_barrier
    ds_read_b128 v[80:83], v136 offset:0
    ds_read_b128 v[40:43], v138 offset:0
    ds_read_b128 v[44:47], v138 offset:2048
    ds_read_b128 v[48:51], v138 offset:4096
    ds_read_b128 v[52:55], v138 offset:6144
    ds_read_b128 v[56:59], v138 offset:8192
    ds_read_b128 v[84:87], v137 offset:0
    ds_read_b128 v[60:63], v138 offset:1024
    ds_read_b128 v[64:67], v138 offset:3072
    ds_read_b128 v[68:71], v138 offset:5120
    ds_read_b128 v[72:75], v138 offset:7168
    ds_read_b128 v[76:79], v138 offset:9216
    s_mov_b32 s57, 3
ps_fs_160:
    s_cmp_lg_u32 s57, 1
    s_cbranch_scc1 ps_tl_161
    s_cmp_lg_u32 s3, 0
    s_cbranch_scc1 ps_notouch_162
    v_lshlrev_b32 v153, 7, v0
    v_add_u32 v153, s74, v153
    s_mov_b64 exec, 0xfffff
    buffer_load_dword v154, v153, s[36:39], 0 offen sc1
    s_mov_b64 exec, 0xffff
    buffer_load_dword v154, v152, s[44:47], 0 offen sc1
    s_mov_b64 exec, -1
ps_notouch_162:
ps_tl_161:
    s_waitcnt lgkmcnt(0)
    s_barrier
    v_mfma_f32_16x16x32_bf16 v[16:19], v[40:43], v[80:83], v[16:19]
    ds_read_b128 v[128:131], v136 offset:8192
    ds_read_b128 v[88:91], v138 offset:10240
    v_mfma_f32_16x16x32_bf16 v[20:23], v[44:47], v[80:83], v[20:23]
    ds_read_b128 v[92:95], v138 offset:12288
    v_mfma_f32_16x16x32_bf16 v[24:27], v[48:51], v[80:83], v[24:27]
    ds_read_b128 v[96:99], v138 offset:14336
    ds_read_b128 v[100:103], v138 offset:16384
    v_mfma_f32_16x16x32_bf16 v[28:31], v[52:55], v[80:83], v[28:31]
    ds_read_b128 v[104:107], v138 offset:18432
    v_mfma_f32_16x16x32_bf16 v[32:35], v[56:59], v[80:83], v[32:35]
    ds_read_b128 v[132:135], v137 offset:8192
    ds_read_b128 v[108:111], v138 offset:11264
    v_mfma_f32_16x16x32_bf16 v[16:19], v[60:63], v[84:87], v[16:19]
    ds_read_b128 v[112:115], v138 offset:13312
    v_mfma_f32_16x16x32_bf16 v[20:23], v[64:67], v[84:87], v[20:23]
    ds_read_b128 v[116:119], v138 offset:15360
    ds_read_b128 v[120:123], v138 offset:17408
    v_mfma_f32_16x16x32_bf16 v[24:27], v[68:71], v[84:87], v[24:27]
    ds_read_b128 v[124:127], v138 offset:19456
    v_mfma_f32_16x16x32_bf16 v[28:31], v[72:75], v[84:87], v[28:31]
    v_mfma_f32_16x16x32_bf16 v[32:35], v[76:79], v[84:87], v[32:35]
    s_waitcnt lgkmcnt(0)
    s_barrier
    v_mfma_f32_16x16x32_bf16 v[16:19], v[88:91], v[128:131], v[16:19]
    ds_read_b128 v[80:83], v136 offset:16384
    ds_read_b128 v[40:43], v138 offset:20480
    v_mfma_f32_16x16x32_bf16 v[20:23], v[92:95], v[128:131], v[20:23]
    ds_read_b128 v[44:47], v138 offset:22528
    v_mfma_f32_16x16x32_bf16 v[24:27], v[96:99], v[128:131], v[24:27]
    ds_read_b128 v[48:51], v138 offset:24576
    ds_read_b128 v[52:55], v138 offset:26624
    v_mfma_f32_16x16x32_bf16 v[28:31], v[100:103], v[128:131], v[28:31]
    ds_read_b128 v[56:59], v138 offset:28672
    v_mfma_f32_16x16x32_bf16 v[32:35], v[104:107], v[128:131], v[32:35]
    ds_read_b128 v[84:87], v137 offset:16384
    ds_read_b128 v[60:63], v138 offset:21504
    v_mfma_f32_16x16x32_bf16 v[16:19], v[108:111], v[132:135], v[16:19]
    ds_read_b128 v[64:67], v138 offset:23552
    v_mfma_f32_16x16x32_bf16 v[20:23], v[112:115], v[132:135], v[20:23]
    ds_read_b128 v[68:71], v138 offset:25600
    ds_read_b128 v[72:75], v138 offset:27648
    v_mfma_f32_16x16x32_bf16 v[24:27], v[116:119], v[132:135], v[24:27]
    ds_read_b128 v[76:79], v138 offset:29696
    v_mfma_f32_16x16x32_bf16 v[28:31], v[120:123], v[132:135], v[28:31]
    v_mfma_f32_16x16x32_bf16 v[32:35], v[124:127], v[132:135], v[32:35]
    s_waitcnt lgkmcnt(0)
    s_barrier
    v_mfma_f32_16x16x32_bf16 v[16:19], v[40:43], v[80:83], v[16:19]
    ds_read_b128 v[128:131], v136 offset:24576
    ds_read_b128 v[88:91], v138 offset:30720
    v_mfma_f32_16x16x32_bf16 v[20:23], v[44:47], v[80:83], v[20:23]
    ds_read_b128 v[92:95], v138 offset:32768
    v_mfma_f32_16x16x32_bf16 v[24:27], v[48:51], v[80:83], v[24:27]
    ds_read_b128 v[96:99], v138 offset:34816
    ds_read_b128 v[100:103], v138 offset:36864
    v_mfma_f32_16x16x32_bf16 v[28:31], v[52:55], v[80:83], v[28:31]
    ds_read_b128 v[104:107], v138 offset:38912
    v_mfma_f32_16x16x32_bf16 v[32:35], v[56:59], v[80:83], v[32:35]
    ds_read_b128 v[132:135], v137 offset:24576
    ds_read_b128 v[108:111], v138 offset:31744
    v_mfma_f32_16x16x32_bf16 v[16:19], v[60:63], v[84:87], v[16:19]
    ds_read_b128 v[112:115], v138 offset:33792
    v_mfma_f32_16x16x32_bf16 v[20:23], v[64:67], v[84:87], v[20:23]
    ds_read_b128 v[116:119], v138 offset:35840
    ds_read_b128 v[120:123], v138 offset:37888
    v_mfma_f32_16x16x32_bf16 v[24:27], v[68:71], v[84:87], v[24:27]
    ds_read_b128 v[124:127], v138 offset:39936
    v_mfma_f32_16x16x32_bf16 v[28:31], v[72:75], v[84:87], v[28:31]
    v_mfma_f32_16x16x32_bf16 v[32:35], v[76:79], v[84:87], v[32:35]
    s_waitcnt lgkmcnt(0)
    s_barrier
    v_mfma_f32_16x16x32_bf16 v[16:19], v[88:91], v[128:131], v[16:19]
    ds_read_b128 v[80:83], v136 offset:32768
    ds_read_b128 v[40:43], v138 offset:40960
    v_mfma_f32_16x16x32_bf16 v[20:23], v[92:95], v[128:131], v[20:23]
    ds_read_b128 v[44:47], v138 offset:43008
    v_mfma_f32_16x16x32_bf16 v[24:27], v[96:99], v[128:131], v[24:27]
    ds_read_b128 v[48:51], v138 offset:45056
    ds_read_b128 v[52:55], v138 offset:47104
    v_mfma_f32_16x16x32_bf16 v[28:31], v[100:103], v[128:131], v[28:31]
    ds_read_b128 v[56:59], v138 offset:49152
    v_mfma_f32_16x16x32_bf16 v[32:35], v[104:107], v[128:131], v[32:35]
    ds_read_b128 v[84:87], v137 offset:32768
    ds_read_b128 v[60:63], v138 offset:41984
    v_mfma_f32_16x16x32_bf16 v[16:19], v[108:111], v[132:135], v[16:19]
    ds_read_b128 v[64:67], v138 offset:44032
    v_mfma_f32_16x16x32_bf16 v[20:23], v[112:115], v[132:135], v[20:23]
    ds_read_b128 v[68:71], v138 offset:46080
    ds_read_b128 v[72:75], v138 offset:48128
    v_mfma_f32_16x16x32_bf16 v[24:27], v[116:119], v[132:135], v[24:27]
    ds_read_b128 v[76:79], v138 offset:50176
    v_mfma_f32_16x16x32_bf16 v[28:31], v[120:123], v[132:135], v[28:31]
    v_mfma_f32_16x16x32_bf16 v[32:35], v[124:127], v[132:135], v[32:35]
    s_waitcnt lgkmcnt(0)
    s_barrier
    v_mfma_f32_16x16x32_bf16 v[16:19], v[40:43], v[80:83], v[16:19]
    ds_read_b128 v[128:131], v136 offset:40960
    ds_read_b128 v[88:91], v139 offset:0
    v_mfma_f32_16x16x32_bf16 v[20:23], v[44:47], v[80:83], v[20:23]
    ds_read_b128 v[92:95], v139 offset:2048
    v_mfma_f32_16x16x32_bf16 v[24:27], v[48:51], v[80:83], v[24:27]
    ds_read_b128 v[96:99], v139 offset:4096
    ds_read_b128 v[100:103], v139 offset:6144
    v_mfma_f32_16x16x32_bf16 v[28:31], v[52:55], v[80:83], v[28:31]
    ds_read_b128 v[104:107], v139 offset:8192
    v_mfma_f32_16x16x32_bf16 v[32:35], v[56:59], v[80:83], v[32:35]
    ds_read_b128 v[132:135], v137 offset:40960
    ds_read_b128 v[108:111], v139 offset:1024
    v_mfma_f32_16x16x32_bf16 v[16:19], v[60:63], v[84:87], v[16:19]
    ds_read_b128 v[112:115], v139 offset:3072
    v_mfma_f32_16x16x32_bf16 v[20:23], v[64:67], v[84:87], v[20:23]
    ds_read_b128 v[116:119], v139 offset:5120
    ds_read_b128 v[120:123], v139 offset:7168
    v_mfma_f32_16x16x32_bf16 v[24:27], v[68:71], v[84:87], v[24:27]
    ds_read_b128 v[124:127], v139 offset:9216
    v_mfma_f32_16x16x32_bf16 v[28:31], v[72:75], v[84:87], v[28:31]
    v_mfma_f32_16x16x32_bf16 v[32:35], v[76:79], v[84:87], v[32:35]
    s_waitcnt lgkmcnt(0)
    s_barrier
    v_mfma_f32_16x16x32_bf16 v[16:19], v[88:91], v[128:131], v[16:19]
    ds_read_b128 v[80:83], v136 offset:49152
    ds_read_b128 v[40:43], v139 offset:10240
    v_mfma_f32_16x16x32_bf16 v[20:23], v[92:95], v[128:131], v[20:23]
    ds_read_b128 v[44:47], v139 offset:12288
    v_mfma_f32_16x16x32_bf16 v[24:27], v[96:99], v[128:131], v[24:27]
    ds_read_b128 v[48:51], v139 offset:14336
    ds_read_b128 v[52:55], v139 offset:16384
    v_mfma_f32_16x16x32_bf16 v[28:31], v[100:103], v[128:131], v[28:31]
    ds_read_b128 v[56:59], v139 offset:18432
    v_mfma_f32_16x16x32_bf16 v[32:35], v[104:107], v[128:131], v[32:35]
    ds_read_b128 v[84:87], v137 offset:49152
    ds_read_b128 v[60:63], v139 offset:11264
    v_mfma_f32_16x16x32_bf16 v[16:19], v[108:111], v[132:135], v[16:19]
    ds_read_b128 v[64:67], v139 offset:13312
    v_mfma_f32_16x16x32_bf16 v[20:23], v[112:115], v[132:135], v[20:23]
    ds_read_b128 v[68:71], v139 offset:15360
    ds_read_b128 v[72:75], v139 offset:17408
    v_mfma_f32_16x16x32_bf16 v[24:27], v[116:119], v[132:135], v[24:27]
    ds_read_b128 v[76:79], v139 offset:19456
    v_mfma_f32_16x16x32_bf16 v[28:31], v[120:123], v[132:135], v[28:31]
    v_mfma_f32_16x16x32_bf16 v[32:35], v[124:127], v[132:135], v[32:35]
    s_waitcnt lgkmcnt(0)
    s_barrier
    v_mfma_f32_16x16x32_bf16 v[16:19], v[40:43], v[80:83], v[16:19]
    ds_read_b128 v[128:131], v136 offset:57344
    ds_read_b128 v[88:91], v139 offset:20480
    v_mfma_f32_16x16x32_bf16 v[20:23], v[44:47], v[80:83], v[20:23]
    ds_read_b128 v[92:95], v139 offset:22528
    v_mfma_f32_16x16x32_bf16 v[24:27], v[48:51], v[80:83], v[24:27]
    ds_read_b128 v[96:99], v139 offset:24576
    ds_read_b128 v[100:103], v139 offset:26624
    v_mfma_f32_16x16x32_bf16 v[28:31], v[52:55], v[80:83], v[28:31]
    ds_read_b128 v[104:107], v139 offset:28672
    v_mfma_f32_16x16x32_bf16 v[32:35], v[56:59], v[80:83], v[32:35]
    ds_read_b128 v[132:135], v137 offset:57344
    ds_read_b128 v[108:111], v139 offset:21504
    v_mfma_f32_16x16x32_bf16 v[16:19], v[60:63], v[84:87], v[16:19]
    ds_read_b128 v[112:115], v139 offset:23552
    v_mfma_f32_16x16x32_bf16 v[20:23], v[64:67], v[84:87], v[20:23]
    ds_read_b128 v[116:119], v139 offset:25600
    ds_read_b128 v[120:123], v139 offset:27648
    v_mfma_f32_16x16x32_bf16 v[24:27], v[68:71], v[84:87], v[24:27]
    ds_read_b128 v[124:127], v139 offset:29696
    v_mfma_f32_16x16x32_bf16 v[28:31], v[72:75], v[84:87], v[28:31]
    v_mfma_f32_16x16x32_bf16 v[32:35], v[76:79], v[84:87], v[32:35]
    s_waitcnt lgkmcnt(0)
    s_barrier
    v_mfma_f32_16x16x32_bf16 v[16:19], v[88:91], v[128:131], v[16:19]
    ds_read_b128 v[80:83], v136 offset:0
    ds_read_b128 v[40:43], v138 offset:0
    v_mfma_f32_16x16x32_bf16 v[20:23], v[92:95], v[128:131], v[20:23]
    ds_read_b128 v[44:47], v138 offset:2048
    v_mfma_f32_16x16x32_bf16 v[24:27], v[96:99], v[128:131], v[24:27]
    ds_read_b128 v[48:51], v138 offset:4096
    ds_read_b128 v[52:55], v138 offset:6144
    v_mfma_f32_16x16x32_bf16 v[28:31], v[100:103], v[128:131], v[28:31]
    ds_read_b128 v[56:59], v138 offset:8192
    v_mfma_f32_16x16x32_bf16 v[32:35], v[104:107], v[128:131], v[32:35]
    ds_read_b128 v[84:87], v137 offset:0
    ds_read_b128 v[60:63], v138 offset:1024
    v_mfma_f32_16x16x32_bf16 v[16:19], v[108:111], v[132:135], v[16:19]
    ds_read_b128 v[64:67], v138 offset:3072
    v_mfma_f32_16x16x32_bf16 v[20:23], v[112:115], v[132:135], v[20:23]
    ds_read_b128 v[68:71], v138 offset:5120
    ds_read_b128 v[72:75], v138 offset:7168
    v_mfma_f32_16x16x32_bf16 v[24:27], v[116:119], v[132:135], v[24:27]
    ds_read_b128 v[76:79], v138 offset:9216
    v_mfma_f32_16x16x32_bf16 v[28:31], v[120:123], v[132:135], v[28:31]
    v_mfma_f32_16x16x32_bf16 v[32:35], v[124:127], v[132:135], v[32:35]
    s_sub_u32 s57, s57, 1
    s_cmp_lg_u32 s57, 0
    s_cbranch_scc1 ps_fs_160
    s_waitcnt lgkmcnt(0)
    s_barrier
    v_mfma_f32_16x16x32_bf16 v[16:19], v[40:43], v[80:83], v[16:19]
    ds_read_b128 v[128:131], v136 offset:8192
    ds_read_b128 v[88:91], v138 offset:10240
    v_mfma_f32_16x16x32_bf16 v[20:23], v[44:47], v[80:83], v[20:23]
    ds_read_b128 v[92:95], v138 offset:12288
    v_mfma_f32_16x16x32_bf16 v[24:27], v[48:51], v[80:83], v[24:27]
    ds_read_b128 v[96:99], v138 offset:14336
    ds_read_b128 v[100:103], v138 offset:16384
    v_mfma_f32_16x16x32_bf16 v[28:31], v[52:55], v[80:83], v[28:31]
    ds_read_b128 v[104:107], v138 offset:18432
    v_mfma_f32_16x16x32_bf16 v[32:35], v[56:59], v[80:83], v[32:35]
    ds_read_b128 v[132:135], v137 offset:8192
    ds_read_b128 v[108:111], v138 offset:11264
    v_mfma_f32_16x16x32_bf16 v[16:19], v[60:63], v[84:87], v[16:19]
    ds_read_b128 v[112:115], v138 offset:13312
    v_mfma_f32_16x16x32_bf16 v[20:23], v[64:67], v[84:87], v[20:23]
    ds_read_b128 v[116:119], v138 offset:15360
    ds_read_b128 v[120:123], v138 offset:17408
    v_mfma_f32_16x16x32_bf16 v[24:27], v[68:71], v[84:87], v[24:27]
    ds_read_b128 v[124:127], v138 offset:19456
    v_mfma_f32_16x16x32_bf16 v[28:31], v[72:75], v[84:87], v[28:31]
    v_mfma_f32_16x16x32_bf16 v[32:35], v[76:79], v[84:87], v[32:35]
    s_waitcnt lgkmcnt(0)
    s_barrier
    v_mfma_f32_16x16x32_bf16 v[16:19], v[88:91], v[128:131], v[16:19]
    ds_read_b128 v[80:83], v136 offset:16384
    ds_read_b128 v[40:43], v138 offset:20480
    v_mfma_f32_16x16x32_bf16 v[20:23], v[92:95], v[128:131], v[20:23]
    ds_read_b128 v[44:47], v138 offset:22528
    v_mfma_f32_16x16x32_bf16 v[24:27], v[96:99], v[128:131], v[24:27]
    ds_read_b128 v[48:51], v138 offset:24576
    ds_read_b128 v[52:55], v138 offset:26624
    v_mfma_f32_16x16x32_bf16 v[28:31], v[100:103], v[128:131], v[28:31]
    ds_read_b128 v[56:59], v138 offset:28672
    v_mfma_f32_16x16x32_bf16 v[32:35], v[104:107], v[128:131], v[32:35]
    ds_read_b128 v[84:87], v137 offset:16384
    ds_read_b128 v[60:63], v138 offset:21504
    v_mfma_f32_16x16x32_bf16 v[16:19], v[108:111], v[132:135], v[16:19]
    ds_read_b128 v[64:67], v138 offset:23552
    v_mfma_f32_16x16x32_bf16 v[20:23], v[112:115], v[132:135], v[20:23]
    ds_read_b128 v[68:71], v138 offset:25600
    ds_read_b128 v[72:75], v138 offset:27648
    v_mfma_f32_16x16x32_bf16 v[24:27], v[116:119], v[132:135], v[24:27]
    ds_read_b128 v[76:79], v138 offset:29696
    v_mfma_f32_16x16x32_bf16 v[28:31], v[120:123], v[132:135], v[28:31]
    v_mfma_f32_16x16x32_bf16 v[32:35], v[124:127], v[132:135], v[32:35]
    s_waitcnt lgkmcnt(0)
    s_barrier
    v_mfma_f32_16x16x32_bf16 v[16:19], v[40:43], v[80:83], v[16:19]
    v_mfma_f32_16x16x32_bf16 v[20:23], v[44:47], v[80:83], v[20:23]
    v_mfma_f32_16x16x32_bf16 v[24:27], v[48:51], v[80:83], v[24:27]
    v_mfma_f32_16x16x32_bf16 v[28:31], v[52:55], v[80:83], v[28:31]
    v_mfma_f32_16x16x32_bf16 v[32:35], v[56:59], v[80:83], v[32:35]
    v_mfma_f32_16x16x32_bf16 v[16:19], v[60:63], v[84:87], v[16:19]
    v_mfma_f32_16x16x32_bf16 v[20:23], v[64:67], v[84:87], v[20:23]
    v_mfma_f32_16x16x32_bf16 v[24:27], v[68:71], v[84:87], v[24:27]
    v_mfma_f32_16x16x32_bf16 v[28:31], v[72:75], v[84:87], v[28:31]
    v_mfma_f32_16x16x32_bf16 v[32:35], v[76:79], v[84:87], v[32:35]
    s_waitcnt vmcnt(0)
    v_lshlrev_b32 v40, 16, v140
    v_and_b32 v41, 0xffff0000, v140
    v_lshlrev_b32 v42, 16, v141
    v_and_b32 v43, 0xffff0000, v141
    v_lshlrev_b32 v44, 16, v142
    v_and_b32 v45, 0xffff0000, v142
    v_lshlrev_b32 v46, 16, v143
    v_and_b32 v47, 0xffff0000, v143
    v_lshlrev_b32 v48, 16, v144
    v_and_b32 v49, 0xffff0000, v144
    v_lshlrev_b32 v50, 16, v145
    v_and_b32 v51, 0xffff0000, v145
    v_lshlrev_b32 v52, 16, v146
    v_and_b32 v53, 0xffff0000, v146
    v_lshlrev_b32 v54, 16, v147
    v_and_b32 v55, 0xffff0000, v147
    v_lshlrev_b32 v56, 16, v148
    v_and_b32 v57, 0xffff0000, v148
    v_lshlrev_b32 v58, 16, v149
    v_and_b32 v59, 0xffff0000, v149
    v_pk_add_f32 v[40:41], v[40:41], v[16:17]
    v_pk_add_f32 v[42:43], v[42:43], v[18:19]
    v_pk_add_f32 v[44:45], v[44:45], v[20:21]
    v_pk_add_f32 v[46:47], v[46:47], v[22:23]
    v_pk_add_f32 v[48:49], v[48:49], v[24:25]
    v_pk_add_f32 v[50:51], v[50:51], v[26:27]
    v_pk_add_f32 v[52:53], v[52:53], v[28:29]
    v_pk_add_f32 v[54:55], v[54:55], v[30:31]
    v_pk_add_f32 v[56:57], v[56:57], v[32:33]
    v_pk_add_f32 v[58:59], v[58:59], v[34:35]
    v_cvt_pk_bf16_f32 v60, v40, v41
    v_cvt_pk_bf16_f32 v61, v42, v43
    v_cvt_pk_bf16_f32 v62, v44, v45
    v_cvt_pk_bf16_f32 v63, v46, v47
    v_cvt_pk_bf16_f32 v64, v48, v49
    v_cvt_pk_bf16_f32 v65, v50, v51
    v_cvt_pk_bf16_f32 v66, v52, v53
    v_cvt_pk_bf16_f32 v67, v54, v55
    v_cvt_pk_bf16_f32 v68, v56, v57
    v_cvt_pk_bf16_f32 v69, v58, v59
    s_cmp_eq_u32 s3, 0
    s_cbranch_scc1 ps_ost_164
    buffer_store_dwordx2 v[60:61], v150, s[36:39], 0 offen offset:0
    buffer_store_dwordx2 v[62:63], v150, s[36:39], 0 offen offset:32
    buffer_store_dwordx2 v[64:65], v150, s[36:39], 0 offen offset:64
    buffer_store_dwordx2 v[66:67], v150, s[36:39], 0 offen offset:96
    buffer_store_dwordx2 v[68:69], v150, s[36:39], 0 offen offset:128
    s_branch ps_resdone_163
ps_ost_164:
    s_cmp_eq_u32 s0, 0
    s_cbranch_scc1 ps_glob_165
    buffer_store_dwordx2 v[60:61], v151, s[36:39], 0 offen offset:0
    buffer_store_dwordx2 v[62:63], v151, s[36:39], 0 offen offset:512
    buffer_store_dwordx2 v[64:65], v151, s[36:39], 0 offen offset:1024
    buffer_store_dwordx2 v[66:67], v151, s[36:39], 0 offen offset:1536
    buffer_store_dwordx2 v[68:69], v151, s[36:39], 0 offen offset:2048
    s_branch ps_dual_166
ps_glob_165:
    buffer_store_dwordx2 v[60:61], v151, s[36:39], 0 offen offset:0 sc1
    buffer_store_dwordx2 v[62:63], v151, s[36:39], 0 offen offset:512 sc1
    buffer_store_dwordx2 v[64:65], v151, s[36:39], 0 offen offset:1024 sc1
    buffer_store_dwordx2 v[66:67], v151, s[36:39], 0 offen offset:1536 sc1
    buffer_store_dwordx2 v[68:69], v151, s[36:39], 0 offen offset:2048 sc1
ps_dual_166:
    v_lshlrev_b32 v40, 16, v60
    v_and_b32 v41, 0xffff0000, v60
    v_lshlrev_b32 v42, 16, v61
    v_and_b32 v43, 0xffff0000, v61
    v_lshlrev_b32 v44, 16, v62
    v_and_b32 v45, 0xffff0000, v62
    v_lshlrev_b32 v46, 16, v63
    v_and_b32 v47, 0xffff0000, v63
    v_lshlrev_b32 v48, 16, v64
    v_and_b32 v49, 0xffff0000, v64
    v_lshlrev_b32 v50, 16, v65
    v_and_b32 v51, 0xffff0000, v65
    v_lshlrev_b32 v52, 16, v66
    v_and_b32 v53, 0xffff0000, v66
    v_lshlrev_b32 v54, 16, v67
    v_and_b32 v55, 0xffff0000, v67
    v_lshlrev_b32 v56, 16, v68
    v_and_b32 v57, 0xffff0000, v68
    v_lshlrev_b32 v58, 16, v69
    v_and_b32 v59, 0xffff0000, v69
    v_pk_add_f32 v[78:79], v[40:41], v[42:43]
    v_pk_add_f32 v[80:81], v[44:45], v[46:47]
    v_pk_add_f32 v[78:79], v[78:79], v[80:81]
    v_pk_add_f32 v[80:81], v[48:49], v[50:51]
    v_pk_add_f32 v[78:79], v[78:79], v[80:81]
    v_pk_add_f32 v[80:81], v[52:53], v[54:55]
    v_pk_add_f32 v[78:79], v[78:79], v[80:81]
    v_pk_add_f32 v[80:81], v[56:57], v[58:59]
    v_pk_add_f32 v[78:79], v[78:79], v[80:81]
    v_add_f32 v72, v78, v79
    v_mov_b32 v76, v72
    s_nop 1
    v_permlane16_swap_b32 v76, v72
    v_add_f32 v72, v72, v76
    v_mov_b32 v76, v72
    s_nop 1
    v_permlane32_swap_b32 v76, v72
    v_add_f32 v72, v72, v76
    v_mul_f32 v74, 0xbc4ccccd, v72
    v_pk_add_f32 v[40:41], v[40:41], v[74:75] op_sel_hi:[1,0]
    v_pk_add_f32 v[42:43], v[42:43], v[74:75] op_sel_hi:[1,0]
    v_pk_add_f32 v[44:45], v[44:45], v[74:75] op_sel_hi:[1,0]
    v_pk_add_f32 v[46:47], v[46:47], v[74:75] op_sel_hi:[1,0]
    v_pk_add_f32 v[48:49], v[48:49], v[74:75] op_sel_hi:[1,0]
    v_pk_add_f32 v[50:51], v[50:51], v[74:75] op_sel_hi:[1,0]
    v_pk_add_f32 v[52:53], v[52:53], v[74:75] op_sel_hi:[1,0]
    v_pk_add_f32 v[54:55], v[54:55], v[74:75] op_sel_hi:[1,0]
    v_pk_add_f32 v[56:57], v[56:57], v[74:75] op_sel_hi:[1,0]
    v_pk_add_f32 v[58:59], v[58:59], v[74:75] op_sel_hi:[1,0]
    v_pk_mul_f32 v[78:79], v[40:41], v[40:41]
    v_pk_mul_f32 v[80:81], v[42:43], v[42:43]
    v_pk_fma_f32 v[78:79], v[44:45], v[44:45], v[78:79]
    v_pk_fma_f32 v[80:81], v[46:47], v[46:47], v[80:81]
    v_pk_fma_f32 v[78:79], v[48:49], v[48:49], v[78:79]
    v_pk_fma_f32 v[80:81], v[50:51], v[50:51], v[80:81]
    v_pk_fma_f32 v[78:79], v[52:53], v[52:53], v[78:79]
    v_pk_fma_f32 v[80:81], v[54:55], v[54:55], v[80:81]
    v_pk_fma_f32 v[78:79], v[56:57], v[56:57], v[78:79]
    v_pk_fma_f32 v[80:81], v[58:59], v[58:59], v[80:81]
    v_pk_add_f32 v[78:79], v[78:79], v[80:81]
    v_add_f32 v73, v78, v79
    v_mov_b32 v76, v73
    s_nop 1
    v_permlane16_swap_b32 v76, v73
    v_add_f32 v73, v73, v76
    v_mov_b32 v76, v73
    s_nop 1
    v_permlane32_swap_b32 v76, v73
    v_add_f32 v73, v73, v76
    s_mov_b64 exec, 0xffff
    s_cmp_eq_u32 s0, 0
    s_cbranch_scc1 ps_glob_167
    buffer_store_dwordx2 v[72:73], v152, s[44:47], 0 offen
    s_branch ps_dual_168
ps_glob_167:
    buffer_store_dwordx2 v[72:73], v152, s[44:47], 0 offen sc1
ps_dual_168:
    s_mov_b64 exec, -1
ps_resdone_163:
    v_mov_b32 v2, 159768
    ds_read_b64 v[2:3], v2
    s_add_u32 s48, s20, 51134464
    s_addc_u32 s49, s21, 0
    s_mov_b32 s50, 65536
    s_mov_b32 s51, 0x20000
    s_lshl_b32 s62, s23, 12
    s_lshl_b32 s63, s96, 7
    s_add_u32 s62, s62, s63
    s_add_u32 s62, s62, 32768
    v_mov_b32 v6, s62
    v_mov_b32 v7, 159744
    v_mov_b32 v8, 3
    s_mul_i32 s63, s3, 5
    s_add_u32 s63, s63, 5
    s_waitcnt lgkmcnt(0)
    v_add_u32 v2, s63, v2
    s_mov_b64 exec, 1
    s_waitcnt vmcnt(0)
    ds_inc_rtn_u32 v9, v7, v8
    s_waitcnt lgkmcnt(0)
    v_readfirstlane_b32 s61, v9
    s_nop 3
    s_cmp_lg_u32 s61, 3
    s_cbranch_scc1 ps_nosig_169
    s_cmp_eq_u32 s0, 0
    s_cbranch_scc1 ps_glob_170
    buffer_store_dwordx2 v[2:3], v6, s[48:51], 0 offen
    s_branch ps_dual_171
ps_glob_170:
    buffer_store_dwordx2 v[2:3], v6, s[48:51], 0 offen sc1
ps_dual_171:
ps_nosig_169:
    s_mov_b64 exec, -1
    s_branch ps_next_139
ps_rx0_135:
    s_and_b32 s62, s96, 3
    s_lshl_b32 s63, s23, 2
    s_add_u32 s62, s62, s63
    s_lshl_b32 s52, s62, 6
    s_lshr_b32 s61, s96, 2
    s_mul_i32 s53, s61, 80
    s_add_u32 s24, s20, 15728640
    s_addc_u32 s25, s21, 0
    s_mov_b32 s26, 2621440
    s_mov_b32 s27, 0x20000
    s_lshr_b32 s62, s52, 4
    s_mul_i32 s62, s62, 20480
    v_lshlrev_b32 v2, 4, v0
    v_add_u32 v2, s62, v2
    v_add_u32 v8, 0, v2
    v_add_u32 v10, 20480, v2
    s_mov_b32 s54, 0
    s_mov_b32 s55, 0
    s_mul_i32 s60, s3, 5
    s_add_u32 s60, s60, 2
    s_add_u32 s48, s20, 51134464
    s_addc_u32 s49, s21, 0
    s_mov_b32 s50, 65536
    s_mov_b32 s51, 0x20000
    v_mov_b32 v50, 159768
    ds_read_b64 v[50:51], v50
    s_lshl_b32 s62, s23, 12
    s_add_u32 s62, s62, 32768
    v_and_b32 v48, 31, v0
    v_lshlrev_b32 v48, 7, v48
    v_add_u32 v48, s62, v48
    s_mov_b32 s42, 0
    s_waitcnt lgkmcnt(0)
ps_gw_173:
    buffer_load_dwordx2 v[52:53], v48, s[48:51], 0 offen sc1
    s_waitcnt vmcnt(0)
    v_sub_u32 v49, v52, v50
    v_subrev_u32 v49, s60, v49
    s_sub_u32 s63, 16, s60
    v_cmp_eq_u32 s[40:41], v53, v51
    v_cmp_gt_u32 vcc, s63, v49
    s_nop 3
    s_and_b64 vcc, vcc, s[40:41]
    s_cmp_eq_u64 vcc, -1
    s_cbranch_scc1 ps_gok_174
ps_ga_175:
    s_sleep 1
    s_add_u32 s42, s42, 1
    s_cmp_lt_u32 s42, 0x20000
    s_cbranch_scc1 ps_gw_173
ps_gok_174:
    v_mov_b32 v48, 159748
    v_mov_b32 v49, s60
    ds_write_b32 v48, v49
ps_nodep_172:
    s_add_u32 m0, s55, 0
    s_nop 0
    buffer_load_dwordx4 v8, s[24:27], s54 offen sc1 lds
    buffer_load_dwordx4 v8, s[24:27], s54 offen offset:1024 sc1 lds
    s_add_u32 m0, s55, 2048
    s_nop 0
    buffer_load_dwordx4 v10, s[24:27], s54 offen sc1 lds
    buffer_load_dwordx4 v10, s[24:27], s54 offen offset:1024 sc1 lds
    s_add_u32 s54, s54, 2048
    s_add_u32 s55, s55, 8192
    s_cmp_eq_u32 s55, 49152
    s_cselect_b32 s55, 0, s55
    s_add_u32 m0, s55, 0
    s_nop 0
    buffer_load_dwordx4 v8, s[24:27], s54 offen sc1 lds
    buffer_load_dwordx4 v8, s[24:27], s54 offen offset:1024 sc1 lds
    s_add_u32 m0, s55, 2048
    s_nop 0
    buffer_load_dwordx4 v10, s[24:27], s54 offen sc1 lds
    buffer_load_dwordx4 v10, s[24:27], s54 offen offset:1024 sc1 lds
    s_add_u32 s54, s54, 2048
    s_add_u32 s55, s55, 8192
    s_cmp_eq_u32 s55, 49152
    s_cselect_b32 s55, 0, s55
    s_add_u32 m0, s55, 0
    s_nop 0
    buffer_load_dwordx4 v8, s[24:27], s54 offen sc1 lds
    buffer_load_dwordx4 v8, s[24:27], s54 offen offset:1024 sc1 lds
    s_add_u32 m0, s55, 2048
    s_nop 0
    buffer_load_dwordx4 v10, s[24:27], s54 offen sc1 lds
    buffer_load_dwordx4 v10, s[24:27], s54 offen offset:1024 sc1 lds
    s_add_u32 s54, s54, 2048
    s_add_u32 s55, s55, 8192
    s_cmp_eq_u32 s55, 49152
    s_cselect_b32 s55, 0, s55
    s_add_u32 m0, s55, 0
    s_nop 0
    buffer_load_dwordx4 v8, s[24:27], s54 offen sc1 lds
    buffer_load_dwordx4 v8, s[24:27], s54 offen offset:1024 sc1 lds
    s_add_u32 m0, s55, 2048
    s_nop 0
    buffer_load_dwordx4 v10, s[24:27], s54 offen sc1 lds
    buffer_load_dwordx4 v10, s[24:27], s54 offen offset:1024 sc1 lds
    s_add_u32 s54, s54, 2048
    s_add_u32 s55, s55, 8192
    s_cmp_eq_u32 s55, 49152
    s_cselect_b32 s55, 0, s55
    s_waitcnt vmcnt(12)
    s_barrier
    s_mov_b32 s57, 6
ps_ldl_176:
    s_add_u32 m0, s55, 0
    s_nop 0
    buffer_load_dwordx4 v8, s[24:27], s54 offen sc1 lds
    buffer_load_dwordx4 v8, s[24:27], s54 offen offset:1024 sc1 lds
    s_add_u32 m0, s55, 2048
    s_nop 0
    buffer_load_dwordx4 v10, s[24:27], s54 offen sc1 lds
    buffer_load_dwordx4 v10, s[24:27], s54 offen offset:1024 sc1 lds
    s_add_u32 s54, s54, 2048
    s_add_u32 s55, s55, 8192
    s_cmp_eq_u32 s55, 49152
    s_cselect_b32 s55, 0, s55
    s_waitcnt vmcnt(12)
    s_sub_u32 s57, s57, 1
    s_cmp_lg_u32 s57, 0
    s_barrier
    s_cbranch_scc1 ps_ldl_176
    s_waitcnt vmcnt(8)
    s_barrier
    s_waitcnt vmcnt(4)
    s_barrier
    s_waitcnt vmcnt(0)
    s_barrier
    s_barrier
    s_and_b32 s62, s96, 1
    s_lshl_b32 s63, s23, 1
    s_add_u32 s62, s62, s63
    s_lshl_b32 s52, s62, 7
    s_lshr_b32 s61, s96, 1
    s_mul_i32 s53, s61, 112
    s_min_u32 s53, s53, 1616
    s_add_u32 s24, s20, 20971520
    s_addc_u32 s25, s21, 0
    s_mov_b32 s26, 2621440
    s_mov_b32 s27, 0x20000
    s_lshr_b32 s62, s52, 4
    s_mul_i32 s62, s62, 20480
    v_lshlrev_b32 v2, 4, v0
    v_add_u32 v2, s62, v2
    v_add_u32 v8, 0, v2
    v_add_u32 v10, 20480, v2
    v_add_u32 v12, 40960, v2
    v_add_u32 v14, 61440, v2
    s_mov_b32 s54, 0
    s_mov_b32 s55, 0
    s_mul_i32 s60, s3, 5
    s_add_u32 s60, s60, 3
    s_and_b32 s43, s96, 1
    s_lshl_b32 s43, s43, 1
    s_mov_b32 s62, 0xcccccccc
    s_lshr_b32 s43, s62, s43
    s_add_u32 s48, s20, 51134464
    s_addc_u32 s49, s21, 0
    s_mov_b32 s50, 65536
    s_mov_b32 s51, 0x20000
    v_mov_b32 v50, 159768
    ds_read_b64 v[50:51], v50
    s_lshl_b32 s62, s23, 12
    s_add_u32 s62, s62, 32768
    v_and_b32 v48, 31, v0
    v_lshlrev_b32 v48, 7, v48
    v_add_u32 v48, s62, v48
    s_mov_b32 s42, 0
    s_waitcnt lgkmcnt(0)
ps_gw_178:
    buffer_load_dwordx2 v[52:53], v48, s[48:51], 0 offen sc1
    s_waitcnt vmcnt(0)
    v_sub_u32 v49, v52, v50
    v_subrev_u32 v49, s60, v49
    s_sub_u32 s63, 16, s60
    v_cmp_eq_u32 s[40:41], v53, v51
    v_cmp_gt_u32 vcc, s63, v49
    s_nop 3
    s_and_b64 vcc, vcc, s[40:41]
    s_or_b32 vcc_lo, vcc_lo, s43
    s_or_b32 vcc_hi, vcc_hi, s43
    s_cmp_eq_u64 vcc, -1
    s_cbranch_scc1 ps_gok_179
ps_ga_180:
    s_sleep 1
    s_add_u32 s42, s42, 1
    s_cmp_lt_u32 s42, 0x20000
    s_cbranch_scc1 ps_gw_178
ps_gok_179:
    v_mov_b32 v48, 159748
    v_mov_b32 v49, s60
    ds_write_b32 v48, v49
ps_nodep_177:
    s_add_u32 m0, s55, 0
    s_nop 0
    buffer_load_dwordx4 v8, s[24:27], s54 offen sc1 lds
    buffer_load_dwordx4 v8, s[24:27], s54 offen offset:1024 sc1 lds
    s_add_u32 m0, s55, 2048
    s_nop 0
    buffer_load_dwordx4 v10, s[24:27], s54 offen sc1 lds
    buffer_load_dwordx4 v10, s[24:27], s54 offen offset:1024 sc1 lds
    s_add_u32 m0, s55, 4096
    s_nop 0
    buffer_load_dwordx4 v12, s[24:27], s54 offen sc1 lds
    buffer_load_dwordx4 v12, s[24:27], s54 offen offset:1024 sc1 lds
    s_add_u32 m0, s55, 6144
    s_nop 0
    buffer_load_dwordx4 v14, s[24:27], s54 offen sc1 lds
    buffer_load_dwordx4 v14, s[24:27], s54 offen offset:1024 sc1 lds
    s_add_u32 s54, s54, 2048
    s_add_u32 s55, s55, 16384
    s_cmp_eq_u32 s55, 49152
    s_cselect_b32 s55, 0, s55
    s_add_u32 m0, s55, 0
    s_nop 0
    buffer_load_dwordx4 v8, s[24:27], s54 offen sc1 lds
    buffer_load_dwordx4 v8, s[24:27], s54 offen offset:1024 sc1 lds
    s_add_u32 m0, s55, 2048
    s_nop 0
    buffer_load_dwordx4 v10, s[24:27], s54 offen sc1 lds
    buffer_load_dwordx4 v10, s[24:27], s54 offen offset:1024 sc1 lds
    s_add_u32 m0, s55, 4096
    s_nop 0
    buffer_load_dwordx4 v12, s[24:27], s54 offen sc1 lds
    buffer_load_dwordx4 v12, s[24:27], s54 offen offset:1024 sc1 lds
    s_add_u32 m0, s55, 6144
    s_nop 0
    buffer_load_dwordx4 v14, s[24:27], s54 offen sc1 lds
    buffer_load_dwordx4 v14, s[24:27], s54 offen offset:1024 sc1 lds
    s_add_u32 s54, s54, 2048
    s_add_u32 s55, s55, 16384
    s_cmp_eq_u32 s55, 49152
    s_cselect_b32 s55, 0, s55
    s_waitcnt vmcnt(8)
    s_barrier
    s_mov_b32 s57, 8
ps_ldl_181:
    s_add_u32 m0, s55, 0
    s_nop 0
    buffer_load_dwordx4 v8, s[24:27], s54 offen sc1 lds
    buffer_load_dwordx4 v8, s[24:27], s54 offen offset:1024 sc1 lds
    s_add_u32 m0, s55, 2048
    s_nop 0
    buffer_load_dwordx4 v10, s[24:27], s54 offen sc1 lds
    buffer_load_dwordx4 v10, s[24:27], s54 offen offset:1024 sc1 lds
    s_add_u32 m0, s55, 4096
    s_nop 0
    buffer_load_dwordx4 v12, s[24:27], s54 offen sc1 lds
    buffer_load_dwordx4 v12, s[24:27], s54 offen offset:1024 sc1 lds
    s_add_u32 m0, s55, 6144
    s_nop 0
    buffer_load_dwordx4 v14, s[24:27], s54 offen sc1 lds
    buffer_load_dwordx4 v14, s[24:27], s54 offen offset:1024 sc1 lds
    s_add_u32 s54, s54, 2048
    s_add_u32 s55, s55, 16384
    s_cmp_eq_u32 s55, 49152
    s_cselect_b32 s55, 0, s55
    s_waitcnt vmcnt(8)
    s_sub_u32 s57, s57, 1
    s_cmp_lg_u32 s57, 0
    s_barrier
    s_cbranch_scc1 ps_ldl_181
    s_add_u32 s40, s20, 43253760
    s_addc_u32 s41, s21, 0
    s_mov_b32 s42, 131072
    s_mov_b32 s43, 0x20000
    s_add_u32 s62, s52, 0
    v_add_u32 v2, s62, v0
    v_lshlrev_b32 v2, 6, v2
    buffer_load_dwordx4 v[56:59], v2, s[40:43], 0 offen offset:0 sc1
    buffer_load_dwordx4 v[60:63], v2, s[40:43], 0 offen offset:16 sc1
    buffer_load_dwordx4 v[64:67], v2, s[40:43], 0 offen offset:32 sc1
    buffer_load_dwordx4 v[68:71], v2, s[40:43], 0 offen offset:48 sc1
    s_waitcnt vmcnt(4)
    s_barrier
    s_waitcnt vmcnt(0)
    v_add_f32 v73, v56, v58
    v_add_f32 v72, v57, v59
    v_add_f32 v73, v73, v60
    v_add_f32 v72, v72, v61
    v_add_f32 v73, v73, v62
    v_add_f32 v72, v72, v63
    v_add_f32 v73, v73, v64
    v_add_f32 v72, v72, v65
    v_add_f32 v73, v73, v66
    v_add_f32 v72, v72, v67
    v_add_f32 v73, v73, v68
    v_add_f32 v72, v72, v69
    v_add_f32 v73, v73, v70
    v_add_f32 v72, v72, v71
    v_mul_f32 v73, 0xbacccccd, v73
    v_mov_b32 v74, 0x3c4ccccd
    v_fma_f32 v56, v56, v74, v73
    v_fma_f32 v58, v58, v74, v73
    v_fma_f32 v60, v60, v74, v73
    v_fma_f32 v62, v62, v74, v73
    v_fma_f32 v64, v64, v74, v73
    v_fma_f32 v66, v66, v74, v73
    v_fma_f32 v68, v68, v74, v73
    v_fma_f32 v70, v70, v74, v73
    v_mul_f32 v75, v56, v56
    v_fmac_f32 v75, v58, v58
    v_fmac_f32 v75, v60, v60
    v_fmac_f32 v75, v62, v62
    v_fmac_f32 v75, v64, v64
    v_fmac_f32 v75, v66, v66
    v_fmac_f32 v75, v68, v68
    v_fmac_f32 v75, v70, v70
    v_mov_b32 v56, 0x42a00000
    v_fma_f32 v72, v75, v56, v72
    v_mov_b32 v56, 0x3727c5ac
    v_mov_b32 v57, 0x3acccccd
    v_fma_f32 v72, v72, v57, v56
    v_rcp_f32 v72, v72
    v_lshlrev_b32 v2, 3, v0
    v_add_u32 v2, 160000, v2
    ds_write_b64 v2, v[72:73]
    s_waitcnt lgkmcnt(0)
    s_barrier
    s_and_b32 s62, s96, 3
    s_lshl_b32 s63, s23, 2
    s_add_u32 s62, s62, s63
    s_lshl_b32 s52, s62, 6
    s_lshr_b32 s61, s96, 2
    s_mul_i32 s53, s61, 80
    s_add_u32 s24, s20, 28835840
    s_addc_u32 s25, s21, 0
    s_mov_b32 s26, 7077888
    s_mov_b32 s27, 0x20000
    s_lshr_b32 s62, s52, 4
    s_mul_i32 s62, s62, 55296
    v_lshlrev_b32 v2, 4, v0
    v_add_u32 v2, s62, v2
    v_add_u32 v8, 0, v2
    v_add_u32 v10, 55296, v2
    s_mov_b32 s54, 0
    s_mov_b32 s55, 0
    s_mul_i32 s60, s3, 5
    s_add_u32 s60, s60, 4
    s_lshr_b32 s43, s96, 1
    s_and_b32 s43, s43, 1
    s_mov_b32 s62, 0xaaaaaaaa
    s_lshr_b32 s43, s62, s43
    s_add_u32 s48, s20, 51134464
    s_addc_u32 s49, s21, 0
    s_mov_b32 s50, 65536
    s_mov_b32 s51, 0x20000
    v_mov_b32 v50, 159768
    ds_read_b64 v[50:51], v50
    s_lshl_b32 s62, s23, 12
    s_add_u32 s62, s62, 32768
    v_and_b32 v48, 31, v0
    v_lshlrev_b32 v48, 7, v48
    v_add_u32 v48, s62, v48
    s_mov_b32 s42, 0
    s_waitcnt lgkmcnt(0)
ps_gw_183:
    buffer_load_dwordx2 v[52:53], v48, s[48:51], 0 offen sc1
    s_waitcnt vmcnt(0)
    v_sub_u32 v49, v52, v50
    v_subrev_u32 v49, s60, v49
    s_sub_u32 s63, 16, s60
    v_cmp_eq_u32 s[40:41], v53, v51
    v_cmp_gt_u32 vcc, s63, v49
    s_nop 3
    s_and_b64 vcc, vcc, s[40:41]
    s_or_b32 vcc_lo, vcc_lo, s43
    s_or_b32 vcc_hi, vcc_hi, s43
    s_cmp_eq_u64 vcc, -1
    s_cbranch_scc1 ps_gok_184
ps_ga_185:
    s_sleep 1
    s_add_u32 s42, s42, 1
    s_cmp_lt_u32 s42, 0x20000
    s_cbranch_scc1 ps_gw_183
ps_gok_184:
    v_mov_b32 v48, 159748
    v_mov_b32 v49, s60
    ds_write_b32 v48, v49
ps_nodep_182:
    s_add_u32 m0, s55, 0
    s_nop 0
    buffer_load_dwordx4 v8, s[24:27], s54 offen sc1 lds
    buffer_load_dwordx4 v8, s[24:27], s54 offen offset:1024 sc1 lds
    s_add_u32 m0, s55, 2048
    s_nop 0
    buffer_load_dwordx4 v10, s[24:27], s54 offen sc1 lds
    buffer_load_dwordx4 v10, s[24:27], s54 offen offset:1024 sc1 lds
    s_add_u32 s54, s54, 2048
    s_add_u32 s55, s55, 8192
    s_cmp_eq_u32 s55, 65536
    s_cselect_b32 s55, 0, s55
    s_add_u32 m0, s55, 0
    s_nop 0
    buffer_load_dwordx4 v8, s[24:27], s54 offen sc1 lds
    buffer_load_dwordx4 v8, s[24:27], s54 offen offset:1024 sc1 lds
    s_add_u32 m0, s55, 2048
    s_nop 0
    buffer_load_dwordx4 v10, s[24:27], s54 offen sc1 lds
    buffer_load_dwordx4 v10, s[24:27], s54 offen offset:1024 sc1 lds
    s_add_u32 s54, s54, 2048
    s_add_u32 s55, s55, 8192
    s_cmp_eq_u32 s55, 65536
    s_cselect_b32 s55, 0, s55
    s_add_u32 m0, s55, 0
    s_nop 0
    buffer_load_dwordx4 v8, s[24:27], s54 offen sc1 lds
    buffer_load_dwordx4 v8, s[24:27], s54 offen offset:1024 sc1 lds
    s_add_u32 m0, s55, 2048
    s_nop 0
    buffer_load_dwordx4 v10, s[24:27], s54 offen sc1 lds
    buffer_load_dwordx4 v10, s[24:27], s54 offen offset:1024 sc1 lds
    s_add_u32 s54, s54, 2048
    s_add_u32 s55, s55, 8192
    s_cmp_eq_u32 s55, 65536
    s_cselect_b32 s55, 0, s55
    s_add_u32 m0, s55, 0
    s_nop 0
    buffer_load_dwordx4 v8, s[24:27], s54 offen sc1 lds
    buffer_load_dwordx4 v8, s[24:27], s54 offen offset:1024 sc1 lds
    s_add_u32 m0, s55, 2048
    s_nop 0
    buffer_load_dwordx4 v10, s[24:27], s54 offen sc1 lds
    buffer_load_dwordx4 v10, s[24:27], s54 offen offset:1024 sc1 lds
    s_add_u32 s54, s54, 2048
    s_add_u32 s55, s55, 8192
    s_cmp_eq_u32 s55, 65536
    s_cselect_b32 s55, 0, s55
    s_add_u32 m0, s55, 0
    s_nop 0
    buffer_load_dwordx4 v8, s[24:27], s54 offen sc1 lds
    buffer_load_dwordx4 v8, s[24:27], s54 offen offset:1024 sc1 lds
    s_add_u32 m0, s55, 2048
    s_nop 0
    buffer_load_dwordx4 v10, s[24:27], s54 offen sc1 lds
    buffer_load_dwordx4 v10, s[24:27], s54 offen offset:1024 sc1 lds
    s_add_u32 s54, s54, 2048
    s_add_u32 s55, s55, 8192
    s_cmp_eq_u32 s55, 65536
    s_cselect_b32 s55, 0, s55
    s_waitcnt vmcnt(16)
    s_barrier
    s_mov_b32 s57, 22
ps_ldl_186:
    s_add_u32 m0, s55, 0
    s_nop 0
    buffer_load_dwordx4 v8, s[24:27], s54 offen sc1 lds
    buffer_load_dwordx4 v8, s[24:27], s54 offen offset:1024 sc1 lds
    s_add_u32 m0, s55, 2048
    s_nop 0
    buffer_load_dwordx4 v10, s[24:27], s54 offen sc1 lds
    buffer_load_dwordx4 v10, s[24:27], s54 offen offset:1024 sc1 lds
    s_add_u32 s54, s54, 2048
    s_add_u32 s55, s55, 8192
    s_cmp_eq_u32 s55, 65536
    s_cselect_b32 s55, 0, s55
    s_waitcnt vmcnt(16)
    s_sub_u32 s57, s57, 1
    s_cmp_lg_u32 s57, 0
    s_barrier
    s_cbranch_scc1 ps_ldl_186
    s_waitcnt vmcnt(12)
    s_barrier
    s_waitcnt vmcnt(8)
    s_barrier
    s_waitcnt vmcnt(4)
    s_barrier
    s_waitcnt vmcnt(0)
    s_barrier
    s_barrier
    s_branch ps_next_139
ps_rx1_136:
    s_and_b32 s62, s96, 3
    s_lshl_b32 s63, s23, 2
    s_add_u32 s62, s62, s63
    s_lshl_b32 s52, s62, 6
    s_lshr_b32 s61, s96, 2
    s_mul_i32 s53, s61, 80
    s_add_u32 s24, s20, 15728640
    s_addc_u32 s25, s21, 0
    s_mov_b32 s26, 2621440
    s_mov_b32 s27, 0x20000
    s_lshr_b32 s62, s52, 4
    s_mul_i32 s62, s62, 20480
    v_lshlrev_b32 v2, 4, v0
    v_add_u32 v2, s62, v2
    v_add_u32 v8, 40960, v2
    v_add_u32 v10, 61440, v2
    s_mov_b32 s54, 0
    s_mov_b32 s55, 0
    s_mul_i32 s63, s3, 5
    s_add_u32 s63, s63, 2
    v_mov_b32 v48, 159748
    s_mov_b32 s64, 0
ps_lw_188:
    ds_read_b32 v49, v48
    s_add_u32 s64, s64, 1
    s_waitcnt lgkmcnt(0)
    v_cmp_gt_u32 vcc, s63, v49
    s_cbranch_vccz ps_lok_189
    s_sleep 1
    s_cmp_lt_u32 s64, 0x200000
    s_cbranch_scc1 ps_lw_188
ps_lok_189:
ps_nodep_187:
    s_add_u32 m0, s55, 4096
    s_nop 0
    buffer_load_dwordx4 v8, s[24:27], s54 offen sc1 lds
    buffer_load_dwordx4 v8, s[24:27], s54 offen offset:1024 sc1 lds
    s_add_u32 m0, s55, 6144
    s_nop 0
    buffer_load_dwordx4 v10, s[24:27], s54 offen sc1 lds
    buffer_load_dwordx4 v10, s[24:27], s54 offen offset:1024 sc1 lds
    s_add_u32 s54, s54, 2048
    s_add_u32 s55, s55, 8192
    s_cmp_eq_u32 s55, 49152
    s_cselect_b32 s55, 0, s55
    s_add_u32 m0, s55, 4096
    s_nop 0
    buffer_load_dwordx4 v8, s[24:27], s54 offen sc1 lds
    buffer_load_dwordx4 v8, s[24:27], s54 offen offset:1024 sc1 lds
    s_add_u32 m0, s55, 6144
    s_nop 0
    buffer_load_dwordx4 v10, s[24:27], s54 offen sc1 lds
    buffer_load_dwordx4 v10, s[24:27], s54 offen offset:1024 sc1 lds
    s_add_u32 s54, s54, 2048
    s_add_u32 s55, s55, 8192
    s_cmp_eq_u32 s55, 49152
    s_cselect_b32 s55, 0, s55
    s_add_u32 m0, s55, 4096
    s_nop 0
    buffer_load_dwordx4 v8, s[24:27], s54 offen sc1 lds
    buffer_load_dwordx4 v8, s[24:27], s54 offen offset:1024 sc1 lds
    s_add_u32 m0, s55, 6144
    s_nop 0
    buffer_load_dwordx4 v10, s[24:27], s54 offen sc1 lds
    buffer_load_dwordx4 v10, s[24:27], s54 offen offset:1024 sc1 lds
    s_add_u32 s54, s54, 2048
    s_add_u32 s55, s55, 8192
    s_cmp_eq_u32 s55, 49152
    s_cselect_b32 s55, 0, s55
    s_add_u32 m0, s55, 4096
    s_nop 0
    buffer_load_dwordx4 v8, s[24:27], s54 offen sc1 lds
    buffer_load_dwordx4 v8, s[24:27], s54 offen offset:1024 sc1 lds
    s_add_u32 m0, s55, 6144
    s_nop 0
    buffer_load_dwordx4 v10, s[24:27], s54 offen sc1 lds
    buffer_load_dwordx4 v10, s[24:27], s54 offen offset:1024 sc1 lds
    s_add_u32 s54, s54, 2048
    s_add_u32 s55, s55, 8192
    s_cmp_eq_u32 s55, 49152
    s_cselect_b32 s55, 0, s55
    s_waitcnt vmcnt(12)
    s_barrier
    s_mov_b32 s57, 6
ps_ldl_190:
    s_add_u32 m0, s55, 4096
    s_nop 0
    buffer_load_dwordx4 v8, s[24:27], s54 offen sc1 lds
    buffer_load_dwordx4 v8, s[24:27], s54 offen offset:1024 sc1 lds
    s_add_u32 m0, s55, 6144
    s_nop 0
    buffer_load_dwordx4 v10, s[24:27], s54 offen sc1 lds
    buffer_load_dwordx4 v10, s[24:27], s54 offen offset:1024 sc1 lds
    s_add_u32 s54, s54, 2048
    s_add_u32 s55, s55, 8192
    s_cmp_eq_u32 s55, 49152
    s_cselect_b32 s55, 0, s55
    s_waitcnt vmcnt(12)
    s_sub_u32 s57, s57, 1
    s_cmp_lg_u32 s57, 0
    s_barrier
    s_cbranch_scc1 ps_ldl_190
    s_waitcnt vmcnt(8)
    s_barrier
    s_waitcnt vmcnt(4)
    s_barrier
    s_waitcnt vmcnt(0)
    s_barrier
    s_barrier
    s_and_b32 s62, s96, 1
    s_lshl_b32 s63, s23, 1
    s_add_u32 s62, s62, s63
    s_lshl_b32 s52, s62, 7
    s_lshr_b32 s61, s96, 1
    s_mul_i32 s53, s61, 112
    s_min_u32 s53, s53, 1616
    s_add_u32 s24, s20, 20971520
    s_addc_u32 s25, s21, 0
    s_mov_b32 s26, 2621440
    s_mov_b32 s27, 0x20000
    s_lshr_b32 s62, s52, 4
    s_mul_i32 s62, s62, 20480
    v_lshlrev_b32 v2, 4, v0
    v_add_u32 v2, s62, v2
    v_add_u32 v8, 81920, v2
    v_add_u32 v10, 102400, v2
    v_add_u32 v12, 122880, v2
    v_add_u32 v14, 143360, v2
    s_mov_b32 s54, 0
    s_mov_b32 s55, 0
    s_mul_i32 s63, s3, 5
    s_add_u32 s63, s63, 3
    v_mov_b32 v48, 159748
    s_mov_b32 s64, 0
ps_lw_192:
    ds_read_b32 v49, v48
    s_add_u32 s64, s64, 1
    s_waitcnt lgkmcnt(0)
    v_cmp_gt_u32 vcc, s63, v49
    s_cbranch_vccz ps_lok_193
    s_sleep 1
    s_cmp_lt_u32 s64, 0x200000
    s_cbranch_scc1 ps_lw_192
ps_lok_193:
ps_nodep_191:
    s_add_u32 m0, s55, 8192
    s_nop 0
    buffer_load_dwordx4 v8, s[24:27], s54 offen sc1 lds
    buffer_load_dwordx4 v8, s[24:27], s54 offen offset:1024 sc1 lds
    s_add_u32 m0, s55, 10240
    s_nop 0
    buffer_load_dwordx4 v10, s[24:27], s54 offen sc1 lds
    buffer_load_dwordx4 v10, s[24:27], s54 offen offset:1024 sc1 lds
    s_add_u32 m0, s55, 12288
    s_nop 0
    buffer_load_dwordx4 v12, s[24:27], s54 offen sc1 lds
    buffer_load_dwordx4 v12, s[24:27], s54 offen offset:1024 sc1 lds
    s_add_u32 m0, s55, 14336
    s_nop 0
    buffer_load_dwordx4 v14, s[24:27], s54 offen sc1 lds
    buffer_load_dwordx4 v14, s[24:27], s54 offen offset:1024 sc1 lds
    s_add_u32 s54, s54, 2048
    s_add_u32 s55, s55, 16384
    s_cmp_eq_u32 s55, 49152
    s_cselect_b32 s55, 0, s55
    s_add_u32 m0, s55, 8192
    s_nop 0
    buffer_load_dwordx4 v8, s[24:27], s54 offen sc1 lds
    buffer_load_dwordx4 v8, s[24:27], s54 offen offset:1024 sc1 lds
    s_add_u32 m0, s55, 10240
    s_nop 0
    buffer_load_dwordx4 v10, s[24:27], s54 offen sc1 lds
    buffer_load_dwordx4 v10, s[24:27], s54 offen offset:1024 sc1 lds
    s_add_u32 m0, s55, 12288
    s_nop 0
    buffer_load_dwordx4 v12, s[24:27], s54 offen sc1 lds
    buffer_load_dwordx4 v12, s[24:27], s54 offen offset:1024 sc1 lds
    s_add_u32 m0, s55, 14336
    s_nop 0
    buffer_load_dwordx4 v14, s[24:27], s54 offen sc1 lds
    buffer_load_dwordx4 v14, s[24:27], s54 offen offset:1024 sc1 lds
    s_add_u32 s54, s54, 2048
    s_add_u32 s55, s55, 16384
    s_cmp_eq_u32 s55, 49152
    s_cselect_b32 s55, 0, s55
    s_waitcnt vmcnt(8)
    s_barrier
    s_mov_b32 s57, 8
ps_ldl_194:
    s_add_u32 m0, s55, 8192
    s_nop 0
    buffer_load_dwordx4 v8, s[24:27], s54 offen sc1 lds
    buffer_load_dwordx4 v8, s[24:27], s54 offen offset:1024 sc1 lds
    s_add_u32 m0, s55, 10240
    s_nop 0
    buffer_load_dwordx4 v10, s[24:27], s54 offen sc1 lds
    buffer_load_dwordx4 v10, s[24:27], s54 offen offset:1024 sc1 lds
    s_add_u32 m0, s55, 12288
    s_nop 0
    buffer_load_dwordx4 v12, s[24:27], s54 offen sc1 lds
    buffer_load_dwordx4 v12, s[24:27], s54 offen offset:1024 sc1 lds
    s_add_u32 m0, s55, 14336
    s_nop 0
    buffer_load_dwordx4 v14, s[24:27], s54 offen sc1 lds
    buffer_load_dwordx4 v14, s[24:27], s54 offen offset:1024 sc1 lds
    s_add_u32 s54, s54, 2048
    s_add_u32 s55, s55, 16384
    s_cmp_eq_u32 s55, 49152
    s_cselect_b32 s55, 0, s55
    s_waitcnt vmcnt(8)
    s_sub_u32 s57, s57, 1
    s_cmp_lg_u32 s57, 0
    s_barrier
    s_cbranch_scc1 ps_ldl_194
    s_add_u32 s40, s20, 43253760
    s_addc_u32 s41, s21, 0
    s_mov_b32 s42, 131072
    s_mov_b32 s43, 0x20000
    s_add_u32 s62, s52, 64
    v_add_u32 v2, s62, v0
    v_lshlrev_b32 v2, 6, v2
    buffer_load_dwordx4 v[56:59], v2, s[40:43], 0 offen offset:0 sc1
    buffer_load_dwordx4 v[60:63], v2, s[40:43], 0 offen offset:16 sc1
    buffer_load_dwordx4 v[64:67], v2, s[40:43], 0 offen offset:32 sc1
    buffer_load_dwordx4 v[68:71], v2, s[40:43], 0 offen offset:48 sc1
    s_waitcnt vmcnt(4)
    s_barrier
    s_waitcnt vmcnt(0)
    v_add_f32 v73, v56, v58
    v_add_f32 v72, v57, v59
    v_add_f32 v73, v73, v60
    v_add_f32 v72, v72, v61
    v_add_f32 v73, v73, v62
    v_add_f32 v72, v72, v63
    v_add_f32 v73, v73, v64
    v_add_f32 v72, v72, v65
    v_add_f32 v73, v73, v66
    v_add_f32 v72, v72, v67
    v_add_f32 v73, v73, v68
    v_add_f32 v72, v72, v69
    v_add_f32 v73, v73, v70
    v_add_f32 v72, v72, v71
    v_mul_f32 v73, 0xbacccccd, v73
    v_mov_b32 v74, 0x3c4ccccd
    v_fma_f32 v56, v56, v74, v73
    v_fma_f32 v58, v58, v74, v73
    v_fma_f32 v60, v60, v74, v73
    v_fma_f32 v62, v62, v74, v73
    v_fma_f32 v64, v64, v74, v73
    v_fma_f32 v66, v66, v74, v73
    v_fma_f32 v68, v68, v74, v73
    v_fma_f32 v70, v70, v74, v73
    v_mul_f32 v75, v56, v56
    v_fmac_f32 v75, v58, v58
    v_fmac_f32 v75, v60, v60
    v_fmac_f32 v75, v62, v62
    v_fmac_f32 v75, v64, v64
    v_fmac_f32 v75, v66, v66
    v_fmac_f32 v75, v68, v68
    v_fmac_f32 v75, v70, v70
    v_mov_b32 v56, 0x42a00000
    v_fma_f32 v72, v75, v56, v72
    v_mov_b32 v56, 0x3727c5ac
    v_mov_b32 v57, 0x3acccccd
    v_fma_f32 v72, v72, v57, v56
    v_rcp_f32 v72, v72
    v_lshlrev_b32 v2, 3, v0
    v_add_u32 v2, 160512, v2
    ds_write_b64 v2, v[72:73]
    s_waitcnt lgkmcnt(0)
    s_barrier
    s_and_b32 s62, s96, 3
    s_lshl_b32 s63, s23, 2
    s_add_u32 s62, s62, s63
    s_lshl_b32 s52, s62, 6
    s_lshr_b32 s61, s96, 2
    s_mul_i32 s53, s61, 80
    s_add_u32 s24, s20, 28835840
    s_addc_u32 s25, s21, 0
    s_mov_b32 s26, 7077888
    s_mov_b32 s27, 0x20000
    s_lshr_b32 s62, s52, 4
    s_mul_i32 s62, s62, 55296
    v_lshlrev_b32 v2, 4, v0
    v_add_u32 v2, s62, v2
    v_add_u32 v8, 110592, v2
    v_add_u32 v10, 165888, v2
    s_mov_b32 s54, 0
    s_mov_b32 s55, 0
    s_mul_i32 s63, s3, 5
    s_add_u32 s63, s63, 4
    v_mov_b32 v48, 159748
    s_mov_b32 s64, 0
ps_lw_196:
    ds_read_b32 v49, v48
    s_add_u32 s64, s64, 1
    s_waitcnt lgkmcnt(0)
    v_cmp_gt_u32 vcc, s63, v49
    s_cbranch_vccz ps_lok_197
    s_sleep 1
    s_cmp_lt_u32 s64, 0x200000
    s_cbranch_scc1 ps_lw_196
ps_lok_197:
ps_nodep_195:
    s_add_u32 m0, s55, 4096
    s_nop 0
    buffer_load_dwordx4 v8, s[24:27], s54 offen sc1 lds
    buffer_load_dwordx4 v8, s[24:27], s54 offen offset:1024 sc1 lds
    s_add_u32 m0, s55, 6144
    s_nop 0
    buffer_load_dwordx4 v10, s[24:27], s54 offen sc1 lds
    buffer_load_dwordx4 v10, s[24:27], s54 offen offset:1024 sc1 lds
    s_add_u32 s54, s54, 2048
    s_add_u32 s55, s55, 8192
    s_cmp_eq_u32 s55, 65536
    s_cselect_b32 s55, 0, s55
    s_add_u32 m0, s55, 4096
    s_nop 0
    buffer_load_dwordx4 v8, s[24:27], s54 offen sc1 lds
    buffer_load_dwordx4 v8, s[24:27], s54 offen offset:1024 sc1 lds
    s_add_u32 m0, s55, 6144
    s_nop 0
    buffer_load_dwordx4 v10, s[24:27], s54 offen sc1 lds
    buffer_load_dwordx4 v10, s[24:27], s54 offen offset:1024 sc1 lds
    s_add_u32 s54, s54, 2048
    s_add_u32 s55, s55, 8192
    s_cmp_eq_u32 s55, 65536
    s_cselect_b32 s55, 0, s55
    s_add_u32 m0, s55, 4096
    s_nop 0
    buffer_load_dwordx4 v8, s[24:27], s54 offen sc1 lds
    buffer_load_dwordx4 v8, s[24:27], s54 offen offset:1024 sc1 lds
    s_add_u32 m0, s55, 6144
    s_nop 0
    buffer_load_dwordx4 v10, s[24:27], s54 offen sc1 lds
    buffer_load_dwordx4 v10, s[24:27], s54 offen offset:1024 sc1 lds
    s_add_u32 s54, s54, 2048
    s_add_u32 s55, s55, 8192
    s_cmp_eq_u32 s55, 65536
    s_cselect_b32 s55, 0, s55
    s_add_u32 m0, s55, 4096
    s_nop 0
    buffer_load_dwordx4 v8, s[24:27], s54 offen sc1 lds
    buffer_load_dwordx4 v8, s[24:27], s54 offen offset:1024 sc1 lds
    s_add_u32 m0, s55, 6144
    s_nop 0
    buffer_load_dwordx4 v10, s[24:27], s54 offen sc1 lds
    buffer_load_dwordx4 v10, s[24:27], s54 offen offset:1024 sc1 lds
    s_add_u32 s54, s54, 2048
    s_add_u32 s55, s55, 8192
    s_cmp_eq_u32 s55, 65536
    s_cselect_b32 s55, 0, s55
    s_add_u32 m0, s55, 4096
    s_nop 0
    buffer_load_dwordx4 v8, s[24:27], s54 offen sc1 lds
    buffer_load_dwordx4 v8, s[24:27], s54 offen offset:1024 sc1 lds
    s_add_u32 m0, s55, 6144
    s_nop 0
    buffer_load_dwordx4 v10, s[24:27], s54 offen sc1 lds
    buffer_load_dwordx4 v10, s[24:27], s54 offen offset:1024 sc1 lds
    s_add_u32 s54, s54, 2048
    s_add_u32 s55, s55, 8192
    s_cmp_eq_u32 s55, 65536
    s_cselect_b32 s55, 0, s55
    s_waitcnt vmcnt(16)
    s_barrier
    s_mov_b32 s57, 22
ps_ldl_198:
    s_add_u32 m0, s55, 4096
    s_nop 0
    buffer_load_dwordx4 v8, s[24:27], s54 offen sc1 lds
    buffer_load_dwordx4 v8, s[24:27], s54 offen offset:1024 sc1 lds
    s_add_u32 m0, s55, 6144
    s_nop 0
    buffer_load_dwordx4 v10, s[24:27], s54 offen sc1 lds
    buffer_load_dwordx4 v10, s[24:27], s54 offen offset:1024 sc1 lds
    s_add_u32 s54, s54, 2048
    s_add_u32 s55, s55, 8192
    s_cmp_eq_u32 s55, 65536
    s_cselect_b32 s55, 0, s55
    s_waitcnt vmcnt(16)
    s_sub_u32 s57, s57, 1
    s_cmp_lg_u32 s57, 0
    s_barrier
    s_cbranch_scc1 ps_ldl_198
    s_waitcnt vmcnt(12)
    s_barrier
    s_waitcnt vmcnt(8)
    s_barrier
    s_waitcnt vmcnt(4)
    s_barrier
    s_waitcnt vmcnt(0)
    s_barrier
    s_barrier
    s_branch ps_next_139
ps_rw0_137:
    s_and_b32 s62, s96, 3
    s_lshl_b32 s63, s23, 2
    s_add_u32 s62, s62, s63
    s_lshl_b32 s52, s62, 6
    s_lshr_b32 s61, s96, 2
    s_mul_i32 s53, s61, 80
    s_add_u32 s28, s20, 43540480
    s_addc_u32 s29, s21, 0
    s_mov_b32 s30, 819200
    s_mov_b32 s31, 0x20000
    s_lshr_b32 s62, s53, 4
    s_mul_i32 s62, s62, 20480
    v_lshlrev_b32 v2, 4, v0
    v_add_u32 v2, s62, v2
    v_add_u32 v8, 0, v2
    v_add_u32 v9, 20480, v2
    v_add_u32 v10, 40960, v2
    s_cmp_lg_u32 s3, 0
    s_cbranch_scc1 ps_wrdy_199
    s_mov_b32 s60, 3
    s_add_u32 s48, s20, 51134464
    s_addc_u32 s49, s21, 0
    s_mov_b32 s50, 65536
    s_mov_b32 s51, 0x20000
    v_mov_b32 v50, 159768
    ds_read_b64 v[50:51], v50
    v_lshlrev_b32 v48, 7, v0
    s_mov_b32 s42, 0
    s_waitcnt lgkmcnt(0)
ps_gw_200:
    buffer_load_dwordx2 v[52:53], v48, s[48:51], 0 offen sc1
    s_mov_b32 s63, 8192
    buffer_load_dwordx2 v[54:55], v48, s[48:51], s63 offen sc1
    s_mov_b32 s63, 16384
    buffer_load_dwordx2 v[56:57], v48, s[48:51], s63 offen sc1
    s_mov_b32 s63, 24576
    buffer_load_dwordx2 v[58:59], v48, s[48:51], s63 offen sc1
    s_waitcnt vmcnt(0)
    v_sub_u32 v49, v52, v50
    v_subrev_u32 v49, s60, v49
    s_sub_u32 s63, 16, s60
    v_cmp_eq_u32 s[40:41], v53, v51
    v_cmp_gt_u32 vcc, s63, v49
    s_nop 3
    s_and_b64 vcc, vcc, s[40:41]
    s_cmp_eq_u64 vcc, -1
    s_cbranch_scc0 ps_ga_202
    v_sub_u32 v49, v54, v50
    v_subrev_u32 v49, s60, v49
    s_sub_u32 s63, 16, s60
    v_cmp_eq_u32 s[40:41], v55, v51
    v_cmp_gt_u32 vcc, s63, v49
    s_nop 3
    s_and_b64 vcc, vcc, s[40:41]
    s_cmp_eq_u64 vcc, -1
    s_cbranch_scc0 ps_ga_202
    v_sub_u32 v49, v56, v50
    v_subrev_u32 v49, s60, v49
    s_sub_u32 s63, 16, s60
    v_cmp_eq_u32 s[40:41], v57, v51
    v_cmp_gt_u32 vcc, s63, v49
    s_nop 3
    s_and_b64 vcc, vcc, s[40:41]
    s_cmp_eq_u64 vcc, -1
    s_cbranch_scc0 ps_ga_202
    v_sub_u32 v49, v58, v50
    v_subrev_u32 v49, s60, v49
    s_sub_u32 s63, 16, s60
    v_cmp_eq_u32 s[40:41], v59, v51
    v_cmp_gt_u32 vcc, s63, v49
    s_nop 3
    s_and_b64 vcc, vcc, s[40:41]
    s_cmp_eq_u64 vcc, -1
    s_cbranch_scc1 ps_gok_201
ps_ga_202:
    s_sleep 1
    s_add_u32 s42, s42, 1
    s_cmp_lt_u32 s42, 0x20000
    s_cbranch_scc1 ps_gw_200
ps_gok_201:
    v_mov_b32 v48, 159756
    v_mov_b32 v49, 2
    ds_write_b32 v48, v49
ps_wrdy_199:
    s_cmp_eq_u32 s3, 0
    s_cbranch_scc1 ps_gpf0_203
    s_add_u32 s28, s20, 46571520
    s_addc_u32 s29, s21, 0
    s_mov_b32 s30, 4423680
    s_mov_b32 s31, 0x20000
    v_lshlrev_b32 v2, 7, v0
    s_barrier
    s_mul_i32 s62, s96, 7
    s_add_u32 s62, s62, 0
    s_min_u32 s62, s62, 215
    s_mul_i32 s62, s62, 20480
    s_mov_b32 exec_lo, 0xffffffff
    s_mov_b32 exec_hi, 0x0
    buffer_load_dword v253, v2, s[28:31], s62 offen
    s_mov_b64 exec, -1
    s_barrier
    s_barrier
    s_mul_i32 s62, s96, 7
    s_add_u32 s62, s62, 2
    s_min_u32 s62, s62, 215
    s_mul_i32 s62, s62, 20480
    s_mov_b32 exec_lo, 0xffffffff
    s_mov_b32 exec_hi, 0x0
    buffer_load_dword v253, v2, s[28:31], s62 offen
    s_mov_b64 exec, -1
    s_barrier
    s_barrier
    s_mul_i32 s62, s96, 7
    s_add_u32 s62, s62, 4
    s_min_u32 s62, s62, 215
    s_mul_i32 s62, s62, 20480
    s_mov_b32 exec_lo, 0xffffffff
    s_mov_b32 exec_hi, 0x0
    buffer_load_dword v253, v2, s[28:31], s62 offen
    s_mov_b64 exec, -1
    s_barrier
    s_barrier
    s_mul_i32 s62, s96, 7
    s_add_u32 s62, s62, 6
    s_min_u32 s62, s62, 215
    s_mul_i32 s62, s62, 20480
    s_mov_b32 exec_lo, 0xffffffff
    s_mov_b32 exec_hi, 0x0
    buffer_load_dword v253, v2, s[28:31], s62 offen
    s_mov_b64 exec, -1
    s_barrier
    s_barrier
    s_barrier
    s_barrier
    s_branch ps_gpf1_204
ps_gpf0_203:
    s_barrier
    s_barrier
    s_barrier
    s_barrier
    s_barrier
    s_barrier
    s_barrier
    s_barrier
    s_barrier
    s_barrier
    s_barrier
ps_gpf1_204:
    s_and_b32 s62, s96, 1
    s_lshl_b32 s63, s23, 1
    s_add_u32 s62, s62, s63
    s_lshl_b32 s52, s62, 7
    s_lshr_b32 s61, s96, 1
    s_mul_i32 s53, s61, 112
    s_min_u32 s53, s53, 1616
    s_add_u32 s28, s20, 46571520
    s_addc_u32 s29, s21, 0
    s_mov_b32 s30, 2211840
    s_mov_b32 s31, 0x20000
    s_add_u32 s32, s20, 48783360
    s_addc_u32 s33, s21, 0
    s_mov_b32 s34, 2211840
    s_mov_b32 s35, 0x20000
    s_lshr_b32 s62, s53, 4
    s_mul_i32 s62, s62, 20480
    v_lshlrev_b32 v2, 4, v0
    v_add_u32 v2, s62, v2
    v_add_u32 v8, 0, v2
    v_add_u32 v9, 20480, v2
    v_add_u32 v10, 40960, v2
    v_add_u32 v11, 61440, v2
    v_add_u32 v12, 81920, v2
    v_add_u32 v13, 102400, v2
    v_add_u32 v14, 122880, v2
    s_mov_b32 s54, 0
    s_mov_b32 s55, 49152
    s_add_u32 m0, s55, 0
    s_nop 0
    buffer_load_dwordx4 v8, s[28:31], s54 offen sc1 lds
    buffer_load_dwordx4 v8, s[28:31], s54 offen offset:1024 sc1 lds
    s_add_u32 m0, s55, 2048
    s_nop 0
    buffer_load_dwordx4 v9, s[28:31], s54 offen sc1 lds
    buffer_load_dwordx4 v9, s[28:31], s54 offen offset:1024 sc1 lds
    s_add_u32 m0, s55, 4096
    s_nop 0
    buffer_load_dwordx4 v10, s[28:31], s54 offen sc1 lds
    buffer_load_dwordx4 v10, s[28:31], s54 offen offset:1024 sc1 lds
    s_add_u32 m0, s55, 6144
    s_nop 0
    buffer_load_dwordx4 v11, s[28:31], s54 offen sc1 lds
    buffer_load_dwordx4 v11, s[28:31], s54 offen offset:1024 sc1 lds
    s_add_u32 m0, s55, 8192
    s_nop 0
    buffer_load_dwordx4 v12, s[28:31], s54 offen sc1 lds
    buffer_load_dwordx4 v12, s[28:31], s54 offen offset:1024 sc1 lds
    s_add_u32 m0, s55, 10240
    s_nop 0
    buffer_load_dwordx4 v13, s[28:31], s54 offen sc1 lds
    buffer_load_dwordx4 v13, s[28:31], s54 offen offset:1024 sc1 lds
    s_add_u32 m0, s55, 12288
    s_nop 0
    buffer_load_dwordx4 v14, s[28:31], s54 offen sc1 lds
    buffer_load_dwordx4 v14, s[28:31], s54 offen offset:1024 sc1 lds
    s_add_u32 s54, s54, 2048
    s_add_u32 s55, s55, 28672
    s_cmp_eq_u32 s55, 135168
    s_cselect_b32 s55, 49152, s55
    s_add_u32 m0, s55, 0
    s_nop 0
    buffer_load_dwordx4 v8, s[28:31], s54 offen sc1 lds
    buffer_load_dwordx4 v8, s[28:31], s54 offen offset:1024 sc1 lds
    s_add_u32 m0, s55, 2048
    s_nop 0
    buffer_load_dwordx4 v9, s[28:31], s54 offen sc1 lds
    buffer_load_dwordx4 v9, s[28:31], s54 offen offset:1024 sc1 lds
    s_add_u32 m0, s55, 4096
    s_nop 0
    buffer_load_dwordx4 v10, s[28:31], s54 offen sc1 lds
    buffer_load_dwordx4 v10, s[28:31], s54 offen offset:1024 sc1 lds
    s_add_u32 m0, s55, 6144
    s_nop 0
    buffer_load_dwordx4 v11, s[28:31], s54 offen sc1 lds
    buffer_load_dwordx4 v11, s[28:31], s54 offen offset:1024 sc1 lds
    s_add_u32 m0, s55, 8192
    s_nop 0
    buffer_load_dwordx4 v12, s[28:31], s54 offen sc1 lds
    buffer_load_dwordx4 v12, s[28:31], s54 offen offset:1024 sc1 lds
    s_add_u32 m0, s55, 10240
    s_nop 0
    buffer_load_dwordx4 v13, s[28:31], s54 offen sc1 lds
    buffer_load_dwordx4 v13, s[28:31], s54 offen offset:1024 sc1 lds
    s_add_u32 m0, s55, 12288
    s_nop 0
    buffer_load_dwordx4 v14, s[28:31], s54 offen sc1 lds
    buffer_load_dwordx4 v14, s[28:31], s54 offen offset:1024 sc1 lds
    s_add_u32 s54, s54, 2048
    s_add_u32 s55, s55, 28672
    s_cmp_eq_u32 s55, 135168
    s_cselect_b32 s55, 49152, s55
    s_waitcnt vmcnt(14)
    s_barrier
    s_mov_b32 s57, 8
ps_ldl_205:
    s_add_u32 m0, s55, 0
    s_nop 0
    buffer_load_dwordx4 v8, s[28:31], s54 offen sc1 lds
    buffer_load_dwordx4 v8, s[28:31], s54 offen offset:1024 sc1 lds
    s_add_u32 m0, s55, 2048
    s_nop 0
    buffer_load_dwordx4 v9, s[28:31], s54 offen sc1 lds
    buffer_load_dwordx4 v9, s[28:31], s54 offen offset:1024 sc1 lds
    s_add_u32 m0, s55, 4096
    s_nop 0
    buffer_load_dwordx4 v10, s[28:31], s54 offen sc1 lds
    buffer_load_dwordx4 v10, s[28:31], s54 offen offset:1024 sc1 lds
    s_add_u32 m0, s55, 6144
    s_nop 0
    buffer_load_dwordx4 v11, s[28:31], s54 offen sc1 lds
    buffer_load_dwordx4 v11, s[28:31], s54 offen offset:1024 sc1 lds
    s_add_u32 m0, s55, 8192
    s_nop 0
    buffer_load_dwordx4 v12, s[28:31], s54 offen sc1 lds
    buffer_load_dwordx4 v12, s[28:31], s54 offen offset:1024 sc1 lds
    s_add_u32 m0, s55, 10240
    s_nop 0
    buffer_load_dwordx4 v13, s[28:31], s54 offen sc1 lds
    buffer_load_dwordx4 v13, s[28:31], s54 offen offset:1024 sc1 lds
    s_add_u32 m0, s55, 12288
    s_nop 0
    buffer_load_dwordx4 v14, s[28:31], s54 offen sc1 lds
    buffer_load_dwordx4 v14, s[28:31], s54 offen offset:1024 sc1 lds
    s_add_u32 s54, s54, 2048
    s_add_u32 s55, s55, 28672
    s_cmp_eq_u32 s55, 135168
    s_cselect_b32 s55, 49152, s55
    s_waitcnt vmcnt(14)
    s_sub_u32 s57, s57, 1
    s_cmp_lg_u32 s57, 0
    s_barrier
    s_cbranch_scc1 ps_ldl_205
    s_add_u32 s44, s20, 50995200
    s_addc_u32 s45, s21, 0
    s_mov_b32 s46, 138240
    s_mov_b32 s47, 0x20000
    s_add_u32 s62, s53, 0
    v_add_u32 v2, s62, v0
    v_lshlrev_b32 v2, 2, v2
    s_mov_b32 s62, 0
    buffer_load_dword v56, v2, s[44:47], s62 offen sc1
    buffer_load_dword v57, v2, s[44:47], s62 offen offset:256 sc1
    s_add_u32 s62, s62, 13824
    buffer_load_dword v58, v2, s[44:47], s62 offen sc1
    buffer_load_dword v59, v2, s[44:47], s62 offen offset:256 sc1
    s_add_u32 s62, s62, 13824
    buffer_load_dword v60, v2, s[44:47], s62 offen sc1
    buffer_load_dword v61, v2, s[44:47], s62 offen offset:256 sc1
    s_add_u32 s62, s62, 13824
    buffer_load_dword v62, v2, s[44:47], s62 offen sc1
    buffer_load_dword v63, v2, s[44:47], s62 offen offset:256 sc1
    s_add_u32 s62, s62, 13824
    buffer_load_dword v64, v2, s[44:47], s62 offen sc1
    buffer_load_dword v65, v2, s[44:47], s62 offen offset:256 sc1
    s_add_u32 s62, s62, 13824
    buffer_load_dword v66, v2, s[44:47], s62 offen sc1
    buffer_load_dword v67, v2, s[44:47], s62 offen offset:256 sc1
    s_add_u32 s62, s62, 13824
    buffer_load_dword v68, v2, s[44:47], s62 offen sc1
    buffer_load_dword v69, v2, s[44:47], s62 offen offset:256 sc1
    s_add_u32 s62, s62, 13824
    buffer_load_dword v70, v2, s[44:47], s62 offen sc1
    buffer_load_dword v71, v2, s[44:47], s62 offen offset:256 sc1
    s_add_u32 s62, s62, 13824
    buffer_load_dword v72, v2, s[44:47], s62 offen sc1
    buffer_load_dword v73, v2, s[44:47], s62 offen offset:256 sc1
    s_add_u32 s62, s62, 13824
    buffer_load_dword v74, v2, s[44:47], s62 offen sc1
    buffer_load_dword v75, v2, s[44:47], s62 offen offset:256 sc1
    s_add_u32 s62, s62, 13824
    s_waitcnt vmcnt(20)
    s_barrier
    s_waitcnt vmcnt(0)
    v_pk_add_f32 v[56:57], v[56:57], v[58:59]
    v_pk_add_f32 v[56:57], v[56:57], v[60:61]
    v_pk_add_f32 v[56:57], v[56:57], v[62:63]
    v_pk_add_f32 v[56:57], v[56:57], v[64:65]
    v_pk_add_f32 v[56:57], v[56:57], v[66:67]
    v_pk_add_f32 v[56:57], v[56:57], v[68:69]
    v_pk_add_f32 v[56:57], v[56:57], v[70:71]
    v_pk_add_f32 v[56:57], v[56:57], v[72:73]
    v_pk_add_f32 v[56:57], v[56:57], v[74:75]
    v_lshlrev_b32 v2, 2, v0
    v_add_u32 v2, 161024, v2
    ds_write_b32 v2, v56
    ds_write_b32 v2, v57 offset:256
    s_waitcnt lgkmcnt(0)
    s_barrier
    s_and_b32 s62, s96, 3
    s_lshl_b32 s63, s23, 2
    s_add_u32 s62, s62, s63
    s_lshl_b32 s52, s62, 6
    s_lshr_b32 s61, s96, 2
    s_mul_i32 s53, s61, 80
    s_add_u32 s28, s20, 44359680
    s_addc_u32 s29, s21, 0
    s_mov_b32 s30, 2211840
    s_mov_b32 s31, 0x20000
    s_lshr_b32 s62, s53, 4
    s_mul_i32 s62, s62, 55296
    v_lshlrev_b32 v2, 4, v0
    v_add_u32 v2, s62, v2
    v_add_u32 v8, 0, v2
    v_add_u32 v9, 55296, v2
    v_add_u32 v10, 110592, v2
    s_mov_b32 s54, 0
    s_mov_b32 s55, 65536
    s_add_u32 m0, s55, 0
    s_nop 0
    buffer_load_dwordx4 v8, s[28:31], s54 offen sc1 lds
    buffer_load_dwordx4 v8, s[28:31], s54 offen offset:1024 sc1 lds
    s_add_u32 m0, s55, 2048
    s_nop 0
    buffer_load_dwordx4 v9, s[28:31], s54 offen sc1 lds
    buffer_load_dwordx4 v9, s[28:31], s54 offen offset:1024 sc1 lds
    s_add_u32 m0, s55, 4096
    s_nop 0
    buffer_load_dwordx4 v10, s[28:31], s54 offen sc1 lds
    s_add_u32 s54, s54, 2048
    s_add_u32 s55, s55, 10240
    s_cmp_eq_u32 s55, 147456
    s_cselect_b32 s55, 65536, s55
    s_add_u32 m0, s55, 0
    s_nop 0
    buffer_load_dwordx4 v8, s[28:31], s54 offen sc1 lds
    buffer_load_dwordx4 v8, s[28:31], s54 offen offset:1024 sc1 lds
    s_add_u32 m0, s55, 2048
    s_nop 0
    buffer_load_dwordx4 v9, s[28:31], s54 offen sc1 lds
    buffer_load_dwordx4 v9, s[28:31], s54 offen offset:1024 sc1 lds
    s_add_u32 m0, s55, 4096
    s_nop 0
    buffer_load_dwordx4 v10, s[28:31], s54 offen sc1 lds
    s_add_u32 s54, s54, 2048
    s_add_u32 s55, s55, 10240
    s_cmp_eq_u32 s55, 147456
    s_cselect_b32 s55, 65536, s55
    s_add_u32 m0, s55, 0
    s_nop 0
    buffer_load_dwordx4 v8, s[28:31], s54 offen sc1 lds
    buffer_load_dwordx4 v8, s[28:31], s54 offen offset:1024 sc1 lds
    s_add_u32 m0, s55, 2048
    s_nop 0
    buffer_load_dwordx4 v9, s[28:31], s54 offen sc1 lds
    buffer_load_dwordx4 v9, s[28:31], s54 offen offset:1024 sc1 lds
    s_add_u32 m0, s55, 4096
    s_nop 0
    buffer_load_dwordx4 v10, s[28:31], s54 offen sc1 lds
    s_add_u32 s54, s54, 2048
    s_add_u32 s55, s55, 10240
    s_cmp_eq_u32 s55, 147456
    s_cselect_b32 s55, 65536, s55
    s_add_u32 m0, s55, 0
    s_nop 0
    buffer_load_dwordx4 v8, s[28:31], s54 offen sc1 lds
    buffer_load_dwordx4 v8, s[28:31], s54 offen offset:1024 sc1 lds
    s_add_u32 m0, s55, 2048
    s_nop 0
    buffer_load_dwordx4 v9, s[28:31], s54 offen sc1 lds
    buffer_load_dwordx4 v9, s[28:31], s54 offen offset:1024 sc1 lds
    s_add_u32 m0, s55, 4096
    s_nop 0
    buffer_load_dwordx4 v10, s[28:31], s54 offen sc1 lds
    s_add_u32 s54, s54, 2048
    s_add_u32 s55, s55, 10240
    s_cmp_eq_u32 s55, 147456
    s_cselect_b32 s55, 65536, s55
    s_add_u32 m0, s55, 0
    s_nop 0
    buffer_load_dwordx4 v8, s[28:31], s54 offen sc1 lds
    buffer_load_dwordx4 v8, s[28:31], s54 offen offset:1024 sc1 lds
    s_add_u32 m0, s55, 2048
    s_nop 0
    buffer_load_dwordx4 v9, s[28:31], s54 offen sc1 lds
    buffer_load_dwordx4 v9, s[28:31], s54 offen offset:1024 sc1 lds
    s_add_u32 m0, s55, 4096
    s_nop 0
    buffer_load_dwordx4 v10, s[28:31], s54 offen sc1 lds
    s_add_u32 s54, s54, 2048
    s_add_u32 s55, s55, 10240
    s_cmp_eq_u32 s55, 147456
    s_cselect_b32 s55, 65536, s55
    s_add_u32 m0, s55, 0
    s_nop 0
    buffer_load_dwordx4 v8, s[28:31], s54 offen sc1 lds
    buffer_load_dwordx4 v8, s[28:31], s54 offen offset:1024 sc1 lds
    s_add_u32 m0, s55, 2048
    s_nop 0
    buffer_load_dwordx4 v9, s[28:31], s54 offen sc1 lds
    buffer_load_dwordx4 v9, s[28:31], s54 offen offset:1024 sc1 lds
    s_add_u32 m0, s55, 4096
    s_nop 0
    buffer_load_dwordx4 v10, s[28:31], s54 offen sc1 lds
    s_add_u32 s54, s54, 2048
    s_add_u32 s55, s55, 10240
    s_cmp_eq_u32 s55, 147456
    s_cselect_b32 s55, 65536, s55
    s_add_u32 m0, s55, 0
    s_nop 0
    buffer_load_dwordx4 v8, s[28:31], s54 offen sc1 lds
    buffer_load_dwordx4 v8, s[28:31], s54 offen offset:1024 sc1 lds
    s_add_u32 m0, s55, 2048
    s_nop 0
    buffer_load_dwordx4 v9, s[28:31], s54 offen sc1 lds
    buffer_load_dwordx4 v9, s[28:31], s54 offen offset:1024 sc1 lds
    s_add_u32 m0, s55, 4096
    s_nop 0
    buffer_load_dwordx4 v10, s[28:31], s54 offen sc1 lds
    s_add_u32 s54, s54, 2048
    s_add_u32 s55, s55, 10240
    s_cmp_eq_u32 s55, 147456
    s_cselect_b32 s55, 65536, s55
    s_waitcnt vmcnt(30)
    s_barrier
    s_mov_b32 s57, 20
ps_ldl_206:
    s_add_u32 m0, s55, 0
    s_nop 0
    buffer_load_dwordx4 v8, s[28:31], s54 offen sc1 lds
    buffer_load_dwordx4 v8, s[28:31], s54 offen offset:1024 sc1 lds
    s_add_u32 m0, s55, 2048
    s_nop 0
    buffer_load_dwordx4 v9, s[28:31], s54 offen sc1 lds
    buffer_load_dwordx4 v9, s[28:31], s54 offen offset:1024 sc1 lds
    s_add_u32 m0, s55, 4096
    s_nop 0
    buffer_load_dwordx4 v10, s[28:31], s54 offen sc1 lds
    s_add_u32 s54, s54, 2048
    s_add_u32 s55, s55, 10240
    s_cmp_eq_u32 s55, 147456
    s_cselect_b32 s55, 65536, s55
    s_waitcnt vmcnt(30)
    s_sub_u32 s57, s57, 1
    s_cmp_lg_u32 s57, 0
    s_barrier
    s_cbranch_scc1 ps_ldl_206
    s_waitcnt vmcnt(25)
    s_barrier
    s_waitcnt vmcnt(20)
    s_barrier
    s_waitcnt vmcnt(15)
    s_barrier
    s_waitcnt vmcnt(10)
    s_barrier
    s_waitcnt vmcnt(5)
    s_barrier
    s_waitcnt vmcnt(0)
    s_barrier
    s_barrier
    s_branch ps_next_139
ps_rw1_138:
    s_and_b32 s62, s96, 3
    s_lshl_b32 s63, s23, 2
    s_add_u32 s62, s62, s63
    s_lshl_b32 s52, s62, 6
    s_lshr_b32 s61, s96, 2
    s_mul_i32 s53, s61, 80
    s_add_u32 s28, s20, 43540480
    s_addc_u32 s29, s21, 0
    s_mov_b32 s30, 819200
    s_mov_b32 s31, 0x20000
    s_lshr_b32 s62, s53, 4
    s_mul_i32 s62, s62, 20480
    v_lshlrev_b32 v2, 4, v0
    v_add_u32 v2, s62, v2
    v_add_u32 v8, 40960, v2
    v_add_u32 v9, 61440, v2
    v_add_u32 v10, 81920, v2
    s_cmp_lg_u32 s3, 0
    s_cbranch_scc1 ps_wrdy_207
    v_mov_b32 v48, 159756
    s_mov_b32 s64, 0
ps_lw_208:
    ds_read_b32 v49, v48
    s_add_u32 s64, s64, 1
    s_waitcnt lgkmcnt(0)
    v_cmp_gt_u32 vcc, 2, v49
    s_cbranch_vccz ps_lok_209
    s_sleep 1
    s_cmp_lt_u32 s64, 0x200000
    s_cbranch_scc1 ps_lw_208
ps_lok_209:
ps_wrdy_207:
    s_cmp_eq_u32 s3, 0
    s_cbranch_scc1 ps_gpf0_210
    s_add_u32 s28, s20, 46571520
    s_addc_u32 s29, s21, 0
    s_mov_b32 s30, 4423680
    s_mov_b32 s31, 0x20000
    v_lshlrev_b32 v2, 7, v0
    s_barrier
    s_barrier
    s_mul_i32 s62, s96, 7
    s_add_u32 s62, s62, 1
    s_min_u32 s62, s62, 215
    s_mul_i32 s62, s62, 20480
    s_mov_b32 exec_lo, 0xffffffff
    s_mov_b32 exec_hi, 0x0
    buffer_load_dword v253, v2, s[28:31], s62 offen
    s_mov_b64 exec, -1
    s_barrier
    s_barrier
    s_mul_i32 s62, s96, 7
    s_add_u32 s62, s62, 3
    s_min_u32 s62, s62, 215
    s_mul_i32 s62, s62, 20480
    s_mov_b32 exec_lo, 0xffffffff
    s_mov_b32 exec_hi, 0x0
    buffer_load_dword v253, v2, s[28:31], s62 offen
    s_mov_b64 exec, -1
    s_barrier
    s_barrier
    s_mul_i32 s62, s96, 7
    s_add_u32 s62, s62, 5
    s_min_u32 s62, s62, 215
    s_mul_i32 s62, s62, 20480
    s_mov_b32 exec_lo, 0xffffffff
    s_mov_b32 exec_hi, 0x0
    buffer_load_dword v253, v2, s[28:31], s62 offen
    s_mov_b64 exec, -1
    s_barrier
    s_barrier
    s_barrier
    s_barrier
    s_barrier
    s_branch ps_gpf1_211
ps_gpf0_210:
    s_barrier
    s_barrier
    s_barrier
    s_barrier
    s_barrier
    s_barrier
    s_barrier
    s_barrier
    s_barrier
    s_barrier
    s_barrier
ps_gpf1_211:
    s_and_b32 s62, s96, 1
    s_lshl_b32 s63, s23, 1
    s_add_u32 s62, s62, s63
    s_lshl_b32 s52, s62, 7
    s_lshr_b32 s61, s96, 1
    s_mul_i32 s53, s61, 112
    s_min_u32 s53, s53, 1616
    s_add_u32 s28, s20, 46571520
    s_addc_u32 s29, s21, 0
    s_mov_b32 s30, 2211840
    s_mov_b32 s31, 0x20000
    s_add_u32 s32, s20, 48783360
    s_addc_u32 s33, s21, 0
    s_mov_b32 s34, 2211840
    s_mov_b32 s35, 0x20000
    s_lshr_b32 s62, s53, 4
    s_mul_i32 s62, s62, 20480
    v_lshlrev_b32 v2, 4, v0
    v_add_u32 v2, s62, v2
    v_add_u32 v8, 0, v2
    v_add_u32 v9, 20480, v2
    v_add_u32 v10, 40960, v2
    v_add_u32 v11, 61440, v2
    v_add_u32 v12, 81920, v2
    v_add_u32 v13, 102400, v2
    v_add_u32 v14, 122880, v2
    s_mov_b32 s54, 0
    s_mov_b32 s55, 49152
    s_add_u32 m0, s55, 14336
    s_nop 0
    buffer_load_dwordx4 v8, s[32:35], s54 offen sc1 lds
    buffer_load_dwordx4 v8, s[32:35], s54 offen offset:1024 sc1 lds
    s_add_u32 m0, s55, 16384
    s_nop 0
    buffer_load_dwordx4 v9, s[32:35], s54 offen sc1 lds
    buffer_load_dwordx4 v9, s[32:35], s54 offen offset:1024 sc1 lds
    s_add_u32 m0, s55, 18432
    s_nop 0
    buffer_load_dwordx4 v10, s[32:35], s54 offen sc1 lds
    buffer_load_dwordx4 v10, s[32:35], s54 offen offset:1024 sc1 lds
    s_add_u32 m0, s55, 20480
    s_nop 0
    buffer_load_dwordx4 v11, s[32:35], s54 offen sc1 lds
    buffer_load_dwordx4 v11, s[32:35], s54 offen offset:1024 sc1 lds
    s_add_u32 m0, s55, 22528
    s_nop 0
    buffer_load_dwordx4 v12, s[32:35], s54 offen sc1 lds
    buffer_load_dwordx4 v12, s[32:35], s54 offen offset:1024 sc1 lds
    s_add_u32 m0, s55, 24576
    s_nop 0
    buffer_load_dwordx4 v13, s[32:35], s54 offen sc1 lds
    buffer_load_dwordx4 v13, s[32:35], s54 offen offset:1024 sc1 lds
    s_add_u32 m0, s55, 26624
    s_nop 0
    buffer_load_dwordx4 v14, s[32:35], s54 offen sc1 lds
    buffer_load_dwordx4 v14, s[32:35], s54 offen offset:1024 sc1 lds
    s_add_u32 s54, s54, 2048
    s_add_u32 s55, s55, 28672
    s_cmp_eq_u32 s55, 135168
    s_cselect_b32 s55, 49152, s55
    s_add_u32 m0, s55, 14336
    s_nop 0
    buffer_load_dwordx4 v8, s[32:35], s54 offen sc1 lds
    buffer_load_dwordx4 v8, s[32:35], s54 offen offset:1024 sc1 lds
    s_add_u32 m0, s55, 16384
    s_nop 0
    buffer_load_dwordx4 v9, s[32:35], s54 offen sc1 lds
    buffer_load_dwordx4 v9, s[32:35], s54 offen offset:1024 sc1 lds
    s_add_u32 m0, s55, 18432
    s_nop 0
    buffer_load_dwordx4 v10, s[32:35], s54 offen sc1 lds
    buffer_load_dwordx4 v10, s[32:35], s54 offen offset:1024 sc1 lds
    s_add_u32 m0, s55, 20480
    s_nop 0
    buffer_load_dwordx4 v11, s[32:35], s54 offen sc1 lds
    buffer_load_dwordx4 v11, s[32:35], s54 offen offset:1024 sc1 lds
    s_add_u32 m0, s55, 22528
    s_nop 0
    buffer_load_dwordx4 v12, s[32:35], s54 offen sc1 lds
    buffer_load_dwordx4 v12, s[32:35], s54 offen offset:1024 sc1 lds
    s_add_u32 m0, s55, 24576
    s_nop 0
    buffer_load_dwordx4 v13, s[32:35], s54 offen sc1 lds
    buffer_load_dwordx4 v13, s[32:35], s54 offen offset:1024 sc1 lds
    s_add_u32 m0, s55, 26624
    s_nop 0
    buffer_load_dwordx4 v14, s[32:35], s54 offen sc1 lds
    buffer_load_dwordx4 v14, s[32:35], s54 offen offset:1024 sc1 lds
    s_add_u32 s54, s54, 2048
    s_add_u32 s55, s55, 28672
    s_cmp_eq_u32 s55, 135168
    s_cselect_b32 s55, 49152, s55
    s_waitcnt vmcnt(14)
    s_barrier
    s_mov_b32 s57, 8
ps_ldl_212:
    s_add_u32 m0, s55, 14336
    s_nop 0
    buffer_load_dwordx4 v8, s[32:35], s54 offen sc1 lds
    buffer_load_dwordx4 v8, s[32:35], s54 offen offset:1024 sc1 lds
    s_add_u32 m0, s55, 16384
    s_nop 0
    buffer_load_dwordx4 v9, s[32:35], s54 offen sc1 lds
    buffer_load_dwordx4 v9, s[32:35], s54 offen offset:1024 sc1 lds
    s_add_u32 m0, s55, 18432
    s_nop 0
    buffer_load_dwordx4 v10, s[32:35], s54 offen sc1 lds
    buffer_load_dwordx4 v10, s[32:35], s54 offen offset:1024 sc1 lds
    s_add_u32 m0, s55, 20480
    s_nop 0
    buffer_load_dwordx4 v11, s[32:35], s54 offen sc1 lds
    buffer_load_dwordx4 v11, s[32:35], s54 offen offset:1024 sc1 lds
    s_add_u32 m0, s55, 22528
    s_nop 0
    buffer_load_dwordx4 v12, s[32:35], s54 offen sc1 lds
    buffer_load_dwordx4 v12, s[32:35], s54 offen offset:1024 sc1 lds
    s_add_u32 m0, s55, 24576
    s_nop 0
    buffer_load_dwordx4 v13, s[32:35], s54 offen sc1 lds
    buffer_load_dwordx4 v13, s[32:35], s54 offen offset:1024 sc1 lds
    s_add_u32 m0, s55, 26624
    s_nop 0
    buffer_load_dwordx4 v14, s[32:35], s54 offen sc1 lds
    buffer_load_dwordx4 v14, s[32:35], s54 offen offset:1024 sc1 lds
    s_add_u32 s54, s54, 2048
    s_add_u32 s55, s55, 28672
    s_cmp_eq_u32 s55, 135168
    s_cselect_b32 s55, 49152, s55
    s_waitcnt vmcnt(14)
    s_sub_u32 s57, s57, 1
    s_cmp_lg_u32 s57, 0
    s_barrier
    s_cbranch_scc1 ps_ldl_212
    s_add_u32 s44, s20, 50995200
    s_addc_u32 s45, s21, 0
    s_mov_b32 s46, 138240
    s_mov_b32 s47, 0x20000
    s_add_u32 s62, s53, 1728
    v_add_u32 v2, s62, v0
    v_lshlrev_b32 v2, 2, v2
    s_mov_b32 s62, 0
    buffer_load_dword v56, v2, s[44:47], s62 offen sc1
    buffer_load_dword v57, v2, s[44:47], s62 offen offset:256 sc1
    s_add_u32 s62, s62, 13824
    buffer_load_dword v58, v2, s[44:47], s62 offen sc1
    buffer_load_dword v59, v2, s[44:47], s62 offen offset:256 sc1
    s_add_u32 s62, s62, 13824
    buffer_load_dword v60, v2, s[44:47], s62 offen sc1
    buffer_load_dword v61, v2, s[44:47], s62 offen offset:256 sc1
    s_add_u32 s62, s62, 13824
    buffer_load_dword v62, v2, s[44:47], s62 offen sc1
    buffer_load_dword v63, v2, s[44:47], s62 offen offset:256 sc1
    s_add_u32 s62, s62, 13824
    buffer_load_dword v64, v2, s[44:47], s62 offen sc1
    buffer_load_dword v65, v2, s[44:47], s62 offen offset:256 sc1
    s_add_u32 s62, s62, 13824
    buffer_load_dword v66, v2, s[44:47], s62 offen sc1
    buffer_load_dword v67, v2, s[44:47], s62 offen offset:256 sc1
    s_add_u32 s62, s62, 13824
    buffer_load_dword v68, v2, s[44:47], s62 offen sc1
    buffer_load_dword v69, v2, s[44:47], s62 offen offset:256 sc1
    s_add_u32 s62, s62, 13824
    buffer_load_dword v70, v2, s[44:47], s62 offen sc1
    buffer_load_dword v71, v2, s[44:47], s62 offen offset:256 sc1
    s_add_u32 s62, s62, 13824
    buffer_load_dword v72, v2, s[44:47], s62 offen sc1
    buffer_load_dword v73, v2, s[44:47], s62 offen offset:256 sc1
    s_add_u32 s62, s62, 13824
    buffer_load_dword v74, v2, s[44:47], s62 offen sc1
    buffer_load_dword v75, v2, s[44:47], s62 offen offset:256 sc1
    s_add_u32 s62, s62, 13824
    s_waitcnt vmcnt(20)
    s_barrier
    s_waitcnt vmcnt(0)
    v_pk_add_f32 v[56:57], v[56:57], v[58:59]
    v_pk_add_f32 v[56:57], v[56:57], v[60:61]
    v_pk_add_f32 v[56:57], v[56:57], v[62:63]
    v_pk_add_f32 v[56:57], v[56:57], v[64:65]
    v_pk_add_f32 v[56:57], v[56:57], v[66:67]
    v_pk_add_f32 v[56:57], v[56:57], v[68:69]
    v_pk_add_f32 v[56:57], v[56:57], v[70:71]
    v_pk_add_f32 v[56:57], v[56:57], v[72:73]
    v_pk_add_f32 v[56:57], v[56:57], v[74:75]
    v_lshlrev_b32 v2, 2, v0
    v_add_u32 v2, 161536, v2
    ds_write_b32 v2, v56
    ds_write_b32 v2, v57 offset:256
    s_waitcnt lgkmcnt(0)
    s_barrier
    s_and_b32 s62, s96, 3
    s_lshl_b32 s63, s23, 2
    s_add_u32 s62, s62, s63
    s_lshl_b32 s52, s62, 6
    s_lshr_b32 s61, s96, 2
    s_mul_i32 s53, s61, 80
    s_add_u32 s28, s20, 44359680
    s_addc_u32 s29, s21, 0
    s_mov_b32 s30, 2211840
    s_mov_b32 s31, 0x20000
    s_lshr_b32 s62, s53, 4
    s_mul_i32 s62, s62, 55296
    v_lshlrev_b32 v2, 4, v0
    v_add_u32 v2, s62, v2
    v_add_u32 v8, 110592, v2
    v_add_u32 v9, 165888, v2
    v_add_u32 v10, 221184, v2
    s_mov_b32 s54, 0
    s_mov_b32 s55, 65536
    s_add_u32 m0, s55, 4096
    s_nop 0
    buffer_load_dwordx4 v8, s[28:31], s54 offen offset:1024 sc1 lds
    s_add_u32 m0, s55, 6144
    s_nop 0
    buffer_load_dwordx4 v9, s[28:31], s54 offen sc1 lds
    buffer_load_dwordx4 v9, s[28:31], s54 offen offset:1024 sc1 lds
    s_add_u32 m0, s55, 8192
    s_nop 0
    buffer_load_dwordx4 v10, s[28:31], s54 offen sc1 lds
    buffer_load_dwordx4 v10, s[28:31], s54 offen offset:1024 sc1 lds
    s_add_u32 s54, s54, 2048
    s_add_u32 s55, s55, 10240
    s_cmp_eq_u32 s55, 147456
    s_cselect_b32 s55, 65536, s55
    s_add_u32 m0, s55, 4096
    s_nop 0
    buffer_load_dwordx4 v8, s[28:31], s54 offen offset:1024 sc1 lds
    s_add_u32 m0, s55, 6144
    s_nop 0
    buffer_load_dwordx4 v9, s[28:31], s54 offen sc1 lds
    buffer_load_dwordx4 v9, s[28:31], s54 offen offset:1024 sc1 lds
    s_add_u32 m0, s55, 8192
    s_nop 0
    buffer_load_dwordx4 v10, s[28:31], s54 offen sc1 lds
    buffer_load_dwordx4 v10, s[28:31], s54 offen offset:1024 sc1 lds
    s_add_u32 s54, s54, 2048
    s_add_u32 s55, s55, 10240
    s_cmp_eq_u32 s55, 147456
    s_cselect_b32 s55, 65536, s55
    s_add_u32 m0, s55, 4096
    s_nop 0
    buffer_load_dwordx4 v8, s[28:31], s54 offen offset:1024 sc1 lds
    s_add_u32 m0, s55, 6144
    s_nop 0
    buffer_load_dwordx4 v9, s[28:31], s54 offen sc1 lds
    buffer_load_dwordx4 v9, s[28:31], s54 offen offset:1024 sc1 lds
    s_add_u32 m0, s55, 8192
    s_nop 0
    buffer_load_dwordx4 v10, s[28:31], s54 offen sc1 lds
    buffer_load_dwordx4 v10, s[28:31], s54 offen offset:1024 sc1 lds
    s_add_u32 s54, s54, 2048
    s_add_u32 s55, s55, 10240
    s_cmp_eq_u32 s55, 147456
    s_cselect_b32 s55, 65536, s55
    s_add_u32 m0, s55, 4096
    s_nop 0
    buffer_load_dwordx4 v8, s[28:31], s54 offen offset:1024 sc1 lds
    s_add_u32 m0, s55, 6144
    s_nop 0
    buffer_load_dwordx4 v9, s[28:31], s54 offen sc1 lds
    buffer_load_dwordx4 v9, s[28:31], s54 offen offset:1024 sc1 lds
    s_add_u32 m0, s55, 8192
    s_nop 0
    buffer_load_dwordx4 v10, s[28:31], s54 offen sc1 lds
    buffer_load_dwordx4 v10, s[28:31], s54 offen offset:1024 sc1 lds
    s_add_u32 s54, s54, 2048
    s_add_u32 s55, s55, 10240
    s_cmp_eq_u32 s55, 147456
    s_cselect_b32 s55, 65536, s55
    s_add_u32 m0, s55, 4096
    s_nop 0
    buffer_load_dwordx4 v8, s[28:31], s54 offen offset:1024 sc1 lds
    s_add_u32 m0, s55, 6144
    s_nop 0
    buffer_load_dwordx4 v9, s[28:31], s54 offen sc1 lds
    buffer_load_dwordx4 v9, s[28:31], s54 offen offset:1024 sc1 lds
    s_add_u32 m0, s55, 8192
    s_nop 0
    buffer_load_dwordx4 v10, s[28:31], s54 offen sc1 lds
    buffer_load_dwordx4 v10, s[28:31], s54 offen offset:1024 sc1 lds
    s_add_u32 s54, s54, 2048
    s_add_u32 s55, s55, 10240
    s_cmp_eq_u32 s55, 147456
    s_cselect_b32 s55, 65536, s55
    s_add_u32 m0, s55, 4096
    s_nop 0
    buffer_load_dwordx4 v8, s[28:31], s54 offen offset:1024 sc1 lds
    s_add_u32 m0, s55, 6144
    s_nop 0
    buffer_load_dwordx4 v9, s[28:31], s54 offen sc1 lds
    buffer_load_dwordx4 v9, s[28:31], s54 offen offset:1024 sc1 lds
    s_add_u32 m0, s55, 8192
    s_nop 0
    buffer_load_dwordx4 v10, s[28:31], s54 offen sc1 lds
    buffer_load_dwordx4 v10, s[28:31], s54 offen offset:1024 sc1 lds
    s_add_u32 s54, s54, 2048
    s_add_u32 s55, s55, 10240
    s_cmp_eq_u32 s55, 147456
    s_cselect_b32 s55, 65536, s55
    s_add_u32 m0, s55, 4096
    s_nop 0
    buffer_load_dwordx4 v8, s[28:31], s54 offen offset:1024 sc1 lds
    s_add_u32 m0, s55, 6144
    s_nop 0
    buffer_load_dwordx4 v9, s[28:31], s54 offen sc1 lds
    buffer_load_dwordx4 v9, s[28:31], s54 offen offset:1024 sc1 lds
    s_add_u32 m0, s55, 8192
    s_nop 0
    buffer_load_dwordx4 v10, s[28:31], s54 offen sc1 lds
    buffer_load_dwordx4 v10, s[28:31], s54 offen offset:1024 sc1 lds
    s_add_u32 s54, s54, 2048
    s_add_u32 s55, s55, 10240
    s_cmp_eq_u32 s55, 147456
    s_cselect_b32 s55, 65536, s55
    s_waitcnt vmcnt(30)
    s_barrier
    s_mov_b32 s57, 20
ps_ldl_213:
    s_add_u32 m0, s55, 4096
    s_nop 0
    buffer_load_dwordx4 v8, s[28:31], s54 offen offset:1024 sc1 lds
    s_add_u32 m0, s55, 6144
    s_nop 0
    buffer_load_dwordx4 v9, s[28:31], s54 offen sc1 lds
    buffer_load_dwordx4 v9, s[28:31], s54 offen offset:1024 sc1 lds
    s_add_u32 m0, s55, 8192
    s_nop 0
    buffer_load_dwordx4 v10, s[28:31], s54 offen sc1 lds
    buffer_load_dwordx4 v10, s[28:31], s54 offen offset:1024 sc1 lds
    s_add_u32 s54, s54, 2048
    s_add_u32 s55, s55, 10240
    s_cmp_eq_u32 s55, 147456
    s_cselect_b32 s55, 65536, s55
    s_waitcnt vmcnt(30)
    s_sub_u32 s57, s57, 1
    s_cmp_lg_u32 s57, 0
    s_barrier
    s_cbranch_scc1 ps_ldl_213
    s_waitcnt vmcnt(25)
    s_barrier
    s_waitcnt vmcnt(20)
    s_barrier
    s_waitcnt vmcnt(15)
    s_barrier
    s_waitcnt vmcnt(10)
    s_barrier
    s_waitcnt vmcnt(5)
    s_barrier
    s_waitcnt vmcnt(0)
    s_barrier
    s_barrier
    s_branch ps_next_139
ps_next_139:
    s_add_u32 s3, s3, 1
    s_cmp_lt_u32 s3, 2
    s_cbranch_scc1 ps_top
ps_end:
    s_endpgm
ps_code_end:
    s_endpgm
.section .rodata,"a"
.p2align 6
.amdhsa_kernel interleave_layers__sliding_block__glu_gated_bilinear__prompt_kernel
  .amdhsa_next_free_vgpr 256
  .amdhsa_next_free_sgpr 102
  .amdhsa_accum_offset 256
  .amdhsa_group_segment_fixed_size 0
  .amdhsa_kernarg_size 80
  .amdhsa_user_sgpr_count 2
  .amdhsa_user_sgpr_kernarg_segment_ptr 1
  .amdhsa_system_sgpr_workgroup_id_x 1

.end_amdhsa_kernel
```
